```python
import torch

def _softmax(x, axis=-1):
    return torch.softmax(x, dim=axis)

def _gelu(x):
    return torch.nn.functional.gelu(x, approximate='tanh')

def _silu(x):
    return torch.nn.functional.silu(x)

def _sigmoid(x):
    return torch.sigmoid(x)

def _layernorm(x, axis=-1, eps=1e-05):
    m = x.mean(dim=axis, keepdim=True)
    v = x.var(dim=axis, keepdim=True, unbiased=False)
    return (x - m) / torch.sqrt(v + eps)

def _scatter_add(tgt, idx, src, axis=0):
    return tgt.clone().index_add_(axis, idx, src)

def _segment_sum(src, seg, n):
    out = torch.zeros((n,) + src.shape[1:], dtype=src.dtype)
    return out.index_add_(0, seg, src)

def _pad(x, pw):
    flat = tuple((v for pair in reversed(pw) for v in pair))
    return torch.nn.functional.pad(x, flat)
kernel_name = 'sequential_preLN__mha_block__mixer_gmlp__prompt'

def setup_inputs():

    _w = lambda a: (lambda t: t.to(torch.bfloat16) if t.is_floating_point() else t)(torch.as_tensor(a))

    def _A_setup():
        B, S, D, H = (1, 2048, 512, 32)
        return {'x': _w((lambda *s: torch.randn(*s, dtype=torch.bfloat16) * 0.05)(B, S, D)), 'wqkv': _w((lambda *s: torch.randn(*s, dtype=torch.bfloat16) * 0.05)(D, 3 * D)), 'wo': _w((lambda *s: torch.randn(*s, dtype=torch.bfloat16) * 0.05)(D, D))}
    _A_in = _A_setup()

    def _B_setup():
        B, S, D, F = (1, 2048, 512, 1792)
        Fh = F // 2
        return {'x': _w((lambda *s: torch.randn(*s, dtype=torch.bfloat16) * 0.05)(B, S, D)), 'w_in': _w((lambda *s: torch.randn(*s, dtype=torch.bfloat16) * 0.4)(D, 2 * Fh)), 'w_sp': _w(0.01 * (lambda *s: torch.randn(*s, dtype=torch.bfloat16) * 0.4)(S, S)), 'b_sp': _w(1.0 + 0.01 * (lambda *s: torch.randn(*s, dtype=torch.bfloat16) * 0.05)(S)), 'w_out': _w((lambda *s: torch.randn(*s, dtype=torch.bfloat16) * 0.05)(Fh, D))}
    _B_in = _B_setup()
    return {'A_x': _A_in['x'], 'A_wqkv': _A_in['wqkv'], 'A_wo': _A_in['wo'], 'B_x': _B_in['x'], 'B_w_in': _B_in['w_in'], 'B_w_sp': _B_in['w_sp'], 'B_b_sp': _B_in['b_sp'], 'B_w_out': _B_in['w_out']}

def reference(A_x, A_wqkv, A_wo, B_x, B_w_in, B_w_sp, B_b_sp, B_w_out):

    def _A_ref(x, wqkv, wo):
        B, S, D = x.shape
        H = 32
        Dh = D // H
        qkv = (lambda x, *d: x.permute(*d))((x @ wqkv).reshape(B, S, 3, H, Dh), 2, 0, 3, 1, 4)
        q, k, v = (qkv[0], qkv[1], qkv[2])
        scores = torch.einsum('bhqd,bhkd->bhqk', q, k) * Dh ** (-0.5)
        p = _softmax(scores, axis=-1)
        o = torch.einsum('bhqk,bhkd->bhqd', p, v)
        return (lambda x, *d: x.permute(*d))(o, 0, 2, 1, 3).reshape(B, S, D) @ wo

    def _B_ref(x, w_in, w_sp, b_sp, w_out):
        B, S, D = x.shape
        F = w_in.shape[-1]
        Fh = F // 2
        z = _gelu(torch.einsum('bsd,df->bsf', x, w_in))
        z1 = z[..., :Fh].clone()
        z2 = _layernorm(z[..., Fh:], axis=-1)
        g = torch.einsum('ts,bsf->btf', w_sp, z2) + b_sp[None, :, None]
        return torch.einsum('bsf,fd->bsd', z1 * g, w_out)
    x = A_x
    h = x + _A_ref(_layernorm(x, axis=-1), A_wqkv, A_wo)
    h2 = h + _B_ref(_layernorm(h, axis=-1), B_w_in, B_w_sp, B_b_sp, B_w_out)
    return h2
```

```asm
; @launch grid=(256,1,1) block=(768,1,1) lds=163840
.amdgcn_target "amdgcn-amd-amdhsa--gfx950"

.text
.globl sequential_preLN__mha_block__mixer_gmlp__prompt_kernel
.p2align 8
.type sequential_preLN__mha_block__mixer_gmlp__prompt_kernel,@function
sequential_preLN__mha_block__mixer_gmlp__prompt_kernel:
  s_cmp_ge_u32 s2, 256
  s_cbranch_scc1 L_sequential_preLN__mha_block__mixer_gmlp__prompt_kernel_exit
  s_load_dwordx2 s[24:25], s[0:1], 80
  s_load_dwordx16 s[4:19], s[0:1], 0
  s_load_dwordx4 s[20:23], s[0:1], 64
  v_lshrrev_b32 v2, 6, v0
  v_and_b32 v1, 63, v0
  v_readfirstlane_b32 s34, v2
  v_lshlrev_b32 v2, 4, v1
  s_and_b32 s35, s2, 7
  s_lshr_b32 s36, s2, 3
  s_sub_u32 s40, s34, 8
  s_cbranch_scc0 L_sequential_preLN__mha_block__mixer_gmlp__prompt_kernel_loader
  s_and_b32 s32, s35, 3
  s_lshl_b32 s32, s32, 3
  s_and_b32 s33, s36, 7
  s_add_u32 s41, s32, s33
  s_lshr_b32 s32, s35, 2
  s_lshl_b32 s32, s32, 2
  s_lshr_b32 s42, s36, 3
  s_add_u32 s42, s42, s32
  v_lshrrev_b32 v4, 3, v1
  v_and_b32 v5, 7, v1
  v_lshlrev_b32 v6, 10, v4
  v_lshl_add_u32 v6, v5, 4, v6
  s_lshl_b32 s32, s41, 16
  s_lshl_b32 s33, s34, 13
  s_add_u32 s48, s32, s33
  s_waitcnt lgkmcnt(0)
  s_mov_b32 s52, s4
  s_and_b32 s53, s5, 0xffff
  s_mov_b32 s54, 0x200000
  s_mov_b32 s55, 0x20000
  s_lshr_b32 s56, s36, 3
  s_lshl_b32 s56, s56, 8
  s_and_b32 s56, s56, 1023
  s_add_u32 s32, s56, 0
  s_and_b32 s32, s32, 1023
  s_add_u32 s32, s32, s48
  buffer_load_dwordx4 v[24:27], v6, s[52:55], s32 offen
  buffer_load_dwordx4 v[28:31], v6, s[52:55], s32 offen offset:128
  s_add_u32 s32, s56, 256
  s_and_b32 s32, s32, 1023
  s_add_u32 s32, s32, s48
  buffer_load_dwordx4 v[32:35], v6, s[52:55], s32 offen
  buffer_load_dwordx4 v[36:39], v6, s[52:55], s32 offen offset:128
  s_add_u32 s32, s56, 512
  s_and_b32 s32, s32, 1023
  s_add_u32 s32, s32, s48
  buffer_load_dwordx4 v[40:43], v6, s[52:55], s32 offen
  buffer_load_dwordx4 v[44:47], v6, s[52:55], s32 offen offset:128
  s_add_u32 s32, s56, 768
  s_and_b32 s32, s32, 1023
  s_add_u32 s32, s32, s48
  buffer_load_dwordx4 v[48:51], v6, s[52:55], s32 offen
  buffer_load_dwordx4 v[52:55], v6, s[52:55], s32 offen offset:128
  s_barrier
  s_mov_b32 s28, s24
  s_and_b32 s29, s25, 0xffff
  s_mov_b32 s30, 0x1a00000
  s_mov_b32 s31, 0x20000
  s_and_b32 s32, s34, 1
  s_lshl_b32 s32, s32, 2
  v_lshrrev_b32 v7, 4, v1
  v_add_u32 v7, s32, v7
  v_xor_b32 v7, v7, v5
  s_lshl_b32 s32, s34, 10
  v_lshl_add_u32 v23, v4, 7, s32
  v_lshl_add_u32 v23, v7, 4, v23
  s_and_b32 s45, s34, 1
  s_lshr_b32 s46, s34, 1
  s_and_b32 s46, s46, 1
  s_lshr_b32 s51, s34, 2
  s_lshl_b32 s47, s41, 1
  s_add_u32 s47, s47, s45
  v_lshrrev_b32 v4, 5, v1
  v_lshlrev_b32 v14, 9, v4
  v_bfe_u32 v4, v1, 2, 2
  v_lshl_add_u32 v14, v4, 6, v14
  v_bfe_u32 v4, v1, 4, 1
  v_lshl_add_u32 v14, v4, 5, v14
  v_and_b32 v4, 3, v1
  v_lshl_add_u32 v14, v4, 3, v14
  s_lshl_b32 s32, s46, 10
  s_lshl_b32 s33, s51, 12
  s_add_u32 s32, s32, s33
  s_add_u32 s32, s32, 65536
  v_add_u32 v14, s32, v14
  v_and_b32 v4, 31, v1
  v_bfe_u32 v6, v1, 1, 3
  v_lshrrev_b32 v7, 5, v1
  v_xor_b32 v6, v6, v7
  s_lshl_b32 s32, s45, 12
  v_lshl_add_u32 v4, v4, 7, s32
  v_xor_b32 v7, 0, v6
  v_lshl_add_u32 v10, v7, 4, v4
  v_xor_b32 v7, 2, v6
  v_lshl_add_u32 v11, v7, 4, v4
  v_xor_b32 v7, 4, v6
  v_lshl_add_u32 v12, v7, 4, v4
  v_xor_b32 v7, 6, v6
  v_lshl_add_u32 v13, v7, 4, v4
  s_lshl_b32 s32, s42, 8
  s_lshl_b32 s33, s46, 7
  s_add_u32 s32, s32, s33
  s_add_u32 s32, s32, s47
  s_lshl_b32 s48, s32, 10
  s_lshl_b32 s49, s32, 11
  s_add_u32 s49, s49, 0x200000
  s_lshl_b32 s50, s42, 5
  s_add_u32 s50, s50, s41
  s_mov_b32 s43, 0
  s_and_b32 s44, s36, 7
  s_lshl_b32 s44, s44, 13
  v_mov_b32 v120, 0
  v_mov_b32 v121, 0
  v_mov_b32 v122, 0
  v_mov_b32 v123, 0
  v_mov_b32 v124, 0
  v_mov_b32 v125, 0
  v_mov_b32 v126, 0
  v_mov_b32 v127, 0
  v_mov_b32 v128, 0
  v_mov_b32 v129, 0
  v_mov_b32 v130, 0
  v_mov_b32 v131, 0
  v_mov_b32 v132, 0
  v_mov_b32 v133, 0
  v_mov_b32 v134, 0
  v_mov_b32 v135, 0
  v_mov_b32 v136, 0
  v_mov_b32 v137, 0
  v_mov_b32 v138, 0
  v_mov_b32 v139, 0
  v_mov_b32 v140, 0
  v_mov_b32 v141, 0
  v_mov_b32 v142, 0
  v_mov_b32 v143, 0
  v_mov_b32 v144, 0
  v_mov_b32 v145, 0
  v_mov_b32 v146, 0
  v_mov_b32 v147, 0
  v_mov_b32 v148, 0
  v_mov_b32 v149, 0
  v_mov_b32 v150, 0
  v_mov_b32 v151, 0
  s_cmp_lg_u32 s2, 0
  s_cbranch_scc1 L_sequential_preLN__mha_block__mixer_gmlp__prompt_kernel_p1c_nopub
  s_cmp_lg_u32 s34, 7
  s_cbranch_scc1 L_sequential_preLN__mha_block__mixer_gmlp__prompt_kernel_p1c_nopub
  s_memrealtime s[38:39]
  s_mov_b32 s60, s22
  s_and_b32 s61, s23, 0xffff
  s_mov_b32 s62, 0x100
  s_mov_b32 s63, 0x20000
  s_waitcnt lgkmcnt(0)
  s_or_b32 s39, s39, 0x80000000
  v_mov_b32 v4, s38
  v_mov_b32 v5, s39
  v_mov_b32 v6, 0
  s_mov_b64 exec, 1
  buffer_store_dwordx2 v[4:5], v6, s[60:63], 0 offen sc1
  s_mov_b64 exec, -1
L_sequential_preLN__mha_block__mixer_gmlp__prompt_kernel_p1c_nopub:
  v_mov_b32 v8, 0x3f803f80
  v_mov_b32 v9, 0xffff0000
  v_mov_b32 v4, 0
  v_mov_b32 v5, 0
  v_mov_b32 v6, 0
  v_mov_b32 v7, 0
  s_waitcnt vmcnt(7)
  v_dot2_f32_bf16 v4, v24, v8, v4
  v_dot2_f32_bf16 v5, v24, v24, v5
  v_dot2_f32_bf16 v6, v25, v8, v6
  v_dot2_f32_bf16 v7, v25, v25, v7
  v_dot2_f32_bf16 v4, v26, v8, v4
  v_dot2_f32_bf16 v5, v26, v26, v5
  v_dot2_f32_bf16 v6, v27, v8, v6
  v_dot2_f32_bf16 v7, v27, v27, v7
  s_waitcnt vmcnt(6)
  v_dot2_f32_bf16 v4, v28, v8, v4
  v_dot2_f32_bf16 v5, v28, v28, v5
  v_dot2_f32_bf16 v6, v29, v8, v6
  v_dot2_f32_bf16 v7, v29, v29, v7
  v_dot2_f32_bf16 v4, v30, v8, v4
  v_dot2_f32_bf16 v5, v30, v30, v5
  v_dot2_f32_bf16 v6, v31, v8, v6
  v_dot2_f32_bf16 v7, v31, v31, v7
  s_waitcnt vmcnt(5)
  v_dot2_f32_bf16 v4, v32, v8, v4
  v_dot2_f32_bf16 v5, v32, v32, v5
  v_dot2_f32_bf16 v6, v33, v8, v6
  v_dot2_f32_bf16 v7, v33, v33, v7
  v_dot2_f32_bf16 v4, v34, v8, v4
  v_dot2_f32_bf16 v5, v34, v34, v5
  v_dot2_f32_bf16 v6, v35, v8, v6
  v_dot2_f32_bf16 v7, v35, v35, v7
  s_waitcnt vmcnt(4)
  v_dot2_f32_bf16 v4, v36, v8, v4
  v_dot2_f32_bf16 v5, v36, v36, v5
  v_dot2_f32_bf16 v6, v37, v8, v6
  v_dot2_f32_bf16 v7, v37, v37, v7
  v_dot2_f32_bf16 v4, v38, v8, v4
  v_dot2_f32_bf16 v5, v38, v38, v5
  v_dot2_f32_bf16 v6, v39, v8, v6
  v_dot2_f32_bf16 v7, v39, v39, v7
  s_waitcnt vmcnt(3)
  v_dot2_f32_bf16 v4, v40, v8, v4
  v_dot2_f32_bf16 v5, v40, v40, v5
  v_dot2_f32_bf16 v6, v41, v8, v6
  v_dot2_f32_bf16 v7, v41, v41, v7
  v_dot2_f32_bf16 v4, v42, v8, v4
  v_dot2_f32_bf16 v5, v42, v42, v5
  v_dot2_f32_bf16 v6, v43, v8, v6
  v_dot2_f32_bf16 v7, v43, v43, v7
  s_waitcnt vmcnt(2)
  v_dot2_f32_bf16 v4, v44, v8, v4
  v_dot2_f32_bf16 v5, v44, v44, v5
  v_dot2_f32_bf16 v6, v45, v8, v6
  v_dot2_f32_bf16 v7, v45, v45, v7
  v_dot2_f32_bf16 v4, v46, v8, v4
  v_dot2_f32_bf16 v5, v46, v46, v5
  v_dot2_f32_bf16 v6, v47, v8, v6
  v_dot2_f32_bf16 v7, v47, v47, v7
  s_waitcnt vmcnt(1)
  v_dot2_f32_bf16 v4, v48, v8, v4
  v_dot2_f32_bf16 v5, v48, v48, v5
  v_dot2_f32_bf16 v6, v49, v8, v6
  v_dot2_f32_bf16 v7, v49, v49, v7
  v_dot2_f32_bf16 v4, v50, v8, v4
  v_dot2_f32_bf16 v5, v50, v50, v5
  v_dot2_f32_bf16 v6, v51, v8, v6
  v_dot2_f32_bf16 v7, v51, v51, v7
  s_waitcnt vmcnt(0)
  v_dot2_f32_bf16 v4, v52, v8, v4
  v_dot2_f32_bf16 v5, v52, v52, v5
  v_dot2_f32_bf16 v6, v53, v8, v6
  v_dot2_f32_bf16 v7, v53, v53, v7
  v_dot2_f32_bf16 v4, v54, v8, v4
  v_dot2_f32_bf16 v5, v54, v54, v5
  v_dot2_f32_bf16 v6, v55, v8, v6
  v_dot2_f32_bf16 v7, v55, v55, v7
  s_nop 2
  v_add_f32 v4, v4, v6
  v_add_f32 v5, v5, v7
  s_nop 1
  v_add_f32_dpp v4, v4, v4 quad_perm:[1,0,3,2] row_mask:0xf bank_mask:0xf
  v_add_f32_dpp v5, v5, v5 quad_perm:[1,0,3,2] row_mask:0xf bank_mask:0xf
  s_nop 1
  v_add_f32_dpp v4, v4, v4 quad_perm:[2,3,0,1] row_mask:0xf bank_mask:0xf
  v_add_f32_dpp v5, v5, v5 quad_perm:[2,3,0,1] row_mask:0xf bank_mask:0xf
  s_nop 1
  v_add_f32_dpp v4, v4, v4 row_half_mirror row_mask:0xf bank_mask:0xf
  v_add_f32_dpp v5, v5, v5 row_half_mirror row_mask:0xf bank_mask:0xf
  v_mul_f32 v4, 0x3b000000, v4
  v_mul_f32 v5, 0x3b000000, v5
  v_fma_f32 v5, -v4, v4, v5
  v_max_f32 v5, 0, v5
  v_add_f32 v5, 0x3727c5ac, v5
  v_rsq_f32 v6, v5
  s_nop 0
  v_mul_f32 v7, v4, v6
  v_sub_f32 v7, 0, v7
  v_lshlrev_b32 v56, 16, v24
  v_and_b32 v57, v9, v24
  v_lshlrev_b32 v58, 16, v25
  v_and_b32 v59, v9, v25
  v_lshlrev_b32 v60, 16, v26
  v_and_b32 v61, v9, v26
  v_lshlrev_b32 v62, 16, v27
  v_and_b32 v63, v9, v27
  v_pk_fma_f32 v[56:57], v[56:57], v[6:7], v[6:7] op_sel:[0,0,1] op_sel_hi:[1,0,1]
  v_pk_fma_f32 v[58:59], v[58:59], v[6:7], v[6:7] op_sel:[0,0,1] op_sel_hi:[1,0,1]
  v_pk_fma_f32 v[60:61], v[60:61], v[6:7], v[6:7] op_sel:[0,0,1] op_sel_hi:[1,0,1]
  v_pk_fma_f32 v[62:63], v[62:63], v[6:7], v[6:7] op_sel:[0,0,1] op_sel_hi:[1,0,1]
  v_cvt_pk_bf16_f32 v24, v56, v57
  v_cvt_pk_bf16_f32 v25, v58, v59
  v_cvt_pk_bf16_f32 v26, v60, v61
  v_cvt_pk_bf16_f32 v27, v62, v63
  s_add_u32 s32, s56, 0
  s_and_b32 s32, s32, 1023
  s_lshl_b32 s32, s32, 6
  v_add_u32 v22, s32, v23
  ds_write_b128 v22, v[24:27] offset:0
  v_lshlrev_b32 v56, 16, v28
  v_and_b32 v57, v9, v28
  v_lshlrev_b32 v58, 16, v29
  v_and_b32 v59, v9, v29
  v_lshlrev_b32 v60, 16, v30
  v_and_b32 v61, v9, v30
  v_lshlrev_b32 v62, 16, v31
  v_and_b32 v63, v9, v31
  v_pk_fma_f32 v[56:57], v[56:57], v[6:7], v[6:7] op_sel:[0,0,1] op_sel_hi:[1,0,1]
  v_pk_fma_f32 v[58:59], v[58:59], v[6:7], v[6:7] op_sel:[0,0,1] op_sel_hi:[1,0,1]
  v_pk_fma_f32 v[60:61], v[60:61], v[6:7], v[6:7] op_sel:[0,0,1] op_sel_hi:[1,0,1]
  v_pk_fma_f32 v[62:63], v[62:63], v[6:7], v[6:7] op_sel:[0,0,1] op_sel_hi:[1,0,1]
  v_cvt_pk_bf16_f32 v28, v56, v57
  v_cvt_pk_bf16_f32 v29, v58, v59
  v_cvt_pk_bf16_f32 v30, v60, v61
  v_cvt_pk_bf16_f32 v31, v62, v63
  ds_write_b128 v22, v[28:31] offset:8192
  v_lshlrev_b32 v56, 16, v32
  v_and_b32 v57, v9, v32
  v_lshlrev_b32 v58, 16, v33
  v_and_b32 v59, v9, v33
  v_lshlrev_b32 v60, 16, v34
  v_and_b32 v61, v9, v34
  v_lshlrev_b32 v62, 16, v35
  v_and_b32 v63, v9, v35
  v_pk_fma_f32 v[56:57], v[56:57], v[6:7], v[6:7] op_sel:[0,0,1] op_sel_hi:[1,0,1]
  v_pk_fma_f32 v[58:59], v[58:59], v[6:7], v[6:7] op_sel:[0,0,1] op_sel_hi:[1,0,1]
  v_pk_fma_f32 v[60:61], v[60:61], v[6:7], v[6:7] op_sel:[0,0,1] op_sel_hi:[1,0,1]
  v_pk_fma_f32 v[62:63], v[62:63], v[6:7], v[6:7] op_sel:[0,0,1] op_sel_hi:[1,0,1]
  v_cvt_pk_bf16_f32 v32, v56, v57
  v_cvt_pk_bf16_f32 v33, v58, v59
  v_cvt_pk_bf16_f32 v34, v60, v61
  v_cvt_pk_bf16_f32 v35, v62, v63
  s_add_u32 s32, s56, 256
  s_and_b32 s32, s32, 1023
  s_lshl_b32 s32, s32, 6
  v_add_u32 v22, s32, v23
  ds_write_b128 v22, v[32:35] offset:0
  v_lshlrev_b32 v56, 16, v36
  v_and_b32 v57, v9, v36
  v_lshlrev_b32 v58, 16, v37
  v_and_b32 v59, v9, v37
  v_lshlrev_b32 v60, 16, v38
  v_and_b32 v61, v9, v38
  v_lshlrev_b32 v62, 16, v39
  v_and_b32 v63, v9, v39
  v_pk_fma_f32 v[56:57], v[56:57], v[6:7], v[6:7] op_sel:[0,0,1] op_sel_hi:[1,0,1]
  v_pk_fma_f32 v[58:59], v[58:59], v[6:7], v[6:7] op_sel:[0,0,1] op_sel_hi:[1,0,1]
  v_pk_fma_f32 v[60:61], v[60:61], v[6:7], v[6:7] op_sel:[0,0,1] op_sel_hi:[1,0,1]
  v_pk_fma_f32 v[62:63], v[62:63], v[6:7], v[6:7] op_sel:[0,0,1] op_sel_hi:[1,0,1]
  v_cvt_pk_bf16_f32 v36, v56, v57
  v_cvt_pk_bf16_f32 v37, v58, v59
  v_cvt_pk_bf16_f32 v38, v60, v61
  v_cvt_pk_bf16_f32 v39, v62, v63
  ds_write_b128 v22, v[36:39] offset:8192
  v_lshlrev_b32 v56, 16, v40
  v_and_b32 v57, v9, v40
  v_lshlrev_b32 v58, 16, v41
  v_and_b32 v59, v9, v41
  v_lshlrev_b32 v60, 16, v42
  v_and_b32 v61, v9, v42
  v_lshlrev_b32 v62, 16, v43
  v_and_b32 v63, v9, v43
  v_pk_fma_f32 v[56:57], v[56:57], v[6:7], v[6:7] op_sel:[0,0,1] op_sel_hi:[1,0,1]
  v_pk_fma_f32 v[58:59], v[58:59], v[6:7], v[6:7] op_sel:[0,0,1] op_sel_hi:[1,0,1]
  v_pk_fma_f32 v[60:61], v[60:61], v[6:7], v[6:7] op_sel:[0,0,1] op_sel_hi:[1,0,1]
  v_pk_fma_f32 v[62:63], v[62:63], v[6:7], v[6:7] op_sel:[0,0,1] op_sel_hi:[1,0,1]
  v_cvt_pk_bf16_f32 v40, v56, v57
  v_cvt_pk_bf16_f32 v41, v58, v59
  v_cvt_pk_bf16_f32 v42, v60, v61
  v_cvt_pk_bf16_f32 v43, v62, v63
  s_add_u32 s32, s56, 512
  s_and_b32 s32, s32, 1023
  s_lshl_b32 s32, s32, 6
  v_add_u32 v22, s32, v23
  ds_write_b128 v22, v[40:43] offset:0
  v_lshlrev_b32 v56, 16, v44
  v_and_b32 v57, v9, v44
  v_lshlrev_b32 v58, 16, v45
  v_and_b32 v59, v9, v45
  v_lshlrev_b32 v60, 16, v46
  v_and_b32 v61, v9, v46
  v_lshlrev_b32 v62, 16, v47
  v_and_b32 v63, v9, v47
  v_pk_fma_f32 v[56:57], v[56:57], v[6:7], v[6:7] op_sel:[0,0,1] op_sel_hi:[1,0,1]
  v_pk_fma_f32 v[58:59], v[58:59], v[6:7], v[6:7] op_sel:[0,0,1] op_sel_hi:[1,0,1]
  v_pk_fma_f32 v[60:61], v[60:61], v[6:7], v[6:7] op_sel:[0,0,1] op_sel_hi:[1,0,1]
  v_pk_fma_f32 v[62:63], v[62:63], v[6:7], v[6:7] op_sel:[0,0,1] op_sel_hi:[1,0,1]
  v_cvt_pk_bf16_f32 v44, v56, v57
  v_cvt_pk_bf16_f32 v45, v58, v59
  v_cvt_pk_bf16_f32 v46, v60, v61
  v_cvt_pk_bf16_f32 v47, v62, v63
  ds_write_b128 v22, v[44:47] offset:8192
  v_lshlrev_b32 v56, 16, v48
  v_and_b32 v57, v9, v48
  v_lshlrev_b32 v58, 16, v49
  v_and_b32 v59, v9, v49
  v_lshlrev_b32 v60, 16, v50
  v_and_b32 v61, v9, v50
  v_lshlrev_b32 v62, 16, v51
  v_and_b32 v63, v9, v51
  v_pk_fma_f32 v[56:57], v[56:57], v[6:7], v[6:7] op_sel:[0,0,1] op_sel_hi:[1,0,1]
  v_pk_fma_f32 v[58:59], v[58:59], v[6:7], v[6:7] op_sel:[0,0,1] op_sel_hi:[1,0,1]
  v_pk_fma_f32 v[60:61], v[60:61], v[6:7], v[6:7] op_sel:[0,0,1] op_sel_hi:[1,0,1]
  v_pk_fma_f32 v[62:63], v[62:63], v[6:7], v[6:7] op_sel:[0,0,1] op_sel_hi:[1,0,1]
  v_cvt_pk_bf16_f32 v48, v56, v57
  v_cvt_pk_bf16_f32 v49, v58, v59
  v_cvt_pk_bf16_f32 v50, v60, v61
  v_cvt_pk_bf16_f32 v51, v62, v63
  s_add_u32 s32, s56, 768
  s_and_b32 s32, s32, 1023
  s_lshl_b32 s32, s32, 6
  v_add_u32 v22, s32, v23
  ds_write_b128 v22, v[48:51] offset:0
  v_lshlrev_b32 v56, 16, v52
  v_and_b32 v57, v9, v52
  v_lshlrev_b32 v58, 16, v53
  v_and_b32 v59, v9, v53
  v_lshlrev_b32 v60, 16, v54
  v_and_b32 v61, v9, v54
  v_lshlrev_b32 v62, 16, v55
  v_and_b32 v63, v9, v55
  v_pk_fma_f32 v[56:57], v[56:57], v[6:7], v[6:7] op_sel:[0,0,1] op_sel_hi:[1,0,1]
  v_pk_fma_f32 v[58:59], v[58:59], v[6:7], v[6:7] op_sel:[0,0,1] op_sel_hi:[1,0,1]
  v_pk_fma_f32 v[60:61], v[60:61], v[6:7], v[6:7] op_sel:[0,0,1] op_sel_hi:[1,0,1]
  v_pk_fma_f32 v[62:63], v[62:63], v[6:7], v[6:7] op_sel:[0,0,1] op_sel_hi:[1,0,1]
  v_cvt_pk_bf16_f32 v52, v56, v57
  v_cvt_pk_bf16_f32 v53, v58, v59
  v_cvt_pk_bf16_f32 v54, v60, v61
  v_cvt_pk_bf16_f32 v55, v62, v63
  ds_write_b128 v22, v[52:55] offset:8192
  s_cmp_lg_u32 s34, 6
  s_cbranch_scc1 L_sequential_preLN__mha_block__mixer_gmlp__prompt_kernel_p1c_nowarm
  v_lshlrev_b32 v4, 7, v1
  s_lshl_b32 s32, s2, 3
  s_mov_b64 exec, 0xff
  s_lshl_b32 s32, s32, 7
  s_add_u32 s32, s32, 0x1700000
  buffer_load_dword v152, v4, s[28:31], s32 offen sc1
  s_mov_b64 exec, -1
L_sequential_preLN__mha_block__mixer_gmlp__prompt_kernel_p1c_nowarm:
  s_cmp_lt_u32 s34, 4
  s_cbranch_scc1 L_sequential_preLN__mha_block__mixer_gmlp__prompt_kernel_p1c_noct2
L_sequential_preLN__mha_block__mixer_gmlp__prompt_kernel_p1c_noct2:
  s_waitcnt lgkmcnt(0)
  s_cmp_ge_u32 s34, 4
  s_cbranch_scc1 L_sequential_preLN__mha_block__mixer_gmlp__prompt_kernel_p1c_vgrp
  v_add_u32 v15, s44, v10
  v_add_u32 v16, s44, v11
  v_add_u32 v17, s44, v12
  v_add_u32 v18, s44, v13
  v_add_u32 v19, s43, v14
  s_add_u32 s44, s44, 8192
  s_and_b32 s44, s44, 0xffff
  s_add_u32 s43, s43, 24576
  s_cmp_eq_u32 s43, 98304
  s_cselect_b32 s43, 0, s43
  s_barrier
  ds_read_b128 v[24:27], v15
  ds_read_b64_tr_b16 v[56:57], v19 offset:0
  ds_read_b64_tr_b16 v[58:59], v19 offset:256
  ds_read_b64_tr_b16 v[60:61], v19 offset:2048
  ds_read_b64_tr_b16 v[62:63], v19 offset:2304
  ds_read_b128 v[28:31], v16
  ds_read_b64_tr_b16 v[64:65], v19 offset:6144
  ds_read_b64_tr_b16 v[66:67], v19 offset:6400
  ds_read_b64_tr_b16 v[68:69], v19 offset:8192
  ds_read_b64_tr_b16 v[70:71], v19 offset:8448
  ds_read_b128 v[32:35], v17
  ds_read_b64_tr_b16 v[72:73], v19 offset:12288
  ds_read_b64_tr_b16 v[74:75], v19 offset:12544
  ds_read_b64_tr_b16 v[76:77], v19 offset:14336
  ds_read_b64_tr_b16 v[78:79], v19 offset:14592
  ds_read_b128 v[36:39], v18
  ds_read_b64_tr_b16 v[80:81], v19 offset:18432
  ds_read_b64_tr_b16 v[82:83], v19 offset:18688
  ds_read_b64_tr_b16 v[84:85], v19 offset:20480
  ds_read_b64_tr_b16 v[86:87], v19 offset:20736
  v_add_u32 v15, s44, v10
  v_add_u32 v16, s44, v11
  v_add_u32 v17, s44, v12
  v_add_u32 v18, s44, v13
  v_add_u32 v19, s43, v14
  s_add_u32 s44, s44, 8192
  s_and_b32 s44, s44, 0xffff
  s_add_u32 s43, s43, 24576
  s_cmp_eq_u32 s43, 98304
  s_cselect_b32 s43, 0, s43
  s_waitcnt lgkmcnt(0)
  s_mov_b32 s37, 3
L_sequential_preLN__mha_block__mixer_gmlp__prompt_kernel_p1c_loopa:
  s_barrier
  v_mfma_f32_32x32x16_bf16 v[120:135], v[56:59], v[24:27], v[120:135]
  ds_read_b128 v[40:43], v15
  ds_read_b64_tr_b16 v[88:89], v19 offset:0
  ds_read_b64_tr_b16 v[90:91], v19 offset:256
  v_mfma_f32_32x32x16_bf16 v[136:151], v[60:63], v[24:27], v[136:151]
  ds_read_b64_tr_b16 v[92:93], v19 offset:2048
  ds_read_b64_tr_b16 v[94:95], v19 offset:2304
  ds_read_b128 v[44:47], v16
  v_mfma_f32_32x32x16_bf16 v[120:135], v[64:67], v[28:31], v[120:135]
  ds_read_b64_tr_b16 v[96:97], v19 offset:6144
  ds_read_b64_tr_b16 v[98:99], v19 offset:6400
  ds_read_b64_tr_b16 v[100:101], v19 offset:8192
  v_mfma_f32_32x32x16_bf16 v[136:151], v[68:71], v[28:31], v[136:151]
  ds_read_b64_tr_b16 v[102:103], v19 offset:8448
  ds_read_b128 v[48:51], v17
  ds_read_b64_tr_b16 v[104:105], v19 offset:12288
  v_mfma_f32_32x32x16_bf16 v[120:135], v[72:75], v[32:35], v[120:135]
  ds_read_b64_tr_b16 v[106:107], v19 offset:12544
  ds_read_b64_tr_b16 v[108:109], v19 offset:14336
  ds_read_b64_tr_b16 v[110:111], v19 offset:14592
  v_mfma_f32_32x32x16_bf16 v[136:151], v[76:79], v[32:35], v[136:151]
  ds_read_b128 v[52:55], v18
  ds_read_b64_tr_b16 v[112:113], v19 offset:18432
  ds_read_b64_tr_b16 v[114:115], v19 offset:18688
  v_mfma_f32_32x32x16_bf16 v[120:135], v[80:83], v[36:39], v[120:135]
  ds_read_b64_tr_b16 v[116:117], v19 offset:20480
  ds_read_b64_tr_b16 v[118:119], v19 offset:20736
  v_add_u32 v15, s44, v10
  v_mfma_f32_32x32x16_bf16 v[136:151], v[84:87], v[36:39], v[136:151]
  v_add_u32 v16, s44, v11
  v_add_u32 v17, s44, v12
  v_add_u32 v18, s44, v13
  v_add_u32 v19, s43, v14
  s_add_u32 s44, s44, 8192
  s_and_b32 s44, s44, 0xffff
  s_add_u32 s43, s43, 24576
  s_cmp_eq_u32 s43, 98304
  s_cselect_b32 s43, 0, s43
  s_waitcnt lgkmcnt(0)
  s_barrier
  v_mfma_f32_32x32x16_bf16 v[120:135], v[88:91], v[40:43], v[120:135]
  ds_read_b128 v[24:27], v15
  ds_read_b64_tr_b16 v[56:57], v19 offset:0
  ds_read_b64_tr_b16 v[58:59], v19 offset:256
  v_mfma_f32_32x32x16_bf16 v[136:151], v[92:95], v[40:43], v[136:151]
  ds_read_b64_tr_b16 v[60:61], v19 offset:2048
  ds_read_b64_tr_b16 v[62:63], v19 offset:2304
  ds_read_b128 v[28:31], v16
  v_mfma_f32_32x32x16_bf16 v[120:135], v[96:99], v[44:47], v[120:135]
  ds_read_b64_tr_b16 v[64:65], v19 offset:6144
  ds_read_b64_tr_b16 v[66:67], v19 offset:6400
  ds_read_b64_tr_b16 v[68:69], v19 offset:8192
  v_mfma_f32_32x32x16_bf16 v[136:151], v[100:103], v[44:47], v[136:151]
  ds_read_b64_tr_b16 v[70:71], v19 offset:8448
  ds_read_b128 v[32:35], v17
  ds_read_b64_tr_b16 v[72:73], v19 offset:12288
  v_mfma_f32_32x32x16_bf16 v[120:135], v[104:107], v[48:51], v[120:135]
  ds_read_b64_tr_b16 v[74:75], v19 offset:12544
  ds_read_b64_tr_b16 v[76:77], v19 offset:14336
  ds_read_b64_tr_b16 v[78:79], v19 offset:14592
  v_mfma_f32_32x32x16_bf16 v[136:151], v[108:111], v[48:51], v[136:151]
  ds_read_b128 v[36:39], v18
  ds_read_b64_tr_b16 v[80:81], v19 offset:18432
  ds_read_b64_tr_b16 v[82:83], v19 offset:18688
  v_mfma_f32_32x32x16_bf16 v[120:135], v[112:115], v[52:55], v[120:135]
  ds_read_b64_tr_b16 v[84:85], v19 offset:20480
  ds_read_b64_tr_b16 v[86:87], v19 offset:20736
  v_add_u32 v15, s44, v10
  v_mfma_f32_32x32x16_bf16 v[136:151], v[116:119], v[52:55], v[136:151]
  v_add_u32 v16, s44, v11
  v_add_u32 v17, s44, v12
  v_add_u32 v18, s44, v13
  v_add_u32 v19, s43, v14
  s_add_u32 s44, s44, 8192
  s_and_b32 s44, s44, 0xffff
  s_add_u32 s43, s43, 24576
  s_cmp_eq_u32 s43, 98304
  s_cselect_b32 s43, 0, s43
  s_sub_u32 s37, s37, 1
  s_cmp_lg_u32 s37, 0
  s_waitcnt lgkmcnt(0)
  s_cbranch_scc1 L_sequential_preLN__mha_block__mixer_gmlp__prompt_kernel_p1c_loopa
  s_barrier
  v_mfma_f32_32x32x16_bf16 v[120:135], v[56:59], v[24:27], v[120:135]
  ds_read_b128 v[40:43], v15
  ds_read_b64_tr_b16 v[88:89], v19 offset:0
  ds_read_b64_tr_b16 v[90:91], v19 offset:256
  v_mfma_f32_32x32x16_bf16 v[136:151], v[60:63], v[24:27], v[136:151]
  ds_read_b64_tr_b16 v[92:93], v19 offset:2048
  ds_read_b64_tr_b16 v[94:95], v19 offset:2304
  ds_read_b128 v[44:47], v16
  v_mfma_f32_32x32x16_bf16 v[120:135], v[64:67], v[28:31], v[120:135]
  ds_read_b64_tr_b16 v[96:97], v19 offset:6144
  ds_read_b64_tr_b16 v[98:99], v19 offset:6400
  ds_read_b64_tr_b16 v[100:101], v19 offset:8192
  v_mfma_f32_32x32x16_bf16 v[136:151], v[68:71], v[28:31], v[136:151]
  ds_read_b64_tr_b16 v[102:103], v19 offset:8448
  ds_read_b128 v[48:51], v17
  ds_read_b64_tr_b16 v[104:105], v19 offset:12288
  v_mfma_f32_32x32x16_bf16 v[120:135], v[72:75], v[32:35], v[120:135]
  ds_read_b64_tr_b16 v[106:107], v19 offset:12544
  ds_read_b64_tr_b16 v[108:109], v19 offset:14336
  ds_read_b64_tr_b16 v[110:111], v19 offset:14592
  v_mfma_f32_32x32x16_bf16 v[136:151], v[76:79], v[32:35], v[136:151]
  ds_read_b128 v[52:55], v18
  ds_read_b64_tr_b16 v[112:113], v19 offset:18432
  ds_read_b64_tr_b16 v[114:115], v19 offset:18688
  v_mfma_f32_32x32x16_bf16 v[120:135], v[80:83], v[36:39], v[120:135]
  ds_read_b64_tr_b16 v[116:117], v19 offset:20480
  ds_read_b64_tr_b16 v[118:119], v19 offset:20736
  v_mov_b32 v22, 90112
  v_mfma_f32_32x32x16_bf16 v[136:151], v[84:87], v[36:39], v[136:151]
  ds_read_b64 v[20:21], v22
  s_waitcnt lgkmcnt(0)
  v_mfma_f32_32x32x16_bf16 v[120:135], v[88:91], v[40:43], v[120:135]
  v_mfma_f32_32x32x16_bf16 v[136:151], v[92:95], v[40:43], v[136:151]
  v_mfma_f32_32x32x16_bf16 v[120:135], v[96:99], v[44:47], v[120:135]
  v_mfma_f32_32x32x16_bf16 v[136:151], v[100:103], v[44:47], v[136:151]
  v_mfma_f32_32x32x16_bf16 v[120:135], v[104:107], v[48:51], v[120:135]
  v_mfma_f32_32x32x16_bf16 v[136:151], v[108:111], v[48:51], v[136:151]
  v_mfma_f32_32x32x16_bf16 v[120:135], v[112:115], v[52:55], v[120:135]
  v_mfma_f32_32x32x16_bf16 v[136:151], v[116:119], v[52:55], v[136:151]
  v_and_b32 v15, 0x33, v1
  v_bfe_u32 v4, v1, 2, 1
  v_lshl_add_u32 v15, v4, 3, v15
  v_bfe_u32 v4, v1, 3, 1
  v_lshl_add_u32 v15, v4, 2, v15
  v_lshlrev_b32 v15, 4, v15
  s_mov_b32 s33, 0x3eb8aa3b
  s_add_u32 s32, s49, 131072
  s_nop 3
  v_mul_f32 v120, s33, v120
  v_mul_f32 v121, s33, v121
  v_mul_f32 v122, s33, v122
  v_mul_f32 v123, s33, v123
  v_mul_f32 v124, s33, v124
  v_mul_f32 v125, s33, v125
  v_mul_f32 v126, s33, v126
  v_mul_f32 v127, s33, v127
  v_mul_f32 v128, s33, v128
  v_mul_f32 v129, s33, v129
  v_mul_f32 v130, s33, v130
  v_mul_f32 v131, s33, v131
  v_mul_f32 v132, s33, v132
  v_mul_f32 v133, s33, v133
  v_mul_f32 v134, s33, v134
  v_mul_f32 v135, s33, v135
  v_cvt_pk_bf16_f32 v24, v136, v137
  v_cvt_pk_bf16_f32 v25, v138, v139
  v_cvt_pk_bf16_f32 v26, v140, v141
  v_cvt_pk_bf16_f32 v27, v142, v143
  v_cvt_pk_bf16_f32 v28, v144, v145
  v_cvt_pk_bf16_f32 v29, v146, v147
  v_cvt_pk_bf16_f32 v30, v148, v149
  v_cvt_pk_bf16_f32 v31, v150, v151
  buffer_store_dwordx4 v[24:27], v15, s[28:31], s49 offen sc1
  buffer_store_dwordx4 v[28:31], v15, s[28:31], s32 offen sc1
  v_cvt_pk_bf16_f32 v32, v120, v121
  v_cvt_pk_bf16_f32 v33, v122, v123
  v_cvt_pk_bf16_f32 v34, v124, v125
  v_cvt_pk_bf16_f32 v35, v126, v127
  v_cvt_pk_bf16_f32 v36, v128, v129
  v_cvt_pk_bf16_f32 v37, v130, v131
  v_cvt_pk_bf16_f32 v38, v132, v133
  v_cvt_pk_bf16_f32 v39, v134, v135
  buffer_store_dwordx4 v[32:35], v2, s[28:31], s48 offen sc1
  s_add_u32 s48, s48, 65536
  buffer_store_dwordx4 v[36:39], v2, s[28:31], s48 offen sc1
  s_branch L_sequential_preLN__mha_block__mixer_gmlp__prompt_kernel_p1c_fl
L_sequential_preLN__mha_block__mixer_gmlp__prompt_kernel_p1c_vgrp:
  v_add_u32 v15, s44, v10
  v_add_u32 v16, s44, v11
  v_add_u32 v17, s44, v12
  v_add_u32 v18, s44, v13
  v_add_u32 v19, s43, v14
  s_add_u32 s44, s44, 8192
  s_and_b32 s44, s44, 0xffff
  s_add_u32 s43, s43, 24576
  s_cmp_eq_u32 s43, 98304
  s_cselect_b32 s43, 0, s43
  s_barrier
  ds_read_b128 v[24:27], v15
  ds_read_b64_tr_b16 v[56:57], v19 offset:0
  ds_read_b64_tr_b16 v[58:59], v19 offset:256
  ds_read_b128 v[28:31], v16
  ds_read_b64_tr_b16 v[60:61], v19 offset:6144
  ds_read_b64_tr_b16 v[62:63], v19 offset:6400
  ds_read_b128 v[32:35], v17
  ds_read_b64_tr_b16 v[64:65], v19 offset:12288
  ds_read_b64_tr_b16 v[66:67], v19 offset:12544
  ds_read_b128 v[36:39], v18
  ds_read_b64_tr_b16 v[68:69], v19 offset:18432
  ds_read_b64_tr_b16 v[70:71], v19 offset:18688
  v_add_u32 v15, s44, v10
  v_add_u32 v16, s44, v11
  v_add_u32 v17, s44, v12
  v_add_u32 v18, s44, v13
  v_add_u32 v19, s43, v14
  s_add_u32 s44, s44, 8192
  s_and_b32 s44, s44, 0xffff
  s_add_u32 s43, s43, 24576
  s_cmp_eq_u32 s43, 98304
  s_cselect_b32 s43, 0, s43
  s_waitcnt lgkmcnt(0)
  s_mov_b32 s37, 3
L_sequential_preLN__mha_block__mixer_gmlp__prompt_kernel_p1c_loopb:
  s_barrier
  v_mfma_f32_32x32x16_bf16 v[120:135], v[24:27], v[56:59], v[120:135]
  ds_read_b128 v[40:43], v15
  ds_read_b64_tr_b16 v[88:89], v19 offset:0
  ds_read_b64_tr_b16 v[90:91], v19 offset:256
  ds_read_b128 v[44:47], v16
  ds_read_b64_tr_b16 v[92:93], v19 offset:6144
  v_mfma_f32_32x32x16_bf16 v[120:135], v[28:31], v[60:63], v[120:135]
  ds_read_b64_tr_b16 v[94:95], v19 offset:6400
  ds_read_b128 v[48:51], v17
  ds_read_b64_tr_b16 v[96:97], v19 offset:12288
  ds_read_b64_tr_b16 v[98:99], v19 offset:12544
  ds_read_b128 v[52:55], v18
  v_mfma_f32_32x32x16_bf16 v[120:135], v[32:35], v[64:67], v[120:135]
  ds_read_b64_tr_b16 v[100:101], v19 offset:18432
  ds_read_b64_tr_b16 v[102:103], v19 offset:18688
  v_add_u32 v15, s44, v10
  v_add_u32 v16, s44, v11
  v_add_u32 v17, s44, v12
  v_mfma_f32_32x32x16_bf16 v[120:135], v[36:39], v[68:71], v[120:135]
  v_add_u32 v18, s44, v13
  v_add_u32 v19, s43, v14
  s_add_u32 s44, s44, 8192
  s_and_b32 s44, s44, 0xffff
  s_add_u32 s43, s43, 24576
  s_cmp_eq_u32 s43, 98304
  s_cselect_b32 s43, 0, s43
  s_waitcnt lgkmcnt(0)
  s_barrier
  v_mfma_f32_32x32x16_bf16 v[120:135], v[40:43], v[88:91], v[120:135]
  ds_read_b128 v[24:27], v15
  ds_read_b64_tr_b16 v[56:57], v19 offset:0
  ds_read_b64_tr_b16 v[58:59], v19 offset:256
  ds_read_b128 v[28:31], v16
  ds_read_b64_tr_b16 v[60:61], v19 offset:6144
  v_mfma_f32_32x32x16_bf16 v[120:135], v[44:47], v[92:95], v[120:135]
  ds_read_b64_tr_b16 v[62:63], v19 offset:6400
  ds_read_b128 v[32:35], v17
  ds_read_b64_tr_b16 v[64:65], v19 offset:12288
  ds_read_b64_tr_b16 v[66:67], v19 offset:12544
  ds_read_b128 v[36:39], v18
  v_mfma_f32_32x32x16_bf16 v[120:135], v[48:51], v[96:99], v[120:135]
  ds_read_b64_tr_b16 v[68:69], v19 offset:18432
  ds_read_b64_tr_b16 v[70:71], v19 offset:18688
  v_add_u32 v15, s44, v10
  v_add_u32 v16, s44, v11
  v_add_u32 v17, s44, v12
  v_mfma_f32_32x32x16_bf16 v[120:135], v[52:55], v[100:103], v[120:135]
  v_add_u32 v18, s44, v13
  v_add_u32 v19, s43, v14
  s_add_u32 s44, s44, 8192
  s_and_b32 s44, s44, 0xffff
  s_add_u32 s43, s43, 24576
  s_cmp_eq_u32 s43, 98304
  s_cselect_b32 s43, 0, s43
  s_sub_u32 s37, s37, 1
  s_cmp_lg_u32 s37, 0
  s_waitcnt lgkmcnt(0)
  s_cbranch_scc1 L_sequential_preLN__mha_block__mixer_gmlp__prompt_kernel_p1c_loopb
  s_barrier
  v_mfma_f32_32x32x16_bf16 v[120:135], v[24:27], v[56:59], v[120:135]
  ds_read_b128 v[40:43], v15
  ds_read_b64_tr_b16 v[88:89], v19 offset:0
  ds_read_b64_tr_b16 v[90:91], v19 offset:256
  ds_read_b128 v[44:47], v16
  ds_read_b64_tr_b16 v[92:93], v19 offset:6144
  v_mfma_f32_32x32x16_bf16 v[120:135], v[28:31], v[60:63], v[120:135]
  ds_read_b64_tr_b16 v[94:95], v19 offset:6400
  ds_read_b128 v[48:51], v17
  ds_read_b64_tr_b16 v[96:97], v19 offset:12288
  ds_read_b64_tr_b16 v[98:99], v19 offset:12544
  ds_read_b128 v[52:55], v18
  v_mfma_f32_32x32x16_bf16 v[120:135], v[32:35], v[64:67], v[120:135]
  ds_read_b64_tr_b16 v[100:101], v19 offset:18432
  ds_read_b64_tr_b16 v[102:103], v19 offset:18688
  v_mov_b32 v22, 90112
  ds_read_b64 v[20:21], v22
  v_mfma_f32_32x32x16_bf16 v[120:135], v[36:39], v[68:71], v[120:135]
  s_waitcnt lgkmcnt(0)
  v_mfma_f32_32x32x16_bf16 v[120:135], v[40:43], v[88:91], v[120:135]
  v_mfma_f32_32x32x16_bf16 v[120:135], v[44:47], v[92:95], v[120:135]
  v_mfma_f32_32x32x16_bf16 v[120:135], v[48:51], v[96:99], v[120:135]
  v_mfma_f32_32x32x16_bf16 v[120:135], v[52:55], v[100:103], v[120:135]
  v_bfe_u32 v6, v1, 4, 1
  v_lshlrev_b32 v15, 17, v6
  v_lshrrev_b32 v7, 5, v1
  v_lshl_add_u32 v15, v7, 8, v15
  v_and_b32 v6, 15, v1
  v_lshl_add_u32 v15, v6, 4, v15
  s_nop 5
  v_cvt_pk_bf16_f32 v24, v120, v121
  v_cvt_pk_bf16_f32 v25, v122, v123
  v_cvt_pk_bf16_f32 v26, v124, v125
  v_cvt_pk_bf16_f32 v27, v126, v127
  v_cvt_pk_bf16_f32 v28, v128, v129
  v_cvt_pk_bf16_f32 v29, v130, v131
  v_cvt_pk_bf16_f32 v30, v132, v133
  v_cvt_pk_bf16_f32 v31, v134, v135
  buffer_store_dwordx4 v[24:27], v15, s[28:31], s49 offen offset:1024 sc1
  buffer_store_dwordx4 v[28:31], v15, s[28:31], s49 offen offset:1536 sc1
L_sequential_preLN__mha_block__mixer_gmlp__prompt_kernel_p1c_fl:
  v_readfirstlane_b32 s38, v20
  v_readfirstlane_b32 s39, v21
  s_nop 1
  s_lshl_b32 s50, s50, 7
  s_add_u32 s50, s50, 0x1700000
  v_lshlrev_b32 v6, 15, v1
  v_mov_b32 v4, s38
  v_mov_b32 v5, s39
  s_waitcnt vmcnt(0)
  s_barrier
  s_cmp_lg_u32 s34, 0
  s_cbranch_scc1 L_sequential_preLN__mha_block__mixer_gmlp__prompt_kernel_p1c_nofl
  s_mov_b64 exec, 255
  buffer_store_dwordx2 v[4:5], v6, s[28:31], s50 offen sc1
  s_mov_b64 exec, -1
L_sequential_preLN__mha_block__mixer_gmlp__prompt_kernel_p1c_nofl:
  s_lshl_b32 s32, s35, 2
  s_lshr_b32 s33, s36, 3
  s_add_u32 s41, s32, s33
  s_and_b32 s42, s36, 7
  s_lshr_b32 s45, s34, 2
  s_and_b32 s32, s34, 3
  s_lshl_b32 s32, s32, 1
  s_lshl_b32 s33, s42, 3
  s_add_u32 s32, s32, s33
  s_add_u32 s43, s32, s45
  s_lshl_b32 s43, s43, 5
  s_add_u32 s43, s43, s41
  s_lshl_b32 s46, s42, 5
  s_add_u32 s46, s46, s41
  s_add_u32 s46, s46, 2048
  s_lshl_b32 s43, s43, 10
  s_add_u32 s43, s43, 0x600000
  s_lshl_b32 s33, s41, 6
  s_add_u32 s44, s32, s33
  s_lshl_b32 s44, s44, 10
  v_lshrrev_b32 v7, 5, v1
  v_and_b32 v9, 15, v1
  v_lshl_add_u32 v9, v7, 4, v9
  v_lshlrev_b32 v9, 4, v9
  v_add_u32 v9, 1024, v9
  v_and_b32 v7, 27, v1
  v_cmp_eq_u32 vcc, 16, v7
  v_mov_b32 v8, 132112
  v_mov_b32 v3, 132096
  v_cndmask_b32 v8, v8, v3, vcc
  v_and_b32 v7, 16, v1
  v_cmp_eq_u32 vcc, 0, v7
  s_lshl_b32 s32, s45, 16
  v_mov_b32 v3, 8192
  v_cndmask_b32 v5, 0, v3, vcc
  v_add_u32 v4, s32, v9
  v_cndmask_b32 v4, v8, v4, vcc
  v_add_u32 v3, s32, v2
  v_mov_b32 v6, 0xdddddddd
  v_lshrrev_b32 v7, 1, v1
  v_min_u32 v7, 23, v7
  v_lshlrev_b32 v7, 9, v7
  v_and_b32 v8, 1, v1
  v_lshl_add_u32 v7, v8, 4, v7
  v_add_u32 v7, 131072, v7
  v_cmp_eq_u32 vcc, 0, v8
  v_mov_b32 v8, 0x3f803f80
  s_nop 0
  v_cndmask_b32 v28, 0, v8, vcc
  v_cndmask_b32 v29, 0, v8, vcc
  v_cndmask_b32 v30, 0, v8, vcc
  v_cndmask_b32 v31, 0, v8, vcc
  ds_write_b128 v7, v[28:31]
  v_mov_b32 v104, 0
  v_mov_b32 v105, 0
  v_mov_b32 v106, 0
  v_mov_b32 v107, 0
  v_mov_b32 v108, 0
  v_mov_b32 v109, 0
  v_mov_b32 v110, 0
  v_mov_b32 v111, 0
  v_mov_b32 v112, 0
  v_mov_b32 v113, 0
  v_mov_b32 v114, 0
  v_mov_b32 v115, 0
  v_mov_b32 v116, 0
  v_mov_b32 v117, 0
  v_mov_b32 v118, 0
  v_mov_b32 v119, 0
  v_mov_b32 v120, 0
  v_mov_b32 v121, 0
  v_mov_b32 v122, 0
  v_mov_b32 v123, 0
  v_mov_b32 v124, 0
  v_mov_b32 v125, 0
  v_mov_b32 v126, 0
  v_mov_b32 v127, 0
  v_mov_b32 v128, 0
  v_mov_b32 v129, 0
  v_mov_b32 v130, 0
  v_mov_b32 v131, 0
  v_mov_b32 v132, 0
  v_mov_b32 v133, 0
  v_mov_b32 v134, 0
  v_mov_b32 v135, 0
  v_mov_b32 v64, 0
  v_mov_b32 v65, 0
  v_mov_b32 v66, 0
  v_mov_b32 v67, 0
  v_mov_b32 v68, 0
  v_mov_b32 v69, 0
  v_mov_b32 v70, 0
  v_mov_b32 v71, 0
  v_mov_b32 v36, 0
  v_mov_b32 v37, 0
  v_mov_b32 v38, 0
  v_mov_b32 v39, 0
  s_cmp_lg_u32 s34, 0
  s_cbranch_scc1 L_sequential_preLN__mha_block__mixer_gmlp__prompt_kernel_p2c_nopoll
  s_lshl_b32 s32, s35, 5
  s_and_b32 s33, s36, 7
  s_lshl_b32 s33, s33, 8
  s_add_u32 s32, s32, s33
  s_lshl_b32 s32, s32, 7
  s_add_u32 s32, s32, 0x1700000
  v_min_u32 v8, 31, v1
  v_lshlrev_b32 v8, 7, v8
  s_mov_b32 s37, 100000
  s_mov_b32 exec_hi, 0x0
  s_branch L_sequential_preLN__mha_block__mixer_gmlp__prompt_kernel_p2c_pollg
L_sequential_preLN__mha_block__mixer_gmlp__prompt_kernel_p2c_poll:
  s_sleep 2
L_sequential_preLN__mha_block__mixer_gmlp__prompt_kernel_p2c_pollg:
  buffer_load_dwordx2 v[12:13], v8, s[28:31], s32 offen sc1
  s_sub_u32 s37, s37, 1
  s_cbranch_scc1 L_sequential_preLN__mha_block__mixer_gmlp__prompt_kernel_p2c_pollx
  s_waitcnt vmcnt(0)
  v_cmp_ne_u64 vcc, s[38:39], v[12:13]
  s_and_b64 exec, exec, vcc
  s_cbranch_scc1 L_sequential_preLN__mha_block__mixer_gmlp__prompt_kernel_p2c_poll
L_sequential_preLN__mha_block__mixer_gmlp__prompt_kernel_p2c_pollx:
  s_mov_b64 exec, -1
L_sequential_preLN__mha_block__mixer_gmlp__prompt_kernel_p2c_nopoll:
  s_barrier
  buffer_load_dwordx4 v[12:15], v2, s[28:31], s44 offen sc1
  buffer_load_dwordx4 v[16:19], v2, s[28:31], s44 offen offset:1024 sc1
  s_waitcnt lgkmcnt(0)
  s_barrier
  ds_read_b128 v[28:31], v2
  ds_read_b128 v[20:23], v3
  ds_read_b128 v[24:27], v3 offset:2048
  s_waitcnt vmcnt(0) lgkmcnt(2)
  v_mfma_f32_32x32x16_bf16 v[72:87], v[28:31], v[12:15], 0
  v_mfma_f32_32x32x16_bf16 v[88:103], v[28:31], v[16:19], 0
  ds_read_b128 v[28:31], v4
  ds_read_b128 v[32:35], v4 offset:512
  s_nop 9
  v_max3_f32 v7, v72, v73, v74
  v_max3_f32 v7, v7, v75, v76
  v_max3_f32 v7, v7, v77, v78
  v_max3_f32 v7, v7, v79, v80
  v_max3_f32 v7, v7, v81, v82
  v_max3_f32 v7, v7, v83, v84
  v_max3_f32 v7, v7, v85, v86
  v_max_f32 v7, v7, v87
  v_mov_b32 v8, v7
  s_nop 1
  v_permlane32_swap_b32 v8, v7
  s_nop 1
  v_max_f32 v7, v7, v8
  v_sub_f32 v72, 0, v7
  v_sub_f32 v73, 0, v7
  v_sub_f32 v74, 0, v7
  v_sub_f32 v75, 0, v7
  v_sub_f32 v76, 0, v7
  v_sub_f32 v77, 0, v7
  v_sub_f32 v78, 0, v7
  v_sub_f32 v79, 0, v7
  v_sub_f32 v80, 0, v7
  v_sub_f32 v81, 0, v7
  v_sub_f32 v82, 0, v7
  v_sub_f32 v83, 0, v7
  v_sub_f32 v84, 0, v7
  v_sub_f32 v85, 0, v7
  v_sub_f32 v86, 0, v7
  v_sub_f32 v87, 0, v7
  s_waitcnt lgkmcnt(0)
  s_nop 0
  v_mfma_f32_32x32x16_bf16 v[40:55], v[20:23], v[12:15], v[72:87]
  v_max3_f32 v7, v88, v89, v90
  v_max3_f32 v7, v7, v91, v92
  v_max3_f32 v7, v7, v93, v94
  v_max3_f32 v7, v7, v95, v96
  v_max3_f32 v7, v7, v97, v98
  v_max3_f32 v7, v7, v99, v100
  v_max3_f32 v7, v7, v101, v102
  v_max_f32 v7, v7, v103
  v_mov_b32 v8, v7
  s_nop 1
  v_permlane32_swap_b32 v8, v7
  s_nop 1
  v_max_f32 v7, v7, v8
  v_sub_f32 v88, 0, v7
  v_sub_f32 v89, 0, v7
  v_sub_f32 v90, 0, v7
  v_sub_f32 v91, 0, v7
  v_sub_f32 v92, 0, v7
  v_sub_f32 v93, 0, v7
  v_sub_f32 v94, 0, v7
  v_sub_f32 v95, 0, v7
  v_sub_f32 v96, 0, v7
  v_sub_f32 v97, 0, v7
  v_sub_f32 v98, 0, v7
  v_sub_f32 v99, 0, v7
  v_sub_f32 v100, 0, v7
  v_sub_f32 v101, 0, v7
  v_sub_f32 v102, 0, v7
  v_sub_f32 v103, 0, v7
  .p2align 3
  v_exp_f32 v40, v40
  v_exp_f32 v41, v41
  v_smfmac_f32_32x32x32_bf16 v[120:135], v[36:39], v[64:71], v6
  v_exp_f32 v42, v42
  v_exp_f32 v43, v43
  v_exp_f32 v44, v44
  v_exp_f32 v45, v45
  v_mfma_f32_32x32x16_bf16 v[56:71], v[20:23], v[16:19], v[88:103]
  v_exp_f32 v46, v46
  v_exp_f32 v47, v47
  v_exp_f32 v48, v48
  s_waitcnt lgkmcnt(0)
  v_exp_f32_e64 v49, v49
  v_smfmac_f32_32x32x32_bf16 v[104:119], v[28:31], v[40:47], v6
  v_exp_f32 v50, v50
  v_exp_f32 v51, v51
  v_exp_f32 v52, v52
  v_exp_f32 v53, v53
  v_exp_f32 v54, v54
  v_exp_f32 v55, v55
  v_exp_f32 v56, v56
  v_exp_f32 v57, v57
  v_smfmac_f32_32x32x32_bf16 v[104:119], v[32:35], v[48:55], v6
  v_exp_f32 v58, v58
  v_exp_f32 v59, v59
  v_exp_f32 v60, v60
  v_exp_f32 v61, v61
  v_mfma_f32_32x32x16_bf16 v[40:55], v[24:27], v[12:15], v[72:87]
  v_exp_f32 v62, v62
  v_exp_f32 v63, v63
  v_exp_f32 v64, v64
  v_exp_f32 v65, v65
  v_smfmac_f32_32x32x32_bf16 v[120:135], v[28:31], v[56:63], v6
  ds_read_b128 v[28:31], v4 offset:2048
  ds_read_b128 v[36:39], v4 offset:2560
  ds_read_b128 v[20:23], v3 offset:4096
  v_exp_f32 v66, v66
  v_exp_f32 v67, v67
  v_exp_f32 v68, v68
  v_exp_f32 v69, v69
  v_exp_f32 v70, v70
  v_exp_f32 v71, v71
  v_exp_f32 v40, v40
  v_exp_f32 v41, v41
  v_smfmac_f32_32x32x32_bf16 v[120:135], v[32:35], v[64:71], v6
  v_exp_f32 v42, v42
  v_exp_f32 v43, v43
  v_exp_f32 v44, v44
  v_exp_f32 v45, v45
  v_mfma_f32_32x32x16_bf16 v[56:71], v[24:27], v[16:19], v[88:103]
  v_exp_f32 v46, v46
  v_exp_f32 v47, v47
  v_exp_f32 v48, v48
  s_waitcnt lgkmcnt(0)
  v_exp_f32_e64 v49, v49
  v_smfmac_f32_32x32x32_bf16 v[104:119], v[28:31], v[40:47], v6
  v_exp_f32 v50, v50
  v_exp_f32 v51, v51
  v_exp_f32 v52, v52
  v_exp_f32 v53, v53
  v_exp_f32 v54, v54
  v_exp_f32 v55, v55
  v_exp_f32 v56, v56
  v_exp_f32 v57, v57
  v_smfmac_f32_32x32x32_bf16 v[104:119], v[36:39], v[48:55], v6
  v_exp_f32 v58, v58
  v_exp_f32 v59, v59
  v_exp_f32 v60, v60
  v_exp_f32 v61, v61
  v_mfma_f32_32x32x16_bf16 v[40:55], v[20:23], v[12:15], v[72:87]
  v_exp_f32 v62, v62
  v_exp_f32 v63, v63
  v_exp_f32 v64, v64
  v_exp_f32 v65, v65
  v_smfmac_f32_32x32x32_bf16 v[120:135], v[28:31], v[56:63], v6
  ds_read_b128 v[28:31], v4 offset:4096
  ds_read_b128 v[32:35], v4 offset:4608
  ds_read_b128 v[24:27], v3 offset:6144
  v_exp_f32 v66, v66
  v_exp_f32 v67, v67
  v_exp_f32 v68, v68
  v_exp_f32 v69, v69
  v_exp_f32 v70, v70
  v_exp_f32 v71, v71
  s_barrier
  .p2align 3
  v_exp_f32 v40, v40
  v_exp_f32 v41, v41
  v_smfmac_f32_32x32x32_bf16 v[120:135], v[36:39], v[64:71], v6
  v_exp_f32 v42, v42
  v_exp_f32 v43, v43
  v_exp_f32 v44, v44
  v_exp_f32 v45, v45
  v_mfma_f32_32x32x16_bf16 v[56:71], v[20:23], v[16:19], v[88:103]
  v_exp_f32 v46, v46
  v_exp_f32 v47, v47
  v_exp_f32 v48, v48
  s_waitcnt lgkmcnt(0)
  v_exp_f32_e64 v49, v49
  v_smfmac_f32_32x32x32_bf16 v[104:119], v[28:31], v[40:47], v6
  v_exp_f32 v50, v50
  v_exp_f32 v51, v51
  v_exp_f32 v52, v52
  v_exp_f32 v53, v53
  v_exp_f32 v54, v54
  v_exp_f32 v55, v55
  v_exp_f32 v56, v56
  v_exp_f32 v57, v57
  v_smfmac_f32_32x32x32_bf16 v[104:119], v[32:35], v[48:55], v6
  v_exp_f32 v58, v58
  v_exp_f32 v59, v59
  v_exp_f32 v60, v60
  v_exp_f32 v61, v61
  v_mfma_f32_32x32x16_bf16 v[40:55], v[24:27], v[12:15], v[72:87]
  v_exp_f32 v62, v62
  v_exp_f32 v63, v63
  v_exp_f32 v64, v64
  v_exp_f32 v65, v65
  v_smfmac_f32_32x32x32_bf16 v[120:135], v[28:31], v[56:63], v6
  ds_read_b128 v[28:31], v4 offset:6144
  ds_read_b128 v[36:39], v4 offset:6656
  ds_read_b128 v[20:23], v3 offset:8192
  v_exp_f32 v66, v66
  v_exp_f32 v67, v67
  v_exp_f32 v68, v68
  v_exp_f32 v69, v69
  v_exp_f32 v70, v70
  v_exp_f32 v71, v71
  v_exp_f32 v40, v40
  v_exp_f32 v41, v41
  v_smfmac_f32_32x32x32_bf16 v[120:135], v[32:35], v[64:71], v6
  v_exp_f32 v42, v42
  v_exp_f32 v43, v43
  v_exp_f32 v44, v44
  v_exp_f32 v45, v45
  v_mfma_f32_32x32x16_bf16 v[56:71], v[24:27], v[16:19], v[88:103]
  v_exp_f32 v46, v46
  v_exp_f32 v47, v47
  v_exp_f32 v48, v48
  s_waitcnt lgkmcnt(0)
  v_exp_f32_e64 v49, v49
  v_smfmac_f32_32x32x32_bf16 v[104:119], v[28:31], v[40:47], v6
  v_exp_f32 v50, v50
  v_exp_f32 v51, v51
  v_exp_f32 v52, v52
  v_exp_f32 v53, v53
  v_exp_f32 v54, v54
  v_exp_f32 v55, v55
  v_exp_f32 v56, v56
  v_exp_f32 v57, v57
  v_smfmac_f32_32x32x32_bf16 v[104:119], v[36:39], v[48:55], v6
  v_exp_f32 v58, v58
  v_exp_f32 v59, v59
  v_exp_f32 v60, v60
  v_exp_f32 v61, v61
  v_mfma_f32_32x32x16_bf16 v[40:55], v[20:23], v[12:15], v[72:87]
  v_exp_f32 v62, v62
  v_exp_f32 v63, v63
  v_exp_f32 v64, v64
  v_exp_f32 v65, v65
  v_smfmac_f32_32x32x32_bf16 v[120:135], v[28:31], v[56:63], v6
  ds_read_b128 v[28:31], v4 offset:8192
  ds_read_b128 v[32:35], v4 offset:8704
  ds_read_b128 v[24:27], v3 offset:10240
  v_exp_f32 v66, v66
  v_exp_f32 v67, v67
  v_add_u32_e64 v4, v5, v4
  v_exp_f32 v68, v68
  v_exp_f32 v69, v69
  v_exp_f32 v70, v70
  v_exp_f32 v71, v71
  v_exp_f32 v40, v40
  v_exp_f32 v41, v41
  v_smfmac_f32_32x32x32_bf16 v[120:135], v[36:39], v[64:71], v6
  v_exp_f32 v42, v42
  v_exp_f32 v43, v43
  v_exp_f32 v44, v44
  v_exp_f32 v45, v45
  v_mfma_f32_32x32x16_bf16 v[56:71], v[20:23], v[16:19], v[88:103]
  v_exp_f32 v46, v46
  v_exp_f32 v47, v47
  v_exp_f32 v48, v48
  s_waitcnt lgkmcnt(0)
  v_exp_f32_e64 v49, v49
  v_smfmac_f32_32x32x32_bf16 v[104:119], v[28:31], v[40:47], v6
  v_exp_f32 v50, v50
  v_exp_f32 v51, v51
  v_exp_f32 v52, v52
  v_exp_f32 v53, v53
  v_exp_f32 v54, v54
  v_exp_f32 v55, v55
  v_exp_f32 v56, v56
  v_exp_f32 v57, v57
  v_smfmac_f32_32x32x32_bf16 v[104:119], v[32:35], v[48:55], v6
  v_exp_f32 v58, v58
  v_exp_f32 v59, v59
  v_exp_f32 v60, v60
  v_exp_f32 v61, v61
  v_mfma_f32_32x32x16_bf16 v[40:55], v[24:27], v[12:15], v[72:87]
  v_exp_f32 v62, v62
  v_exp_f32 v63, v63
  v_exp_f32 v64, v64
  v_exp_f32 v65, v65
  v_smfmac_f32_32x32x32_bf16 v[120:135], v[28:31], v[56:63], v6
  ds_read_b128 v[28:31], v4 offset:2048
  ds_read_b128 v[36:39], v4 offset:2560
  ds_read_b128 v[20:23], v3 offset:12288
  v_exp_f32 v66, v66
  v_exp_f32 v67, v67
  v_exp_f32 v68, v68
  v_exp_f32 v69, v69
  v_exp_f32 v70, v70
  v_exp_f32 v71, v71
  v_exp_f32 v40, v40
  v_exp_f32 v41, v41
  v_smfmac_f32_32x32x32_bf16 v[120:135], v[32:35], v[64:71], v6
  v_exp_f32 v42, v42
  v_exp_f32 v43, v43
  v_exp_f32 v44, v44
  v_exp_f32 v45, v45
  v_mfma_f32_32x32x16_bf16 v[56:71], v[24:27], v[16:19], v[88:103]
  v_exp_f32 v46, v46
  v_exp_f32 v47, v47
  v_exp_f32 v48, v48
  s_waitcnt lgkmcnt(0)
  v_exp_f32_e64 v49, v49
  v_smfmac_f32_32x32x32_bf16 v[104:119], v[28:31], v[40:47], v6
  v_exp_f32 v50, v50
  v_exp_f32 v51, v51
  v_exp_f32 v52, v52
  v_exp_f32 v53, v53
  v_exp_f32 v54, v54
  v_exp_f32 v55, v55
  v_exp_f32 v56, v56
  v_exp_f32 v57, v57
  v_smfmac_f32_32x32x32_bf16 v[104:119], v[36:39], v[48:55], v6
  v_exp_f32 v58, v58
  v_exp_f32 v59, v59
  v_exp_f32 v60, v60
  v_exp_f32 v61, v61
  v_mfma_f32_32x32x16_bf16 v[40:55], v[20:23], v[12:15], v[72:87]
  v_exp_f32 v62, v62
  v_exp_f32 v63, v63
  v_exp_f32 v64, v64
  v_exp_f32 v65, v65
  v_smfmac_f32_32x32x32_bf16 v[120:135], v[28:31], v[56:63], v6
  ds_read_b128 v[28:31], v4 offset:4096
  ds_read_b128 v[32:35], v4 offset:4608
  ds_read_b128 v[24:27], v3 offset:14336
  v_exp_f32 v66, v66
  v_exp_f32 v67, v67
  v_exp_f32 v68, v68
  v_exp_f32 v69, v69
  v_exp_f32 v70, v70
  v_exp_f32 v71, v71
  v_exp_f32 v40, v40
  v_exp_f32 v41, v41
  v_smfmac_f32_32x32x32_bf16 v[120:135], v[36:39], v[64:71], v6
  v_exp_f32 v42, v42
  v_exp_f32 v43, v43
  v_exp_f32 v44, v44
  v_exp_f32 v45, v45
  v_mfma_f32_32x32x16_bf16 v[56:71], v[20:23], v[16:19], v[88:103]
  v_exp_f32 v46, v46
  v_exp_f32 v47, v47
  v_exp_f32 v48, v48
  s_waitcnt lgkmcnt(0)
  v_exp_f32_e64 v49, v49
  v_smfmac_f32_32x32x32_bf16 v[104:119], v[28:31], v[40:47], v6
  v_exp_f32 v50, v50
  v_exp_f32 v51, v51
  v_exp_f32 v52, v52
  v_exp_f32 v53, v53
  v_exp_f32 v54, v54
  v_exp_f32 v55, v55
  v_exp_f32 v56, v56
  v_exp_f32 v57, v57
  v_smfmac_f32_32x32x32_bf16 v[104:119], v[32:35], v[48:55], v6
  v_exp_f32 v58, v58
  v_exp_f32 v59, v59
  v_exp_f32 v60, v60
  v_exp_f32 v61, v61
  v_mfma_f32_32x32x16_bf16 v[40:55], v[24:27], v[12:15], v[72:87]
  v_exp_f32 v62, v62
  v_exp_f32 v63, v63
  v_exp_f32 v64, v64
  v_exp_f32 v65, v65
  v_smfmac_f32_32x32x32_bf16 v[120:135], v[28:31], v[56:63], v6
  ds_read_b128 v[28:31], v4 offset:6144
  ds_read_b128 v[36:39], v4 offset:6656
  ds_read_b128 v[20:23], v3 offset:16384
  v_exp_f32 v66, v66
  v_exp_f32 v67, v67
  v_exp_f32 v68, v68
  v_exp_f32 v69, v69
  v_exp_f32 v70, v70
  v_exp_f32 v71, v71
  v_exp_f32 v40, v40
  v_exp_f32 v41, v41
  v_smfmac_f32_32x32x32_bf16 v[120:135], v[32:35], v[64:71], v6
  v_exp_f32 v42, v42
  v_exp_f32 v43, v43
  v_exp_f32 v44, v44
  v_exp_f32 v45, v45
  v_mfma_f32_32x32x16_bf16 v[56:71], v[24:27], v[16:19], v[88:103]
  v_exp_f32 v46, v46
  v_exp_f32 v47, v47
  v_exp_f32 v48, v48
  s_waitcnt lgkmcnt(0)
  v_exp_f32_e64 v49, v49
  v_smfmac_f32_32x32x32_bf16 v[104:119], v[28:31], v[40:47], v6
  v_exp_f32 v50, v50
  v_exp_f32 v51, v51
  v_exp_f32 v52, v52
  v_exp_f32 v53, v53
  v_exp_f32 v54, v54
  v_exp_f32 v55, v55
  v_exp_f32 v56, v56
  v_exp_f32 v57, v57
  v_smfmac_f32_32x32x32_bf16 v[104:119], v[36:39], v[48:55], v6
  v_exp_f32 v58, v58
  v_exp_f32 v59, v59
  v_exp_f32 v60, v60
  v_exp_f32 v61, v61
  v_mfma_f32_32x32x16_bf16 v[40:55], v[20:23], v[12:15], v[72:87]
  v_exp_f32 v62, v62
  v_exp_f32 v63, v63
  v_exp_f32 v64, v64
  v_exp_f32 v65, v65
  v_smfmac_f32_32x32x32_bf16 v[120:135], v[28:31], v[56:63], v6
  ds_read_b128 v[28:31], v4 offset:8192
  ds_read_b128 v[32:35], v4 offset:8704
  ds_read_b128 v[24:27], v3 offset:18432
  v_exp_f32 v66, v66
  v_exp_f32 v67, v67
  v_add_u32_e64 v4, v5, v4
  v_exp_f32 v68, v68
  v_exp_f32 v69, v69
  v_exp_f32 v70, v70
  v_exp_f32 v71, v71
  s_barrier
  .p2align 3
  v_exp_f32 v40, v40
  v_exp_f32 v41, v41
  v_smfmac_f32_32x32x32_bf16 v[120:135], v[36:39], v[64:71], v6
  v_exp_f32 v42, v42
  v_exp_f32 v43, v43
  v_exp_f32 v44, v44
  v_exp_f32 v45, v45
  v_mfma_f32_32x32x16_bf16 v[56:71], v[20:23], v[16:19], v[88:103]
  v_exp_f32 v46, v46
  v_exp_f32 v47, v47
  v_exp_f32 v48, v48
  s_waitcnt lgkmcnt(0)
  v_exp_f32_e64 v49, v49
  v_smfmac_f32_32x32x32_bf16 v[104:119], v[28:31], v[40:47], v6
  v_exp_f32 v50, v50
  v_exp_f32 v51, v51
  v_exp_f32 v52, v52
  v_exp_f32 v53, v53
  v_exp_f32 v54, v54
  v_exp_f32 v55, v55
  v_exp_f32 v56, v56
  v_exp_f32 v57, v57
  v_smfmac_f32_32x32x32_bf16 v[104:119], v[32:35], v[48:55], v6
  v_exp_f32 v58, v58
  v_exp_f32 v59, v59
  v_exp_f32 v60, v60
  v_exp_f32 v61, v61
  v_mfma_f32_32x32x16_bf16 v[40:55], v[24:27], v[12:15], v[72:87]
  v_exp_f32 v62, v62
  v_exp_f32 v63, v63
  v_exp_f32 v64, v64
  v_exp_f32 v65, v65
  v_smfmac_f32_32x32x32_bf16 v[120:135], v[28:31], v[56:63], v6
  ds_read_b128 v[28:31], v4 offset:2048
  ds_read_b128 v[36:39], v4 offset:2560
  ds_read_b128 v[20:23], v3 offset:20480
  v_exp_f32 v66, v66
  v_exp_f32 v67, v67
  v_exp_f32 v68, v68
  v_exp_f32 v69, v69
  v_exp_f32 v70, v70
  v_exp_f32 v71, v71
  v_exp_f32 v40, v40
  v_exp_f32 v41, v41
  v_smfmac_f32_32x32x32_bf16 v[120:135], v[32:35], v[64:71], v6
  v_exp_f32 v42, v42
  v_exp_f32 v43, v43
  v_exp_f32 v44, v44
  v_exp_f32 v45, v45
  v_mfma_f32_32x32x16_bf16 v[56:71], v[24:27], v[16:19], v[88:103]
  v_exp_f32 v46, v46
  v_exp_f32 v47, v47
  v_exp_f32 v48, v48
  s_waitcnt lgkmcnt(0)
  v_exp_f32_e64 v49, v49
  v_smfmac_f32_32x32x32_bf16 v[104:119], v[28:31], v[40:47], v6
  v_exp_f32 v50, v50
  v_exp_f32 v51, v51
  v_exp_f32 v52, v52
  v_exp_f32 v53, v53
  v_exp_f32 v54, v54
  v_exp_f32 v55, v55
  v_exp_f32 v56, v56
  v_exp_f32 v57, v57
  v_smfmac_f32_32x32x32_bf16 v[104:119], v[36:39], v[48:55], v6
  v_exp_f32 v58, v58
  v_exp_f32 v59, v59
  v_exp_f32 v60, v60
  v_exp_f32 v61, v61
  v_mfma_f32_32x32x16_bf16 v[40:55], v[20:23], v[12:15], v[72:87]
  v_exp_f32 v62, v62
  v_exp_f32 v63, v63
  v_exp_f32 v64, v64
  v_exp_f32 v65, v65
  v_smfmac_f32_32x32x32_bf16 v[120:135], v[28:31], v[56:63], v6
  ds_read_b128 v[28:31], v4 offset:4096
  ds_read_b128 v[32:35], v4 offset:4608
  ds_read_b128 v[24:27], v3 offset:22528
  v_exp_f32 v66, v66
  v_exp_f32 v67, v67
  v_exp_f32 v68, v68
  v_exp_f32 v69, v69
  v_exp_f32 v70, v70
  v_exp_f32 v71, v71
  v_exp_f32 v40, v40
  v_exp_f32 v41, v41
  v_smfmac_f32_32x32x32_bf16 v[120:135], v[36:39], v[64:71], v6
  v_exp_f32 v42, v42
  v_exp_f32 v43, v43
  v_exp_f32 v44, v44
  v_exp_f32 v45, v45
  v_mfma_f32_32x32x16_bf16 v[56:71], v[20:23], v[16:19], v[88:103]
  v_exp_f32 v46, v46
  v_exp_f32 v47, v47
  v_exp_f32 v48, v48
  s_waitcnt lgkmcnt(0)
  v_exp_f32_e64 v49, v49
  v_smfmac_f32_32x32x32_bf16 v[104:119], v[28:31], v[40:47], v6
  v_exp_f32 v50, v50
  v_exp_f32 v51, v51
  v_exp_f32 v52, v52
  v_exp_f32 v53, v53
  v_exp_f32 v54, v54
  v_exp_f32 v55, v55
  v_exp_f32 v56, v56
  v_exp_f32 v57, v57
  v_smfmac_f32_32x32x32_bf16 v[104:119], v[32:35], v[48:55], v6
  v_exp_f32 v58, v58
  v_exp_f32 v59, v59
  v_exp_f32 v60, v60
  v_exp_f32 v61, v61
  v_mfma_f32_32x32x16_bf16 v[40:55], v[24:27], v[12:15], v[72:87]
  v_exp_f32 v62, v62
  v_exp_f32 v63, v63
  v_exp_f32 v64, v64
  v_exp_f32 v65, v65
  v_smfmac_f32_32x32x32_bf16 v[120:135], v[28:31], v[56:63], v6
  ds_read_b128 v[28:31], v4 offset:6144
  ds_read_b128 v[36:39], v4 offset:6656
  ds_read_b128 v[20:23], v3 offset:24576
  v_exp_f32 v66, v66
  v_exp_f32 v67, v67
  v_exp_f32 v68, v68
  v_exp_f32 v69, v69
  v_exp_f32 v70, v70
  v_exp_f32 v71, v71
  v_exp_f32 v40, v40
  v_exp_f32 v41, v41
  v_smfmac_f32_32x32x32_bf16 v[120:135], v[32:35], v[64:71], v6
  v_exp_f32 v42, v42
  v_exp_f32 v43, v43
  v_exp_f32 v44, v44
  v_exp_f32 v45, v45
  v_mfma_f32_32x32x16_bf16 v[56:71], v[24:27], v[16:19], v[88:103]
  v_exp_f32 v46, v46
  v_exp_f32 v47, v47
  v_exp_f32 v48, v48
  s_waitcnt lgkmcnt(0)
  v_exp_f32_e64 v49, v49
  v_smfmac_f32_32x32x32_bf16 v[104:119], v[28:31], v[40:47], v6
  v_exp_f32 v50, v50
  v_exp_f32 v51, v51
  v_exp_f32 v52, v52
  v_exp_f32 v53, v53
  v_exp_f32 v54, v54
  v_exp_f32 v55, v55
  v_exp_f32 v56, v56
  v_exp_f32 v57, v57
  v_smfmac_f32_32x32x32_bf16 v[104:119], v[36:39], v[48:55], v6
  v_exp_f32 v58, v58
  v_exp_f32 v59, v59
  v_exp_f32 v60, v60
  v_exp_f32 v61, v61
  v_mfma_f32_32x32x16_bf16 v[40:55], v[20:23], v[12:15], v[72:87]
  v_exp_f32 v62, v62
  v_exp_f32 v63, v63
  v_exp_f32 v64, v64
  v_exp_f32 v65, v65
  v_smfmac_f32_32x32x32_bf16 v[120:135], v[28:31], v[56:63], v6
  ds_read_b128 v[28:31], v4 offset:8192
  ds_read_b128 v[32:35], v4 offset:8704
  ds_read_b128 v[24:27], v3 offset:26624
  v_exp_f32 v66, v66
  v_exp_f32 v67, v67
  v_add_u32_e64 v4, v5, v4
  v_exp_f32 v68, v68
  v_exp_f32 v69, v69
  v_exp_f32 v70, v70
  v_exp_f32 v71, v71
  v_exp_f32 v40, v40
  v_exp_f32 v41, v41
  v_smfmac_f32_32x32x32_bf16 v[120:135], v[36:39], v[64:71], v6
  v_exp_f32 v42, v42
  v_exp_f32 v43, v43
  v_exp_f32 v44, v44
  v_exp_f32 v45, v45
  v_mfma_f32_32x32x16_bf16 v[56:71], v[20:23], v[16:19], v[88:103]
  v_exp_f32 v46, v46
  v_exp_f32 v47, v47
  v_exp_f32 v48, v48
  s_waitcnt lgkmcnt(0)
  v_exp_f32_e64 v49, v49
  v_smfmac_f32_32x32x32_bf16 v[104:119], v[28:31], v[40:47], v6
  v_exp_f32 v50, v50
  v_exp_f32 v51, v51
  v_exp_f32 v52, v52
  v_exp_f32 v53, v53
  v_exp_f32 v54, v54
  v_exp_f32 v55, v55
  v_exp_f32 v56, v56
  v_exp_f32 v57, v57
  v_smfmac_f32_32x32x32_bf16 v[104:119], v[32:35], v[48:55], v6
  v_exp_f32 v58, v58
  v_exp_f32 v59, v59
  v_exp_f32 v60, v60
  v_exp_f32 v61, v61
  v_mfma_f32_32x32x16_bf16 v[40:55], v[24:27], v[12:15], v[72:87]
  v_exp_f32 v62, v62
  v_exp_f32 v63, v63
  v_exp_f32 v64, v64
  v_exp_f32 v65, v65
  v_smfmac_f32_32x32x32_bf16 v[120:135], v[28:31], v[56:63], v6
  ds_read_b128 v[28:31], v4 offset:2048
  ds_read_b128 v[36:39], v4 offset:2560
  ds_read_b128 v[20:23], v3 offset:28672
  v_exp_f32 v66, v66
  v_exp_f32 v67, v67
  v_exp_f32 v68, v68
  v_exp_f32 v69, v69
  v_exp_f32 v70, v70
  v_exp_f32 v71, v71
  v_exp_f32 v40, v40
  v_exp_f32 v41, v41
  v_smfmac_f32_32x32x32_bf16 v[120:135], v[32:35], v[64:71], v6
  v_exp_f32 v42, v42
  v_exp_f32 v43, v43
  v_exp_f32 v44, v44
  v_exp_f32 v45, v45
  v_mfma_f32_32x32x16_bf16 v[56:71], v[24:27], v[16:19], v[88:103]
  v_exp_f32 v46, v46
  v_exp_f32 v47, v47
  v_exp_f32 v48, v48
  s_waitcnt lgkmcnt(0)
  v_exp_f32_e64 v49, v49
  v_smfmac_f32_32x32x32_bf16 v[104:119], v[28:31], v[40:47], v6
  v_exp_f32 v50, v50
  v_exp_f32 v51, v51
  v_exp_f32 v52, v52
  v_exp_f32 v53, v53
  v_exp_f32 v54, v54
  v_exp_f32 v55, v55
  v_exp_f32 v56, v56
  v_exp_f32 v57, v57
  v_smfmac_f32_32x32x32_bf16 v[104:119], v[36:39], v[48:55], v6
  v_exp_f32 v58, v58
  v_exp_f32 v59, v59
  v_exp_f32 v60, v60
  v_exp_f32 v61, v61
  v_mfma_f32_32x32x16_bf16 v[40:55], v[20:23], v[12:15], v[72:87]
  v_exp_f32 v62, v62
  v_exp_f32 v63, v63
  v_exp_f32 v64, v64
  v_exp_f32 v65, v65
  v_smfmac_f32_32x32x32_bf16 v[120:135], v[28:31], v[56:63], v6
  ds_read_b128 v[28:31], v4 offset:4096
  ds_read_b128 v[32:35], v4 offset:4608
  ds_read_b128 v[24:27], v3 offset:30720
  v_exp_f32 v66, v66
  v_exp_f32 v67, v67
  v_exp_f32 v68, v68
  v_exp_f32 v69, v69
  v_exp_f32 v70, v70
  v_exp_f32 v71, v71
  v_exp_f32 v40, v40
  v_exp_f32 v41, v41
  v_smfmac_f32_32x32x32_bf16 v[120:135], v[36:39], v[64:71], v6
  v_exp_f32 v42, v42
  v_exp_f32 v43, v43
  v_exp_f32 v44, v44
  v_exp_f32 v45, v45
  v_mfma_f32_32x32x16_bf16 v[56:71], v[20:23], v[16:19], v[88:103]
  v_exp_f32 v46, v46
  v_exp_f32 v47, v47
  v_exp_f32 v48, v48
  s_waitcnt lgkmcnt(0)
  v_exp_f32_e64 v49, v49
  v_smfmac_f32_32x32x32_bf16 v[104:119], v[28:31], v[40:47], v6
  v_exp_f32 v50, v50
  v_exp_f32 v51, v51
  v_exp_f32 v52, v52
  v_exp_f32 v53, v53
  v_exp_f32 v54, v54
  v_exp_f32 v55, v55
  v_exp_f32 v56, v56
  v_exp_f32 v57, v57
  v_smfmac_f32_32x32x32_bf16 v[104:119], v[32:35], v[48:55], v6
  v_exp_f32 v58, v58
  v_exp_f32 v59, v59
  v_exp_f32 v60, v60
  v_exp_f32 v61, v61
  v_mfma_f32_32x32x16_bf16 v[40:55], v[24:27], v[12:15], v[72:87]
  v_exp_f32 v62, v62
  v_exp_f32 v63, v63
  v_exp_f32 v64, v64
  v_exp_f32 v65, v65
  v_smfmac_f32_32x32x32_bf16 v[120:135], v[28:31], v[56:63], v6
  ds_read_b128 v[28:31], v4 offset:6144
  ds_read_b128 v[36:39], v4 offset:6656
  ds_read_b128 v[20:23], v3 offset:32768
  v_exp_f32 v66, v66
  v_exp_f32 v67, v67
  v_exp_f32 v68, v68
  v_exp_f32 v69, v69
  v_exp_f32 v70, v70
  v_exp_f32 v71, v71
  v_exp_f32 v40, v40
  v_exp_f32 v41, v41
  v_smfmac_f32_32x32x32_bf16 v[120:135], v[32:35], v[64:71], v6
  v_exp_f32 v42, v42
  v_exp_f32 v43, v43
  v_exp_f32 v44, v44
  v_exp_f32 v45, v45
  v_mfma_f32_32x32x16_bf16 v[56:71], v[24:27], v[16:19], v[88:103]
  v_exp_f32 v46, v46
  v_exp_f32 v47, v47
  v_exp_f32 v48, v48
  s_waitcnt lgkmcnt(0)
  v_exp_f32_e64 v49, v49
  v_smfmac_f32_32x32x32_bf16 v[104:119], v[28:31], v[40:47], v6
  v_exp_f32 v50, v50
  v_exp_f32 v51, v51
  v_exp_f32 v52, v52
  v_exp_f32 v53, v53
  v_exp_f32 v54, v54
  v_exp_f32 v55, v55
  v_exp_f32 v56, v56
  v_exp_f32 v57, v57
  v_smfmac_f32_32x32x32_bf16 v[104:119], v[36:39], v[48:55], v6
  v_exp_f32 v58, v58
  v_exp_f32 v59, v59
  v_exp_f32 v60, v60
  v_exp_f32 v61, v61
  v_mfma_f32_32x32x16_bf16 v[40:55], v[20:23], v[12:15], v[72:87]
  v_exp_f32 v62, v62
  v_exp_f32 v63, v63
  v_exp_f32 v64, v64
  v_exp_f32 v65, v65
  v_smfmac_f32_32x32x32_bf16 v[120:135], v[28:31], v[56:63], v6
  ds_read_b128 v[28:31], v4 offset:8192
  ds_read_b128 v[32:35], v4 offset:8704
  ds_read_b128 v[24:27], v3 offset:34816
  v_exp_f32 v66, v66
  v_exp_f32 v67, v67
  v_add_u32_e64 v4, v5, v4
  v_exp_f32 v68, v68
  v_exp_f32 v69, v69
  v_exp_f32 v70, v70
  v_exp_f32 v71, v71
  v_exp_f32 v40, v40
  v_exp_f32 v41, v41
  v_smfmac_f32_32x32x32_bf16 v[120:135], v[36:39], v[64:71], v6
  v_exp_f32 v42, v42
  v_exp_f32 v43, v43
  v_exp_f32 v44, v44
  v_exp_f32 v45, v45
  v_mfma_f32_32x32x16_bf16 v[56:71], v[20:23], v[16:19], v[88:103]
  v_exp_f32 v46, v46
  v_exp_f32 v47, v47
  v_exp_f32 v48, v48
  s_waitcnt lgkmcnt(0)
  v_exp_f32_e64 v49, v49
  v_smfmac_f32_32x32x32_bf16 v[104:119], v[28:31], v[40:47], v6
  v_exp_f32 v50, v50
  v_exp_f32 v51, v51
  v_exp_f32 v52, v52
  v_exp_f32 v53, v53
  v_exp_f32 v54, v54
  v_exp_f32 v55, v55
  v_exp_f32 v56, v56
  v_exp_f32 v57, v57
  v_smfmac_f32_32x32x32_bf16 v[104:119], v[32:35], v[48:55], v6
  v_exp_f32 v58, v58
  v_exp_f32 v59, v59
  v_exp_f32 v60, v60
  v_exp_f32 v61, v61
  v_mfma_f32_32x32x16_bf16 v[40:55], v[24:27], v[12:15], v[72:87]
  v_exp_f32 v62, v62
  v_exp_f32 v63, v63
  v_exp_f32 v64, v64
  v_exp_f32 v65, v65
  v_smfmac_f32_32x32x32_bf16 v[120:135], v[28:31], v[56:63], v6
  ds_read_b128 v[28:31], v4 offset:2048
  ds_read_b128 v[36:39], v4 offset:2560
  ds_read_b128 v[20:23], v3 offset:36864
  v_exp_f32 v66, v66
  v_exp_f32 v67, v67
  v_exp_f32 v68, v68
  v_exp_f32 v69, v69
  v_exp_f32 v70, v70
  v_exp_f32 v71, v71
  v_exp_f32 v40, v40
  v_exp_f32 v41, v41
  v_smfmac_f32_32x32x32_bf16 v[120:135], v[32:35], v[64:71], v6
  v_exp_f32 v42, v42
  v_exp_f32 v43, v43
  v_exp_f32 v44, v44
  v_exp_f32 v45, v45
  v_mfma_f32_32x32x16_bf16 v[56:71], v[24:27], v[16:19], v[88:103]
  v_exp_f32 v46, v46
  v_exp_f32 v47, v47
  v_exp_f32 v48, v48
  s_waitcnt lgkmcnt(0)
  v_exp_f32_e64 v49, v49
  v_smfmac_f32_32x32x32_bf16 v[104:119], v[28:31], v[40:47], v6
  v_exp_f32 v50, v50
  v_exp_f32 v51, v51
  v_exp_f32 v52, v52
  v_exp_f32 v53, v53
  v_exp_f32 v54, v54
  v_exp_f32 v55, v55
  v_exp_f32 v56, v56
  v_exp_f32 v57, v57
  v_smfmac_f32_32x32x32_bf16 v[104:119], v[36:39], v[48:55], v6
  v_exp_f32 v58, v58
  v_exp_f32 v59, v59
  v_exp_f32 v60, v60
  v_exp_f32 v61, v61
  v_mfma_f32_32x32x16_bf16 v[40:55], v[20:23], v[12:15], v[72:87]
  v_exp_f32 v62, v62
  v_exp_f32 v63, v63
  v_exp_f32 v64, v64
  v_exp_f32 v65, v65
  v_smfmac_f32_32x32x32_bf16 v[120:135], v[28:31], v[56:63], v6
  ds_read_b128 v[28:31], v4 offset:4096
  ds_read_b128 v[32:35], v4 offset:4608
  ds_read_b128 v[24:27], v3 offset:38912
  v_exp_f32 v66, v66
  v_exp_f32 v67, v67
  v_exp_f32 v68, v68
  v_exp_f32 v69, v69
  v_exp_f32 v70, v70
  v_exp_f32 v71, v71
  v_exp_f32 v40, v40
  v_exp_f32 v41, v41
  v_smfmac_f32_32x32x32_bf16 v[120:135], v[36:39], v[64:71], v6
  v_exp_f32 v42, v42
  v_exp_f32 v43, v43
  v_exp_f32 v44, v44
  v_exp_f32 v45, v45
  v_mfma_f32_32x32x16_bf16 v[56:71], v[20:23], v[16:19], v[88:103]
  v_exp_f32 v46, v46
  v_exp_f32 v47, v47
  v_exp_f32 v48, v48
  s_waitcnt lgkmcnt(0)
  v_exp_f32_e64 v49, v49
  v_smfmac_f32_32x32x32_bf16 v[104:119], v[28:31], v[40:47], v6
  v_exp_f32 v50, v50
  v_exp_f32 v51, v51
  v_exp_f32 v52, v52
  v_exp_f32 v53, v53
  v_exp_f32 v54, v54
  v_exp_f32 v55, v55
  v_exp_f32 v56, v56
  v_exp_f32 v57, v57
  v_smfmac_f32_32x32x32_bf16 v[104:119], v[32:35], v[48:55], v6
  v_exp_f32 v58, v58
  v_exp_f32 v59, v59
  v_exp_f32 v60, v60
  v_exp_f32 v61, v61
  v_mfma_f32_32x32x16_bf16 v[40:55], v[24:27], v[12:15], v[72:87]
  v_exp_f32 v62, v62
  v_exp_f32 v63, v63
  v_exp_f32 v64, v64
  v_exp_f32 v65, v65
  v_smfmac_f32_32x32x32_bf16 v[120:135], v[28:31], v[56:63], v6
  ds_read_b128 v[28:31], v4 offset:6144
  ds_read_b128 v[36:39], v4 offset:6656
  ds_read_b128 v[20:23], v3 offset:40960
  v_exp_f32 v66, v66
  v_exp_f32 v67, v67
  v_exp_f32 v68, v68
  v_exp_f32 v69, v69
  v_exp_f32 v70, v70
  v_exp_f32 v71, v71
  v_exp_f32 v40, v40
  v_exp_f32 v41, v41
  v_smfmac_f32_32x32x32_bf16 v[120:135], v[32:35], v[64:71], v6
  v_exp_f32 v42, v42
  v_exp_f32 v43, v43
  v_exp_f32 v44, v44
  v_exp_f32 v45, v45
  v_mfma_f32_32x32x16_bf16 v[56:71], v[24:27], v[16:19], v[88:103]
  v_exp_f32 v46, v46
  v_exp_f32 v47, v47
  v_exp_f32 v48, v48
  s_waitcnt lgkmcnt(0)
  v_exp_f32_e64 v49, v49
  v_smfmac_f32_32x32x32_bf16 v[104:119], v[28:31], v[40:47], v6
  v_exp_f32 v50, v50
  v_exp_f32 v51, v51
  v_exp_f32 v52, v52
  v_exp_f32 v53, v53
  v_exp_f32 v54, v54
  v_exp_f32 v55, v55
  v_exp_f32 v56, v56
  v_exp_f32 v57, v57
  v_smfmac_f32_32x32x32_bf16 v[104:119], v[36:39], v[48:55], v6
  v_exp_f32 v58, v58
  v_exp_f32 v59, v59
  v_exp_f32 v60, v60
  v_exp_f32 v61, v61
  v_mfma_f32_32x32x16_bf16 v[40:55], v[20:23], v[12:15], v[72:87]
  v_exp_f32 v62, v62
  v_exp_f32 v63, v63
  v_exp_f32 v64, v64
  v_exp_f32 v65, v65
  v_smfmac_f32_32x32x32_bf16 v[120:135], v[28:31], v[56:63], v6
  ds_read_b128 v[28:31], v4 offset:8192
  ds_read_b128 v[32:35], v4 offset:8704
  ds_read_b128 v[24:27], v3 offset:43008
  v_exp_f32 v66, v66
  v_exp_f32 v67, v67
  v_add_u32_e64 v4, v5, v4
  v_exp_f32 v68, v68
  v_exp_f32 v69, v69
  v_exp_f32 v70, v70
  v_exp_f32 v71, v71
  v_exp_f32 v40, v40
  v_exp_f32 v41, v41
  v_smfmac_f32_32x32x32_bf16 v[120:135], v[36:39], v[64:71], v6
  v_exp_f32 v42, v42
  v_exp_f32 v43, v43
  v_exp_f32 v44, v44
  v_exp_f32 v45, v45
  v_mfma_f32_32x32x16_bf16 v[56:71], v[20:23], v[16:19], v[88:103]
  v_exp_f32 v46, v46
  v_exp_f32 v47, v47
  v_exp_f32 v48, v48
  s_waitcnt lgkmcnt(0)
  v_exp_f32_e64 v49, v49
  v_smfmac_f32_32x32x32_bf16 v[104:119], v[28:31], v[40:47], v6
  v_exp_f32 v50, v50
  v_exp_f32 v51, v51
  v_exp_f32 v52, v52
  v_exp_f32 v53, v53
  v_exp_f32 v54, v54
  v_exp_f32 v55, v55
  v_exp_f32 v56, v56
  v_exp_f32 v57, v57
  v_smfmac_f32_32x32x32_bf16 v[104:119], v[32:35], v[48:55], v6
  v_exp_f32 v58, v58
  v_exp_f32 v59, v59
  v_exp_f32 v60, v60
  v_exp_f32 v61, v61
  v_mfma_f32_32x32x16_bf16 v[40:55], v[24:27], v[12:15], v[72:87]
  v_exp_f32 v62, v62
  v_exp_f32 v63, v63
  v_exp_f32 v64, v64
  v_exp_f32 v65, v65
  v_smfmac_f32_32x32x32_bf16 v[120:135], v[28:31], v[56:63], v6
  ds_read_b128 v[28:31], v4 offset:2048
  ds_read_b128 v[36:39], v4 offset:2560
  ds_read_b128 v[20:23], v3 offset:45056
  v_exp_f32 v66, v66
  v_exp_f32 v67, v67
  v_exp_f32 v68, v68
  v_exp_f32 v69, v69
  v_exp_f32 v70, v70
  v_exp_f32 v71, v71
  v_exp_f32 v40, v40
  v_exp_f32 v41, v41
  v_smfmac_f32_32x32x32_bf16 v[120:135], v[32:35], v[64:71], v6
  v_exp_f32 v42, v42
  v_exp_f32 v43, v43
  v_exp_f32 v44, v44
  v_exp_f32 v45, v45
  v_mfma_f32_32x32x16_bf16 v[56:71], v[24:27], v[16:19], v[88:103]
  v_exp_f32 v46, v46
  v_exp_f32 v47, v47
  v_exp_f32 v48, v48
  s_waitcnt lgkmcnt(0)
  v_exp_f32_e64 v49, v49
  v_smfmac_f32_32x32x32_bf16 v[104:119], v[28:31], v[40:47], v6
  v_exp_f32 v50, v50
  v_exp_f32 v51, v51
  v_exp_f32 v52, v52
  v_exp_f32 v53, v53
  v_exp_f32 v54, v54
  v_exp_f32 v55, v55
  v_exp_f32 v56, v56
  v_exp_f32 v57, v57
  v_smfmac_f32_32x32x32_bf16 v[104:119], v[36:39], v[48:55], v6
  v_exp_f32 v58, v58
  v_exp_f32 v59, v59
  v_exp_f32 v60, v60
  v_exp_f32 v61, v61
  v_mfma_f32_32x32x16_bf16 v[40:55], v[20:23], v[12:15], v[72:87]
  v_exp_f32 v62, v62
  v_exp_f32 v63, v63
  v_exp_f32 v64, v64
  v_exp_f32 v65, v65
  v_smfmac_f32_32x32x32_bf16 v[120:135], v[28:31], v[56:63], v6
  ds_read_b128 v[28:31], v4 offset:4096
  ds_read_b128 v[32:35], v4 offset:4608
  ds_read_b128 v[24:27], v3 offset:47104
  v_exp_f32 v66, v66
  v_exp_f32 v67, v67
  v_exp_f32 v68, v68
  v_exp_f32 v69, v69
  v_exp_f32 v70, v70
  v_exp_f32 v71, v71
  v_exp_f32 v40, v40
  v_exp_f32 v41, v41
  v_smfmac_f32_32x32x32_bf16 v[120:135], v[36:39], v[64:71], v6
  v_exp_f32 v42, v42
  v_exp_f32 v43, v43
  v_exp_f32 v44, v44
  v_exp_f32 v45, v45
  v_mfma_f32_32x32x16_bf16 v[56:71], v[20:23], v[16:19], v[88:103]
  v_exp_f32 v46, v46
  v_exp_f32 v47, v47
  v_exp_f32 v48, v48
  s_waitcnt lgkmcnt(0)
  v_exp_f32_e64 v49, v49
  v_smfmac_f32_32x32x32_bf16 v[104:119], v[28:31], v[40:47], v6
  v_exp_f32 v50, v50
  v_exp_f32 v51, v51
  v_exp_f32 v52, v52
  v_exp_f32 v53, v53
  v_exp_f32 v54, v54
  v_exp_f32 v55, v55
  v_exp_f32 v56, v56
  v_exp_f32 v57, v57
  v_smfmac_f32_32x32x32_bf16 v[104:119], v[32:35], v[48:55], v6
  v_exp_f32 v58, v58
  v_exp_f32 v59, v59
  v_exp_f32 v60, v60
  v_exp_f32 v61, v61
  v_mfma_f32_32x32x16_bf16 v[40:55], v[24:27], v[12:15], v[72:87]
  v_exp_f32 v62, v62
  v_exp_f32 v63, v63
  v_exp_f32 v64, v64
  v_exp_f32 v65, v65
  v_smfmac_f32_32x32x32_bf16 v[120:135], v[28:31], v[56:63], v6
  ds_read_b128 v[28:31], v4 offset:6144
  ds_read_b128 v[36:39], v4 offset:6656
  ds_read_b128 v[20:23], v3 offset:49152
  v_exp_f32 v66, v66
  v_exp_f32 v67, v67
  v_exp_f32 v68, v68
  v_exp_f32 v69, v69
  v_exp_f32 v70, v70
  v_exp_f32 v71, v71
  v_exp_f32 v40, v40
  v_exp_f32 v41, v41
  v_smfmac_f32_32x32x32_bf16 v[120:135], v[32:35], v[64:71], v6
  v_exp_f32 v42, v42
  v_exp_f32 v43, v43
  v_exp_f32 v44, v44
  v_exp_f32 v45, v45
  v_mfma_f32_32x32x16_bf16 v[56:71], v[24:27], v[16:19], v[88:103]
  v_exp_f32 v46, v46
  v_exp_f32 v47, v47
  v_exp_f32 v48, v48
  s_waitcnt lgkmcnt(0)
  v_exp_f32_e64 v49, v49
  v_smfmac_f32_32x32x32_bf16 v[104:119], v[28:31], v[40:47], v6
  v_exp_f32 v50, v50
  v_exp_f32 v51, v51
  v_exp_f32 v52, v52
  v_exp_f32 v53, v53
  v_exp_f32 v54, v54
  v_exp_f32 v55, v55
  v_exp_f32 v56, v56
  v_exp_f32 v57, v57
  v_smfmac_f32_32x32x32_bf16 v[104:119], v[36:39], v[48:55], v6
  v_exp_f32 v58, v58
  v_exp_f32 v59, v59
  v_exp_f32 v60, v60
  v_exp_f32 v61, v61
  v_mfma_f32_32x32x16_bf16 v[40:55], v[20:23], v[12:15], v[72:87]
  v_exp_f32 v62, v62
  v_exp_f32 v63, v63
  v_exp_f32 v64, v64
  v_exp_f32 v65, v65
  v_smfmac_f32_32x32x32_bf16 v[120:135], v[28:31], v[56:63], v6
  ds_read_b128 v[28:31], v4 offset:8192
  ds_read_b128 v[32:35], v4 offset:8704
  ds_read_b128 v[24:27], v3 offset:51200
  v_exp_f32 v66, v66
  v_exp_f32 v67, v67
  v_add_u32_e64 v4, v5, v4
  v_exp_f32 v68, v68
  v_exp_f32 v69, v69
  v_exp_f32 v70, v70
  v_exp_f32 v71, v71
  s_barrier
  .p2align 3
  v_exp_f32 v40, v40
  v_exp_f32 v41, v41
  v_smfmac_f32_32x32x32_bf16 v[120:135], v[36:39], v[64:71], v6
  v_exp_f32 v42, v42
  v_exp_f32 v43, v43
  v_exp_f32 v44, v44
  v_exp_f32 v45, v45
  v_mfma_f32_32x32x16_bf16 v[56:71], v[20:23], v[16:19], v[88:103]
  v_exp_f32 v46, v46
  v_exp_f32 v47, v47
  v_exp_f32 v48, v48
  s_waitcnt lgkmcnt(0)
  v_exp_f32_e64 v49, v49
  v_smfmac_f32_32x32x32_bf16 v[104:119], v[28:31], v[40:47], v6
  v_exp_f32 v50, v50
  v_exp_f32 v51, v51
  v_exp_f32 v52, v52
  v_exp_f32 v53, v53
  v_exp_f32 v54, v54
  v_exp_f32 v55, v55
  v_exp_f32 v56, v56
  v_exp_f32 v57, v57
  v_smfmac_f32_32x32x32_bf16 v[104:119], v[32:35], v[48:55], v6
  v_exp_f32 v58, v58
  v_exp_f32 v59, v59
  v_exp_f32 v60, v60
  v_exp_f32 v61, v61
  v_mfma_f32_32x32x16_bf16 v[40:55], v[24:27], v[12:15], v[72:87]
  v_exp_f32 v62, v62
  v_exp_f32 v63, v63
  v_exp_f32 v64, v64
  v_exp_f32 v65, v65
  v_smfmac_f32_32x32x32_bf16 v[120:135], v[28:31], v[56:63], v6
  ds_read_b128 v[28:31], v4 offset:2048
  ds_read_b128 v[36:39], v4 offset:2560
  ds_read_b128 v[20:23], v3 offset:53248
  v_exp_f32 v66, v66
  v_exp_f32 v67, v67
  v_exp_f32 v68, v68
  v_exp_f32 v69, v69
  v_exp_f32 v70, v70
  v_exp_f32 v71, v71
  v_exp_f32 v40, v40
  v_exp_f32 v41, v41
  v_smfmac_f32_32x32x32_bf16 v[120:135], v[32:35], v[64:71], v6
  v_exp_f32 v42, v42
  v_exp_f32 v43, v43
  v_exp_f32 v44, v44
  v_exp_f32 v45, v45
  v_mfma_f32_32x32x16_bf16 v[56:71], v[24:27], v[16:19], v[88:103]
  v_exp_f32 v46, v46
  v_exp_f32 v47, v47
  v_exp_f32 v48, v48
  s_waitcnt lgkmcnt(0)
  v_exp_f32_e64 v49, v49
  v_smfmac_f32_32x32x32_bf16 v[104:119], v[28:31], v[40:47], v6
  v_exp_f32 v50, v50
  v_exp_f32 v51, v51
  v_exp_f32 v52, v52
  v_exp_f32 v53, v53
  v_exp_f32 v54, v54
  v_exp_f32 v55, v55
  v_exp_f32 v56, v56
  v_exp_f32 v57, v57
  v_smfmac_f32_32x32x32_bf16 v[104:119], v[36:39], v[48:55], v6
  v_exp_f32 v58, v58
  v_exp_f32 v59, v59
  v_exp_f32 v60, v60
  v_exp_f32 v61, v61
  v_mfma_f32_32x32x16_bf16 v[40:55], v[20:23], v[12:15], v[72:87]
  v_exp_f32 v62, v62
  v_exp_f32 v63, v63
  v_exp_f32 v64, v64
  v_exp_f32 v65, v65
  v_smfmac_f32_32x32x32_bf16 v[120:135], v[28:31], v[56:63], v6
  ds_read_b128 v[28:31], v4 offset:4096
  ds_read_b128 v[32:35], v4 offset:4608
  ds_read_b128 v[24:27], v3 offset:55296
  v_exp_f32 v66, v66
  v_exp_f32 v67, v67
  v_exp_f32 v68, v68
  v_exp_f32 v69, v69
  v_exp_f32 v70, v70
  v_exp_f32 v71, v71
  v_exp_f32 v40, v40
  v_exp_f32 v41, v41
  v_smfmac_f32_32x32x32_bf16 v[120:135], v[36:39], v[64:71], v6
  v_exp_f32 v42, v42
  v_exp_f32 v43, v43
  v_exp_f32 v44, v44
  v_exp_f32 v45, v45
  v_mfma_f32_32x32x16_bf16 v[56:71], v[20:23], v[16:19], v[88:103]
  v_exp_f32 v46, v46
  v_exp_f32 v47, v47
  v_exp_f32 v48, v48
  s_waitcnt lgkmcnt(0)
  v_exp_f32_e64 v49, v49
  v_smfmac_f32_32x32x32_bf16 v[104:119], v[28:31], v[40:47], v6
  v_exp_f32 v50, v50
  v_exp_f32 v51, v51
  v_exp_f32 v52, v52
  v_exp_f32 v53, v53
  v_exp_f32 v54, v54
  v_exp_f32 v55, v55
  v_exp_f32 v56, v56
  v_exp_f32 v57, v57
  v_smfmac_f32_32x32x32_bf16 v[104:119], v[32:35], v[48:55], v6
  v_exp_f32 v58, v58
  v_exp_f32 v59, v59
  v_exp_f32 v60, v60
  v_exp_f32 v61, v61
  v_mfma_f32_32x32x16_bf16 v[40:55], v[24:27], v[12:15], v[72:87]
  v_exp_f32 v62, v62
  v_exp_f32 v63, v63
  v_exp_f32 v64, v64
  v_exp_f32 v65, v65
  v_smfmac_f32_32x32x32_bf16 v[120:135], v[28:31], v[56:63], v6
  ds_read_b128 v[28:31], v4 offset:6144
  ds_read_b128 v[36:39], v4 offset:6656
  ds_read_b128 v[20:23], v3 offset:57344
  v_exp_f32 v66, v66
  v_exp_f32 v67, v67
  v_exp_f32 v68, v68
  v_exp_f32 v69, v69
  v_exp_f32 v70, v70
  v_exp_f32 v71, v71
  v_exp_f32 v40, v40
  v_exp_f32 v41, v41
  v_smfmac_f32_32x32x32_bf16 v[120:135], v[32:35], v[64:71], v6
  v_exp_f32 v42, v42
  v_exp_f32 v43, v43
  v_exp_f32 v44, v44
  v_exp_f32 v45, v45
  v_mfma_f32_32x32x16_bf16 v[56:71], v[24:27], v[16:19], v[88:103]
  v_exp_f32 v46, v46
  v_exp_f32 v47, v47
  v_exp_f32 v48, v48
  s_waitcnt lgkmcnt(0)
  v_exp_f32_e64 v49, v49
  v_smfmac_f32_32x32x32_bf16 v[104:119], v[28:31], v[40:47], v6
  v_exp_f32 v50, v50
  v_exp_f32 v51, v51
  v_exp_f32 v52, v52
  v_exp_f32 v53, v53
  v_exp_f32 v54, v54
  v_exp_f32 v55, v55
  v_exp_f32 v56, v56
  v_exp_f32 v57, v57
  v_smfmac_f32_32x32x32_bf16 v[104:119], v[36:39], v[48:55], v6
  v_exp_f32 v58, v58
  v_exp_f32 v59, v59
  v_exp_f32 v60, v60
  v_exp_f32 v61, v61
  v_mfma_f32_32x32x16_bf16 v[40:55], v[20:23], v[12:15], v[72:87]
  v_exp_f32 v62, v62
  v_exp_f32 v63, v63
  v_exp_f32 v64, v64
  v_exp_f32 v65, v65
  v_smfmac_f32_32x32x32_bf16 v[120:135], v[28:31], v[56:63], v6
  ds_read_b128 v[28:31], v4 offset:8192
  ds_read_b128 v[32:35], v4 offset:8704
  ds_read_b128 v[24:27], v3 offset:59392
  v_exp_f32 v66, v66
  v_exp_f32 v67, v67
  v_add_u32_e64 v4, v5, v4
  v_exp_f32 v68, v68
  v_exp_f32 v69, v69
  v_exp_f32 v70, v70
  v_exp_f32 v71, v71
  v_exp_f32 v40, v40
  v_exp_f32 v41, v41
  v_smfmac_f32_32x32x32_bf16 v[120:135], v[36:39], v[64:71], v6
  v_exp_f32 v42, v42
  v_exp_f32 v43, v43
  v_exp_f32 v44, v44
  v_exp_f32 v45, v45
  v_mfma_f32_32x32x16_bf16 v[56:71], v[20:23], v[16:19], v[88:103]
  v_exp_f32 v46, v46
  v_exp_f32 v47, v47
  v_exp_f32 v48, v48
  s_waitcnt lgkmcnt(0)
  v_exp_f32_e64 v49, v49
  v_smfmac_f32_32x32x32_bf16 v[104:119], v[28:31], v[40:47], v6
  v_exp_f32 v50, v50
  v_exp_f32 v51, v51
  v_exp_f32 v52, v52
  v_exp_f32 v53, v53
  v_exp_f32 v54, v54
  v_exp_f32 v55, v55
  v_exp_f32 v56, v56
  v_exp_f32 v57, v57
  v_smfmac_f32_32x32x32_bf16 v[104:119], v[32:35], v[48:55], v6
  v_exp_f32 v58, v58
  v_exp_f32 v59, v59
  v_exp_f32 v60, v60
  v_exp_f32 v61, v61
  v_mfma_f32_32x32x16_bf16 v[40:55], v[24:27], v[12:15], v[72:87]
  v_exp_f32 v62, v62
  v_exp_f32 v63, v63
  v_exp_f32 v64, v64
  v_exp_f32 v65, v65
  v_smfmac_f32_32x32x32_bf16 v[120:135], v[28:31], v[56:63], v6
  ds_read_b128 v[28:31], v4 offset:2048
  ds_read_b128 v[36:39], v4 offset:2560
  ds_read_b128 v[20:23], v3 offset:61440
  v_exp_f32 v66, v66
  v_exp_f32 v67, v67
  v_exp_f32 v68, v68
  v_exp_f32 v69, v69
  v_exp_f32 v70, v70
  v_exp_f32 v71, v71
  v_exp_f32 v40, v40
  v_exp_f32 v41, v41
  v_smfmac_f32_32x32x32_bf16 v[120:135], v[32:35], v[64:71], v6
  v_exp_f32 v42, v42
  v_exp_f32 v43, v43
  v_exp_f32 v44, v44
  v_exp_f32 v45, v45
  v_mfma_f32_32x32x16_bf16 v[56:71], v[24:27], v[16:19], v[88:103]
  v_exp_f32 v46, v46
  v_exp_f32 v47, v47
  v_exp_f32 v48, v48
  s_waitcnt lgkmcnt(0)
  v_exp_f32_e64 v49, v49
  v_smfmac_f32_32x32x32_bf16 v[104:119], v[28:31], v[40:47], v6
  v_exp_f32 v50, v50
  v_exp_f32 v51, v51
  v_exp_f32 v52, v52
  v_exp_f32 v53, v53
  v_exp_f32 v54, v54
  v_exp_f32 v55, v55
  v_exp_f32 v56, v56
  v_exp_f32 v57, v57
  v_smfmac_f32_32x32x32_bf16 v[104:119], v[36:39], v[48:55], v6
  v_exp_f32 v58, v58
  v_exp_f32 v59, v59
  v_exp_f32 v60, v60
  v_exp_f32 v61, v61
  v_mfma_f32_32x32x16_bf16 v[40:55], v[20:23], v[12:15], v[72:87]
  v_exp_f32 v62, v62
  v_exp_f32 v63, v63
  v_exp_f32 v64, v64
  v_exp_f32 v65, v65
  v_smfmac_f32_32x32x32_bf16 v[120:135], v[28:31], v[56:63], v6
  ds_read_b128 v[28:31], v4 offset:4096
  ds_read_b128 v[32:35], v4 offset:4608
  ds_read_b128 v[24:27], v3 offset:63488
  v_exp_f32 v66, v66
  v_exp_f32 v67, v67
  v_exp_f32 v68, v68
  v_exp_f32 v69, v69
  v_exp_f32 v70, v70
  v_exp_f32 v71, v71
  v_exp_f32 v40, v40
  v_exp_f32 v41, v41
  v_smfmac_f32_32x32x32_bf16 v[120:135], v[36:39], v[64:71], v6
  v_exp_f32 v42, v42
  v_exp_f32 v43, v43
  v_exp_f32 v44, v44
  v_exp_f32 v45, v45
  v_mfma_f32_32x32x16_bf16 v[56:71], v[20:23], v[16:19], v[88:103]
  v_exp_f32 v46, v46
  v_exp_f32 v47, v47
  v_exp_f32 v48, v48
  s_waitcnt lgkmcnt(0)
  v_exp_f32_e64 v49, v49
  v_smfmac_f32_32x32x32_bf16 v[104:119], v[28:31], v[40:47], v6
  v_exp_f32 v50, v50
  v_exp_f32 v51, v51
  v_exp_f32 v52, v52
  v_exp_f32 v53, v53
  v_exp_f32 v54, v54
  v_exp_f32 v55, v55
  v_exp_f32 v56, v56
  v_exp_f32 v57, v57
  v_smfmac_f32_32x32x32_bf16 v[104:119], v[32:35], v[48:55], v6
  v_exp_f32 v58, v58
  v_exp_f32 v59, v59
  v_exp_f32 v60, v60
  v_exp_f32 v61, v61
  v_mfma_f32_32x32x16_bf16 v[40:55], v[24:27], v[12:15], v[72:87]
  v_exp_f32 v62, v62
  v_exp_f32 v63, v63
  v_exp_f32 v64, v64
  v_exp_f32 v65, v65
  v_smfmac_f32_32x32x32_bf16 v[120:135], v[28:31], v[56:63], v6
  ds_read_b128 v[28:31], v4 offset:6144
  ds_read_b128 v[36:39], v4 offset:6656
  s_nop 0
  s_nop 0
  v_exp_f32 v66, v66
  v_exp_f32 v67, v67
  v_exp_f32 v68, v68
  v_exp_f32 v69, v69
  v_exp_f32 v70, v70
  v_exp_f32 v71, v71
  v_exp_f32 v40, v40
  v_exp_f32 v41, v41
  v_smfmac_f32_32x32x32_bf16 v[120:135], v[32:35], v[64:71], v6
  v_exp_f32 v42, v42
  v_exp_f32 v43, v43
  v_exp_f32 v44, v44
  v_exp_f32 v45, v45
  v_mfma_f32_32x32x16_bf16 v[56:71], v[24:27], v[16:19], v[88:103]
  v_exp_f32 v46, v46
  v_exp_f32 v47, v47
  v_exp_f32 v48, v48
  s_waitcnt lgkmcnt(0)
  v_exp_f32_e64 v49, v49
  v_smfmac_f32_32x32x32_bf16 v[104:119], v[28:31], v[40:47], v6
  v_exp_f32 v50, v50
  v_exp_f32 v51, v51
  v_exp_f32 v52, v52
  v_exp_f32 v53, v53
  v_exp_f32 v54, v54
  v_exp_f32 v55, v55
  v_exp_f32 v56, v56
  v_exp_f32 v57, v57
  v_smfmac_f32_32x32x32_bf16 v[104:119], v[36:39], v[48:55], v6
  v_exp_f32 v58, v58
  v_exp_f32 v59, v59
  v_exp_f32 v60, v60
  v_exp_f32 v61, v61
  v_exp_f32 v62, v62
  v_exp_f32 v63, v63
  v_exp_f32 v64, v64
  v_exp_f32 v65, v65
  v_smfmac_f32_32x32x32_bf16 v[120:135], v[28:31], v[56:63], v6
  v_exp_f32 v66, v66
  v_exp_f32 v67, v67
  v_add_u32_e64 v4, v5, v4
  v_exp_f32 v68, v68
  v_exp_f32 v69, v69
  v_exp_f32 v70, v70
  v_exp_f32 v71, v71
  s_mul_i32 s32, s34, 2304
  s_add_u32 s32, s32, 143360
  v_smfmac_f32_32x32x32_bf16 v[120:135], v[36:39], v[64:71], v6
  v_add_u32 v7, s32, v2
  v_lshlrev_b32 v3, 2, v1
  v_add_u32 v3, s32, v3
  s_xor_b32 s33, s34, 4
  s_mul_i32 s33, s33, 2304
  s_add_u32 s33, s33, 143360
  v_add_u32 v8, s33, v2
  v_lshlrev_b32 v4, 2, v1
  v_add_u32 v4, s33, v4
  s_nop 2
  s_cmp_eq_u32 s45, 0
  s_cbranch_scc1 L_sequential_preLN__mha_block__mixer_gmlp__prompt_kernel_p2c_kh0
  ds_write_b128 v7, v[104:107]
  ds_write_b128 v7, v[108:111] offset:1024
  ds_write_b32 v3, v112 offset:2048
  s_waitcnt lgkmcnt(0)
  v_mov_b32 v104, v120
  v_mov_b32 v105, v121
  v_mov_b32 v106, v122
  v_mov_b32 v107, v123
  v_mov_b32 v108, v124
  v_mov_b32 v109, v125
  v_mov_b32 v110, v126
  v_mov_b32 v111, v127
  v_mov_b32 v112, v128
  v_mov_b32 v12, v16
  v_mov_b32 v13, v17
  v_mov_b32 v14, v18
  v_mov_b32 v15, v19
  s_branch L_sequential_preLN__mha_block__mixer_gmlp__prompt_kernel_p2c_xch
L_sequential_preLN__mha_block__mixer_gmlp__prompt_kernel_p2c_kh0:
  ds_write_b128 v7, v[120:123]
  ds_write_b128 v7, v[124:127] offset:1024
  ds_write_b32 v3, v128 offset:2048
  s_waitcnt lgkmcnt(0)
L_sequential_preLN__mha_block__mixer_gmlp__prompt_kernel_p2c_xch:
  s_barrier
  ds_read_b128 v[40:43], v8
  ds_read_b128 v[44:47], v8 offset:1024
  ds_read_b32 v48, v4 offset:2048
  s_waitcnt lgkmcnt(0)
  v_add_f32 v104, v104, v40
  v_add_f32 v105, v105, v41
  v_add_f32 v106, v106, v42
  v_add_f32 v107, v107, v43
  v_add_f32 v108, v108, v44
  v_add_f32 v109, v109, v45
  v_add_f32 v110, v110, v46
  v_add_f32 v111, v111, v47
  v_add_f32 v112, v112, v48
  v_add_f32 v7, abs(v104), v112
  v_add_f32 v7, abs(v105), v7
  v_add_f32 v7, abs(v106), v7
  v_add_f32 v7, abs(v107), v7
  v_add_f32 v7, abs(v108), v7
  v_add_f32 v7, abs(v109), v7
  v_add_f32 v7, abs(v110), v7
  v_add_f32 v7, abs(v111), v7
  s_mov_b32 s32, 0x71800000
  v_cmp_gt_f32 vcc, s32, v7
  s_cmp_eq_u64 vcc, -1
  s_cbranch_scc1 L_sequential_preLN__mha_block__mixer_gmlp__prompt_kernel_p2c_store
  s_lshl_b32 s44, s41, 17
  s_add_u32 s44, s44, 0x200000
  s_mov_b32 s37, 64
  s_mov_b32 s33, s44
  v_mov_b32 v7, 0xff800000
L_sequential_preLN__mha_block__mixer_gmlp__prompt_kernel_p2c_fb1:
  buffer_load_dwordx4 v[20:23], v2, s[28:31], s33 offen sc1
  s_add_u32 s33, s33, 2048
  s_waitcnt vmcnt(0)
  v_mfma_f32_32x32x16_bf16 v[40:55], v[20:23], v[12:15], 0
  s_nop 15
  v_max3_f32 v7, v7, v40, v41
  v_max3_f32 v7, v7, v42, v43
  v_max3_f32 v7, v7, v44, v45
  v_max3_f32 v7, v7, v46, v47
  v_max3_f32 v7, v7, v48, v49
  v_max3_f32 v7, v7, v50, v51
  v_max3_f32 v7, v7, v52, v53
  v_max3_f32 v7, v7, v54, v55
  s_sub_u32 s37, s37, 1
  s_cmp_lg_u32 s37, 0
  s_cbranch_scc1 L_sequential_preLN__mha_block__mixer_gmlp__prompt_kernel_p2c_fb1
  v_mov_b32 v8, v7
  s_nop 1
  v_permlane32_swap_b32 v8, v7
  s_nop 1
  v_max_f32 v7, v7, v8
  v_sub_f32 v72, 0, v7
  v_mov_b32 v104, 0
  v_sub_f32 v73, 0, v7
  v_mov_b32 v105, 0
  v_sub_f32 v74, 0, v7
  v_mov_b32 v106, 0
  v_sub_f32 v75, 0, v7
  v_mov_b32 v107, 0
  v_sub_f32 v76, 0, v7
  v_mov_b32 v108, 0
  v_sub_f32 v77, 0, v7
  v_mov_b32 v109, 0
  v_sub_f32 v78, 0, v7
  v_mov_b32 v110, 0
  v_sub_f32 v79, 0, v7
  v_mov_b32 v111, 0
  v_sub_f32 v80, 0, v7
  v_mov_b32 v112, 0
  v_sub_f32 v81, 0, v7
  v_mov_b32 v113, 0
  v_sub_f32 v82, 0, v7
  v_mov_b32 v114, 0
  v_sub_f32 v83, 0, v7
  v_mov_b32 v115, 0
  v_sub_f32 v84, 0, v7
  v_mov_b32 v116, 0
  v_sub_f32 v85, 0, v7
  v_mov_b32 v117, 0
  v_sub_f32 v86, 0, v7
  v_mov_b32 v118, 0
  v_sub_f32 v87, 0, v7
  v_mov_b32 v119, 0
  v_mov_b32 v28, 0x3f803f80
  v_mov_b32 v32, 0x3f803f80
  v_mov_b32 v29, 0x3f803f80
  v_mov_b32 v33, 0x3f803f80
  v_mov_b32 v30, 0x3f803f80
  v_mov_b32 v34, 0x3f803f80
  v_mov_b32 v31, 0x3f803f80
  v_mov_b32 v35, 0x3f803f80
  s_mov_b32 s37, 64
L_sequential_preLN__mha_block__mixer_gmlp__prompt_kernel_p2c_fb2:
  buffer_load_dwordx4 v[20:23], v2, s[28:31], s44 offen sc1
  s_mov_b32 exec_lo, 0xffff
  s_mov_b32 exec_hi, 0xffff
  buffer_load_dwordx4 v[28:31], v9, s[28:31], s44 offen sc1
  buffer_load_dwordx4 v[32:35], v9, s[28:31], s44 offen offset:512 sc1
  s_mov_b64 exec, -1
  s_add_u32 s44, s44, 2048
  s_waitcnt vmcnt(0)
  v_mfma_f32_32x32x16_bf16 v[40:55], v[20:23], v[12:15], v[72:87]
  s_nop 15
  v_exp_f32 v40, v40
  v_exp_f32 v41, v41
  v_exp_f32 v42, v42
  v_exp_f32 v43, v43
  v_exp_f32 v44, v44
  v_exp_f32 v45, v45
  v_exp_f32 v46, v46
  v_exp_f32 v47, v47
  v_exp_f32 v48, v48
  v_exp_f32 v49, v49
  v_exp_f32 v50, v50
  v_exp_f32 v51, v51
  v_exp_f32 v52, v52
  v_exp_f32 v53, v53
  v_exp_f32 v54, v54
  v_exp_f32 v55, v55
  s_nop 1
  v_smfmac_f32_32x32x32_bf16 v[104:119], v[28:31], v[40:47], v6
  v_smfmac_f32_32x32x32_bf16 v[104:119], v[32:35], v[48:55], v6
  s_nop 15
  s_sub_u32 s37, s37, 1
  s_cmp_lg_u32 s37, 0
  s_cbranch_scc1 L_sequential_preLN__mha_block__mixer_gmlp__prompt_kernel_p2c_fb2
L_sequential_preLN__mha_block__mixer_gmlp__prompt_kernel_p2c_store:
  v_rcp_f32 v8, v112
  s_nop 0
  v_mul_f32 v104, v104, v8
  v_mul_f32 v105, v105, v8
  v_mul_f32 v106, v106, v8
  v_mul_f32 v107, v107, v8
  v_mul_f32 v108, v108, v8
  v_mul_f32 v109, v109, v8
  v_mul_f32 v110, v110, v8
  v_mul_f32 v111, v111, v8
  v_cvt_pk_bf16_f32 v20, v104, v105
  v_cvt_pk_bf16_f32 v21, v106, v107
  v_cvt_pk_bf16_f32 v22, v108, v109
  v_cvt_pk_bf16_f32 v23, v110, v111
  buffer_store_dwordx4 v[20:23], v2, s[28:31], s43 offen sc1
  s_lshl_b32 s46, s46, 7
  s_add_u32 s46, s46, 0x1700000
  v_lshlrev_b32 v7, 15, v1
  v_mov_b32 v40, s38
  v_mov_b32 v41, s39
  s_waitcnt vmcnt(0)
  s_barrier
  s_cmp_lg_u32 s34, 0
  s_cbranch_scc1 L_sequential_preLN__mha_block__mixer_gmlp__prompt_kernel_p2c_nofl
  s_mov_b64 exec, 255
  buffer_store_dwordx2 v[40:41], v7, s[28:31], s46 offen sc1
  s_mov_b64 exec, -1
L_sequential_preLN__mha_block__mixer_gmlp__prompt_kernel_p2c_nofl:
  s_lshl_b32 s32, s35, 2
  s_and_b32 s33, s36, 3
  s_add_u32 s41, s32, s33
  s_lshr_b32 s42, s36, 2
  s_cmp_ge_u32 s34, 4
  s_cbranch_scc1 L_sequential_preLN__mha_block__mixer_gmlp__prompt_kernel_p3c_idle
  s_and_b32 s43, s34, 1
  s_lshr_b32 s44, s34, 1
  s_lshl_b32 s45, s41, 1
  s_add_u32 s45, s45, s43
  s_lshl_b32 s48, s45, 4
  s_lshl_b32 s33, s42, 1
  s_add_u32 s48, s48, s33
  s_add_u32 s48, s48, s44
  s_lshl_b32 s46, s48, 11
  s_add_u32 s46, s46, 0x800000
  s_lshl_b32 s47, s45, 15
  s_lshl_b32 s33, s42, 7
  s_add_u32 s47, s47, s33
  s_lshl_b32 s33, s44, 6
  s_add_u32 s47, s47, s33
  v_lshrrev_b32 v3, 5, v1
  v_lshlrev_b32 v8, 8, v3
  v_bfe_u32 v3, v1, 2, 2
  v_lshl_add_u32 v8, v3, 6, v8
  v_bfe_u32 v3, v1, 4, 1
  v_lshl_add_u32 v8, v3, 5, v8
  v_and_b32 v3, 3, v1
  v_lshl_add_u32 v8, v3, 3, v8
  s_lshl_b32 s32, s44, 10
  v_add_u32 v8, s32, v8
  s_lshl_b32 s32, s43, 12
  v_add_u32 v9, s32, v2
  v_add_u32 v132, 65536, v8
  v_add_u32 v133, 65536, v9
  v_mov_b32 v100, 0
  v_mov_b32 v101, 0
  v_mov_b32 v102, 0
  v_mov_b32 v103, 0
  v_mov_b32 v104, 0
  v_mov_b32 v105, 0
  v_mov_b32 v106, 0
  v_mov_b32 v107, 0
  v_mov_b32 v108, 0
  v_mov_b32 v109, 0
  v_mov_b32 v110, 0
  v_mov_b32 v111, 0
  v_mov_b32 v112, 0
  v_mov_b32 v113, 0
  v_mov_b32 v114, 0
  v_mov_b32 v115, 0
  v_and_b32 v3, 31, v1
  v_lshlrev_b32 v3, 6, v3
  v_lshrrev_b32 v6, 5, v1
  v_lshl_add_u32 v3, v6, 3, v3
  s_lshl_b32 s32, s34, 11
  s_add_u32 s32, s32, 131072
  v_add_u32 v3, s32, v3
  v_bfe_u32 v6, v1, 2, 2
  v_xor_b32 v116, 0, v6
  v_lshl_add_u32 v116, v116, 4, v3
  v_xor_b32 v117, 1, v6
  v_lshl_add_u32 v117, v117, 4, v3
  v_xor_b32 v118, 2, v6
  v_lshl_add_u32 v118, v118, 4, v3
  v_xor_b32 v119, 3, v6
  v_lshl_add_u32 v119, v119, 4, v3
  s_cmp_lg_u32 s34, 0
  s_cbranch_scc1 L_sequential_preLN__mha_block__mixer_gmlp__prompt_kernel_p3c_nopoll
  s_lshl_b32 s32, s35, 5
  s_add_u32 s32, s32, 2048
  s_and_b32 s33, s36, 7
  s_lshl_b32 s33, s33, 8
  s_add_u32 s32, s32, s33
  s_lshl_b32 s32, s32, 7
  s_add_u32 s32, s32, 0x1700000
  v_min_u32 v4, 31, v1
  v_lshlrev_b32 v4, 7, v4
  s_mov_b32 s37, 100000
  s_mov_b32 exec_hi, 0x0
  s_branch L_sequential_preLN__mha_block__mixer_gmlp__prompt_kernel_p3c_pollg
L_sequential_preLN__mha_block__mixer_gmlp__prompt_kernel_p3c_poll:
  s_sleep 2
L_sequential_preLN__mha_block__mixer_gmlp__prompt_kernel_p3c_pollg:
  buffer_load_dwordx2 v[6:7], v4, s[28:31], s32 offen sc1
  s_sub_u32 s37, s37, 1
  s_cbranch_scc1 L_sequential_preLN__mha_block__mixer_gmlp__prompt_kernel_p3c_pollx
  s_waitcnt vmcnt(0)
  v_cmp_ne_u64 vcc, s[38:39], v[6:7]
  s_and_b64 exec, exec, vcc
  s_cbranch_scc1 L_sequential_preLN__mha_block__mixer_gmlp__prompt_kernel_p3c_poll
L_sequential_preLN__mha_block__mixer_gmlp__prompt_kernel_p3c_pollx:
  s_mov_b64 exec, -1
L_sequential_preLN__mha_block__mixer_gmlp__prompt_kernel_p3c_nopoll:
  s_barrier
  ds_read_b64_tr_b16 v[20:21], v8 offset:0
  ds_read_b64_tr_b16 v[22:23], v8 offset:512
  ds_read_b64_tr_b16 v[24:25], v8 offset:2048
  ds_read_b64_tr_b16 v[26:27], v8 offset:2560
  ds_read_b64_tr_b16 v[28:29], v8 offset:4096
  ds_read_b64_tr_b16 v[30:31], v8 offset:4608
  ds_read_b64_tr_b16 v[32:33], v8 offset:6144
  ds_read_b64_tr_b16 v[34:35], v8 offset:6656
  s_barrier
  ds_read_b128 v[68:71], v9 offset:32768
  ds_read_b128 v[72:75], v9 offset:33792
  ds_read_b128 v[76:79], v9 offset:34816
  ds_read_b128 v[80:83], v9 offset:35840
  ds_read_b64_tr_b16 v[36:37], v8 offset:8192
  ds_read_b64_tr_b16 v[38:39], v8 offset:8704
  ds_read_b64_tr_b16 v[40:41], v8 offset:10240
  ds_read_b64_tr_b16 v[42:43], v8 offset:10752
  ds_read_b64_tr_b16 v[44:45], v8 offset:12288
  ds_read_b64_tr_b16 v[46:47], v8 offset:12800
  ds_read_b64_tr_b16 v[48:49], v8 offset:14336
  ds_read_b64_tr_b16 v[50:51], v8 offset:14848
  s_waitcnt lgkmcnt(8)
  s_barrier
  ds_read_b128 v[84:87], v9 offset:40960
  ds_read_b128 v[88:91], v9 offset:41984
  v_mfma_f32_32x32x16_bf16 v[100:115], v[20:23], v[68:71], v[100:115]
  ds_read_b128 v[92:95], v9 offset:43008
  ds_read_b128 v[96:99], v9 offset:44032
  ds_read_b64 v[12:13], v116
  v_mfma_f32_32x32x16_bf16 v[100:115], v[24:27], v[72:75], v[100:115]
  ds_read_b64 v[14:15], v117
  ds_read_b64 v[16:17], v118
  ds_read_b64 v[18:19], v119
  v_mfma_f32_32x32x16_bf16 v[100:115], v[28:31], v[76:79], v[100:115]
  ds_read_b64_tr_b16 v[52:53], v8 offset:16384
  ds_read_b64_tr_b16 v[54:55], v8 offset:16896
  ds_read_b64_tr_b16 v[56:57], v8 offset:18432
  v_mfma_f32_32x32x16_bf16 v[100:115], v[32:35], v[80:83], v[100:115]
  ds_read_b64_tr_b16 v[58:59], v8 offset:18944
  ds_read_b64_tr_b16 v[60:61], v8 offset:20480
  ds_read_b64_tr_b16 v[62:63], v8 offset:20992
  ds_read_b64_tr_b16 v[64:65], v8 offset:22528
  ds_read_b64_tr_b16 v[66:67], v8 offset:23040
  s_waitcnt lgkmcnt(8)
  s_barrier
  ds_read_b128 v[68:71], v9 offset:49152
  ds_read_b128 v[72:75], v9 offset:50176
  v_mfma_f32_32x32x16_bf16 v[100:115], v[36:39], v[84:87], v[100:115]
  ds_read_b128 v[76:79], v9 offset:51200
  ds_read_b128 v[80:83], v9 offset:52224
  ds_read_b64_tr_b16 v[20:21], v8 offset:24576
  v_mfma_f32_32x32x16_bf16 v[100:115], v[40:43], v[88:91], v[100:115]
  ds_read_b64_tr_b16 v[22:23], v8 offset:25088
  ds_read_b64_tr_b16 v[24:25], v8 offset:26624
  ds_read_b64_tr_b16 v[26:27], v8 offset:27136
  v_mfma_f32_32x32x16_bf16 v[100:115], v[44:47], v[92:95], v[100:115]
  ds_read_b64_tr_b16 v[28:29], v8 offset:28672
  ds_read_b64_tr_b16 v[30:31], v8 offset:29184
  ds_read_b64_tr_b16 v[32:33], v8 offset:30720
  v_mfma_f32_32x32x16_bf16 v[100:115], v[48:51], v[96:99], v[100:115]
  ds_read_b64_tr_b16 v[34:35], v8 offset:31232
  s_waitcnt lgkmcnt(8)
  s_barrier
  ds_read_b128 v[84:87], v9 offset:57344
  ds_read_b128 v[88:91], v9 offset:58368
  v_mfma_f32_32x32x16_bf16 v[100:115], v[52:55], v[68:71], v[100:115]
  ds_read_b128 v[92:95], v9 offset:59392
  ds_read_b128 v[96:99], v9 offset:60416
  ds_read_b64_tr_b16 v[36:37], v132 offset:0
  v_mfma_f32_32x32x16_bf16 v[100:115], v[56:59], v[72:75], v[100:115]
  ds_read_b64_tr_b16 v[38:39], v132 offset:512
  ds_read_b64_tr_b16 v[40:41], v132 offset:2048
  ds_read_b64_tr_b16 v[42:43], v132 offset:2560
  v_mfma_f32_32x32x16_bf16 v[100:115], v[60:63], v[76:79], v[100:115]
  ds_read_b64_tr_b16 v[44:45], v132 offset:4096
  ds_read_b64_tr_b16 v[46:47], v132 offset:4608
  ds_read_b64_tr_b16 v[48:49], v132 offset:6144
  v_mfma_f32_32x32x16_bf16 v[100:115], v[64:67], v[80:83], v[100:115]
  ds_read_b64_tr_b16 v[50:51], v132 offset:6656
  v_lshlrev_b32 v116, 16, v12
  v_and_b32 v117, 0xffff0000, v12
  v_lshlrev_b32 v118, 16, v13
  v_and_b32 v119, 0xffff0000, v13
  v_lshlrev_b32 v120, 16, v14
  v_and_b32 v121, 0xffff0000, v14
  v_lshlrev_b32 v122, 16, v15
  v_and_b32 v123, 0xffff0000, v15
  v_lshlrev_b32 v124, 16, v16
  v_and_b32 v125, 0xffff0000, v16
  v_lshlrev_b32 v126, 16, v17
  v_and_b32 v127, 0xffff0000, v17
  v_lshlrev_b32 v128, 16, v18
  v_and_b32 v129, 0xffff0000, v18
  v_lshlrev_b32 v130, 16, v19
  v_and_b32 v131, 0xffff0000, v19
  s_waitcnt lgkmcnt(8)
  s_barrier
  ds_read_b128 v[68:71], v133 offset:32768
  ds_read_b128 v[72:75], v133 offset:33792
  v_mfma_f32_32x32x16_bf16 v[100:115], v[20:23], v[84:87], v[100:115]
  ds_read_b128 v[76:79], v133 offset:34816
  ds_read_b128 v[80:83], v133 offset:35840
  ds_read_b64_tr_b16 v[52:53], v132 offset:8192
  v_mfma_f32_32x32x16_bf16 v[100:115], v[24:27], v[88:91], v[100:115]
  ds_read_b64_tr_b16 v[54:55], v132 offset:8704
  ds_read_b64_tr_b16 v[56:57], v132 offset:10240
  ds_read_b64_tr_b16 v[58:59], v132 offset:10752
  v_mfma_f32_32x32x16_bf16 v[100:115], v[28:31], v[92:95], v[100:115]
  ds_read_b64_tr_b16 v[60:61], v132 offset:12288
  ds_read_b64_tr_b16 v[62:63], v132 offset:12800
  ds_read_b64_tr_b16 v[64:65], v132 offset:14336
  v_mfma_f32_32x32x16_bf16 v[100:115], v[32:35], v[96:99], v[100:115]
  ds_read_b64_tr_b16 v[66:67], v132 offset:14848
  s_waitcnt lgkmcnt(8)
  s_barrier
  ds_read_b128 v[84:87], v133 offset:40960
  ds_read_b128 v[88:91], v133 offset:41984
  v_mfma_f32_32x32x16_bf16 v[100:115], v[36:39], v[68:71], v[100:115]
  ds_read_b128 v[92:95], v133 offset:43008
  ds_read_b128 v[96:99], v133 offset:44032
  ds_read_b64_tr_b16 v[20:21], v132 offset:16384
  v_mfma_f32_32x32x16_bf16 v[100:115], v[40:43], v[72:75], v[100:115]
  ds_read_b64_tr_b16 v[22:23], v132 offset:16896
  ds_read_b64_tr_b16 v[24:25], v132 offset:18432
  ds_read_b64_tr_b16 v[26:27], v132 offset:18944
  v_mfma_f32_32x32x16_bf16 v[100:115], v[44:47], v[76:79], v[100:115]
  ds_read_b64_tr_b16 v[28:29], v132 offset:20480
  ds_read_b64_tr_b16 v[30:31], v132 offset:20992
  ds_read_b64_tr_b16 v[32:33], v132 offset:22528
  v_mfma_f32_32x32x16_bf16 v[100:115], v[48:51], v[80:83], v[100:115]
  ds_read_b64_tr_b16 v[34:35], v132 offset:23040
  s_waitcnt lgkmcnt(8)
  s_barrier
  ds_read_b128 v[68:71], v133 offset:49152
  ds_read_b128 v[72:75], v133 offset:50176
  v_mfma_f32_32x32x16_bf16 v[100:115], v[52:55], v[84:87], v[100:115]
  ds_read_b128 v[76:79], v133 offset:51200
  ds_read_b128 v[80:83], v133 offset:52224
  ds_read_b64_tr_b16 v[36:37], v132 offset:24576
  v_mfma_f32_32x32x16_bf16 v[100:115], v[56:59], v[88:91], v[100:115]
  ds_read_b64_tr_b16 v[38:39], v132 offset:25088
  ds_read_b64_tr_b16 v[40:41], v132 offset:26624
  ds_read_b64_tr_b16 v[42:43], v132 offset:27136
  v_mfma_f32_32x32x16_bf16 v[100:115], v[60:63], v[92:95], v[100:115]
  ds_read_b64_tr_b16 v[44:45], v132 offset:28672
  ds_read_b64_tr_b16 v[46:47], v132 offset:29184
  ds_read_b64_tr_b16 v[48:49], v132 offset:30720
  v_mfma_f32_32x32x16_bf16 v[100:115], v[64:67], v[96:99], v[100:115]
  ds_read_b64_tr_b16 v[50:51], v132 offset:31232
  s_waitcnt lgkmcnt(8)
  s_barrier
  ds_read_b128 v[84:87], v133 offset:57344
  ds_read_b128 v[88:91], v133 offset:58368
  v_mfma_f32_32x32x16_bf16 v[100:115], v[20:23], v[68:71], v[100:115]
  ds_read_b128 v[92:95], v133 offset:59392
  ds_read_b128 v[96:99], v133 offset:60416
  v_mfma_f32_32x32x16_bf16 v[100:115], v[24:27], v[72:75], v[100:115]
  v_mfma_f32_32x32x16_bf16 v[100:115], v[28:31], v[76:79], v[100:115]
  v_mfma_f32_32x32x16_bf16 v[100:115], v[32:35], v[80:83], v[100:115]
  s_waitcnt lgkmcnt(3)
  v_mfma_f32_32x32x16_bf16 v[100:115], v[36:39], v[84:87], v[100:115]
  s_waitcnt lgkmcnt(2)
  v_mfma_f32_32x32x16_bf16 v[100:115], v[40:43], v[88:91], v[100:115]
  s_waitcnt lgkmcnt(1)
  v_mfma_f32_32x32x16_bf16 v[100:115], v[44:47], v[92:95], v[100:115]
  s_waitcnt lgkmcnt(0)
  v_mfma_f32_32x32x16_bf16 v[100:115], v[48:51], v[96:99], v[100:115]
  s_barrier
  s_nop 10
  v_add_f32 v100, v100, v116
  v_add_f32 v101, v101, v117
  v_add_f32 v102, v102, v118
  v_add_f32 v103, v103, v119
  v_add_f32 v104, v104, v120
  v_add_f32 v105, v105, v121
  v_add_f32 v106, v106, v122
  v_add_f32 v107, v107, v123
  v_add_f32 v108, v108, v124
  v_add_f32 v109, v109, v125
  v_add_f32 v110, v110, v126
  v_add_f32 v111, v111, v127
  v_add_f32 v112, v112, v128
  v_add_f32 v113, v113, v129
  v_add_f32 v114, v114, v130
  v_add_f32 v115, v115, v131
  v_cvt_pk_bf16_f32 v12, v100, v101
  v_cvt_pk_bf16_f32 v13, v102, v103
  v_cvt_pk_bf16_f32 v14, v104, v105
  v_cvt_pk_bf16_f32 v15, v106, v107
  v_cvt_pk_bf16_f32 v16, v108, v109
  v_cvt_pk_bf16_f32 v17, v110, v111
  v_cvt_pk_bf16_f32 v18, v112, v113
  v_cvt_pk_bf16_f32 v19, v114, v115
  buffer_store_dwordx4 v[12:15], v2, s[28:31], s46 offen sc1
  buffer_store_dwordx4 v[16:19], v2, s[28:31], s46 offen offset:1024 sc1
  v_add_f32 v20, v100, v101
  v_mul_f32 v21, v100, v100
  v_add_f32 v22, v102, v103
  v_mul_f32 v23, v101, v101
  v_fmac_f32 v21, v102, v102
  v_fmac_f32 v23, v103, v103
  v_add_f32 v20, v20, v104
  v_fmac_f32 v21, v104, v104
  v_add_f32 v22, v22, v105
  v_fmac_f32 v23, v105, v105
  v_add_f32 v20, v20, v106
  v_fmac_f32 v21, v106, v106
  v_add_f32 v22, v22, v107
  v_fmac_f32 v23, v107, v107
  v_add_f32 v20, v20, v108
  v_fmac_f32 v21, v108, v108
  v_add_f32 v22, v22, v109
  v_fmac_f32 v23, v109, v109
  v_add_f32 v20, v20, v110
  v_fmac_f32 v21, v110, v110
  v_add_f32 v22, v22, v111
  v_fmac_f32 v23, v111, v111
  v_add_f32 v20, v20, v112
  v_fmac_f32 v21, v112, v112
  v_add_f32 v22, v22, v113
  v_fmac_f32 v23, v113, v113
  v_add_f32 v20, v20, v114
  v_fmac_f32 v21, v114, v114
  v_add_f32 v22, v22, v115
  v_fmac_f32 v23, v115, v115
  v_add_f32 v20, v20, v22
  v_add_f32 v21, v21, v23
  v_mov_b32 v4, v20
  v_mov_b32 v6, v21
  s_nop 1
  v_permlane32_swap_b32 v4, v20
  v_permlane32_swap_b32 v6, v21
  s_nop 1
  v_add_f32 v20, v20, v4
  v_add_f32 v21, v21, v6
  v_lshlrev_b32 v3, 3, v1
  s_lshl_b32 s32, s48, 8
  s_add_u32 s32, s32, 0x1680000
  s_mov_b32 exec_hi, 0
  buffer_store_dwordx2 v[20:21], v3, s[28:31], s32 offen sc1
  s_mov_b32 exec_hi, -1
  s_lshl_b32 s48, s41, 3
  s_add_u32 s48, s48, s42
  s_add_u32 s48, s48, 4096
  s_lshl_b32 s48, s48, 7
  s_add_u32 s48, s48, 0x1700000
  v_lshlrev_b32 v3, 15, v1
  v_mov_b32 v6, s38
  v_mov_b32 v7, s39
  s_waitcnt vmcnt(0)
  s_barrier
  s_cmp_lg_u32 s34, 0
  s_cbranch_scc1 L_sequential_preLN__mha_block__mixer_gmlp__prompt_kernel_p3c_nofl
  s_mov_b64 exec, 15
  buffer_store_dwordx2 v[6:7], v3, s[28:31], s48 offen sc1
  s_mov_b64 exec, -1
L_sequential_preLN__mha_block__mixer_gmlp__prompt_kernel_p3c_nofl:
  s_branch L_sequential_preLN__mha_block__mixer_gmlp__prompt_kernel_p3c_end
L_sequential_preLN__mha_block__mixer_gmlp__prompt_kernel_p3c_idle:
  s_barrier
  s_barrier
  s_barrier
  s_barrier
  s_barrier
  s_barrier
  s_barrier
  s_barrier
  s_barrier
  s_barrier
  s_barrier
L_sequential_preLN__mha_block__mixer_gmlp__prompt_kernel_p3c_end:
  s_cmp_ge_u32 s36, 28
  s_cbranch_scc1 L_sequential_preLN__mha_block__mixer_gmlp__prompt_kernel_p4c_end
  s_lshl_b32 s32, s35, 1
  s_and_b32 s33, s36, 1
  s_add_u32 s41, s32, s33
  s_lshr_b32 s42, s36, 1
  s_and_b32 s43, s34, 3
  s_lshr_b32 s44, s34, 2
  s_lshl_b32 s45, s41, 2
  s_add_u32 s45, s45, s43
  v_lshrrev_b32 v3, 5, v1
  v_lshlrev_b32 v8, 8, v3
  v_bfe_u32 v3, v1, 2, 2
  v_lshl_add_u32 v8, v3, 6, v8
  v_bfe_u32 v3, v1, 4, 1
  v_lshl_add_u32 v8, v3, 5, v8
  v_and_b32 v3, 3, v1
  v_lshl_add_u32 v8, v3, 3, v8
  s_lshl_b32 s32, s44, 10
  s_add_u32 s32, s32, 131072
  v_add_u32 v8, s32, v8
  s_lshl_b32 s32, s43, 12
  v_add_u32 v9, s32, v2
  v_add_u32 v28, 65536, v9
  v_mov_b32 v96, 0
  v_mov_b32 v97, 0
  v_mov_b32 v98, 0
  v_mov_b32 v99, 0
  v_mov_b32 v100, 0
  v_mov_b32 v101, 0
  v_mov_b32 v102, 0
  v_mov_b32 v103, 0
  v_mov_b32 v104, 0
  v_mov_b32 v105, 0
  v_mov_b32 v106, 0
  v_mov_b32 v107, 0
  v_mov_b32 v108, 0
  v_mov_b32 v109, 0
  v_mov_b32 v110, 0
  v_mov_b32 v111, 0
  v_mov_b32 v112, 0
  v_mov_b32 v113, 0
  v_mov_b32 v114, 0
  v_mov_b32 v115, 0
  v_mov_b32 v116, 0
  v_mov_b32 v117, 0
  v_mov_b32 v118, 0
  v_mov_b32 v119, 0
  v_mov_b32 v120, 0
  v_mov_b32 v121, 0
  v_mov_b32 v122, 0
  v_mov_b32 v123, 0
  v_mov_b32 v124, 0
  v_mov_b32 v125, 0
  v_mov_b32 v126, 0
  v_mov_b32 v127, 0
  s_lshl_b32 s32, s44, 7
  s_add_u32 s32, s32, 155648
  v_lshrrev_b32 v4, 5, v1
  v_lshl_add_u32 v10, v4, 4, s32
  v_and_b32 v3, 31, v1
  s_lshl_b32 s32, s43, 8
  s_add_u32 s32, s32, 156160
  v_lshl_add_u32 v11, v3, 3, s32
  s_lshl_b32 s32, s34, 9
  s_add_u32 s32, s32, 157696
  v_lshl_add_u32 v12, v1, 3, s32
  s_mov_b32 s46, 0xc0135761
  v_mov_b32 v14, 0xbdd2d3e8
  v_bfe_u32 v13, v1, 4, 1
  v_lshlrev_b32 v13, 9, v13
  v_bfe_u32 v3, v1, 2, 1
  v_lshl_add_u32 v13, v3, 8, v13
  v_bfe_u32 v3, v1, 3, 1
  v_lshl_add_u32 v13, v3, 7, v13
  v_lshl_add_u32 v13, v4, 6, v13
  v_and_b32 v3, 3, v1
  v_lshl_add_u32 v13, v3, 4, v13
  s_lshl_b32 s52, s42, 1
  s_add_u32 s52, s52, s44
  s_lshl_b32 s52, s52, 1
  s_add_u32 s32, s52, 0
  s_mul_i32 s33, s32, 37
  s_lshr_b32 s33, s33, 8
  s_mul_i32 s50, s33, 441
  s_add_u32 s50, s50, s32
  s_mul_i32 s33, s45, 7
  s_add_u32 s50, s50, s33
  s_lshl_b32 s50, s50, 10
  s_add_u32 s50, s50, 0xe00000
  s_add_u32 s32, s52, 1
  s_mul_i32 s33, s32, 37
  s_lshr_b32 s33, s33, 8
  s_mul_i32 s51, s33, 441
  s_add_u32 s51, s51, s32
  s_mul_i32 s33, s45, 7
  s_add_u32 s51, s51, s33
  s_lshl_b32 s51, s51, 10
  s_add_u32 s51, s51, 0xe00000
  s_mul_i32 s32, s45, 56
  s_add_u32 s52, s52, s32
  s_lshl_b32 s52, s52, 10
  s_add_u32 s52, s52, 0xa00000
  s_mul_i32 s47, s45, 7168
  s_add_u32 s47, s47, 0x1600000
  s_add_u32 s48, s47, 4096
  s_lshl_b32 s53, s42, 9
  s_add_u32 s53, s53, s47
  s_lshl_b32 s49, s42, 4
  s_add_u32 s49, s49, s41
  s_add_u32 s49, s49, 6144
  v_mov_b32 v22, s38
  v_mov_b32 v23, s39
  s_cmp_lg_u32 s34, 0
  s_cbranch_scc1 L_sequential_preLN__mha_block__mixer_gmlp__prompt_kernel_p4c_nopoll
  s_lshl_b32 s32, s41, 4
  s_add_u32 s32, s32, 4096
  s_and_b32 s33, s42, 3
  s_lshl_b32 s33, s33, 8
  s_add_u32 s32, s32, s33
  s_lshl_b32 s32, s32, 7
  s_add_u32 s32, s32, 0x1700000
  v_min_u32 v3, 15, v1
  v_lshlrev_b32 v3, 7, v3
  s_mov_b32 s37, 100000
  s_mov_b64 exec, 0xffff
  s_branch L_sequential_preLN__mha_block__mixer_gmlp__prompt_kernel_p4c_pollg
L_sequential_preLN__mha_block__mixer_gmlp__prompt_kernel_p4c_poll:
  s_sleep 2
L_sequential_preLN__mha_block__mixer_gmlp__prompt_kernel_p4c_pollg:
  buffer_load_dwordx2 v[6:7], v3, s[28:31], s32 offen sc1
  s_sub_u32 s37, s37, 1
  s_cbranch_scc1 L_sequential_preLN__mha_block__mixer_gmlp__prompt_kernel_p4c_pollx
  s_waitcnt vmcnt(0)
  v_cmp_ne_u64 vcc, s[38:39], v[6:7]
  s_and_b64 exec, exec, vcc
  s_cbranch_scc1 L_sequential_preLN__mha_block__mixer_gmlp__prompt_kernel_p4c_poll
L_sequential_preLN__mha_block__mixer_gmlp__prompt_kernel_p4c_pollx:
  s_mov_b64 exec, -1
L_sequential_preLN__mha_block__mixer_gmlp__prompt_kernel_p4c_nopoll:
  s_barrier
  s_barrier
  ds_read_b128 v[64:67], v9 offset:0
  ds_read_b64_tr_b16 v[32:33], v8 offset:0
  ds_read_b64_tr_b16 v[34:35], v8 offset:512
  ds_read_b128 v[68:71], v9 offset:1024
  ds_read_b64_tr_b16 v[36:37], v8 offset:2048
  ds_read_b64_tr_b16 v[38:39], v8 offset:2560
  ds_read_b128 v[72:75], v9 offset:2048
  ds_read_b64_tr_b16 v[40:41], v8 offset:4096
  ds_read_b64_tr_b16 v[42:43], v8 offset:4608
  ds_read_b128 v[76:79], v9 offset:3072
  ds_read_b64_tr_b16 v[44:45], v8 offset:6144
  ds_read_b64_tr_b16 v[46:47], v8 offset:6656
  s_barrier
  s_waitcnt lgkmcnt(0)
  v_mfma_f32_32x32x16_bf16 v[96:111], v[32:35], v[64:67], v[96:111]
  ds_read_b128 v[80:83], v9 offset:16384
  ds_read_b64_tr_b16 v[48:49], v8 offset:8192
  ds_read_b64_tr_b16 v[50:51], v8 offset:8704
  v_mfma_f32_32x32x16_bf16 v[96:111], v[36:39], v[68:71], v[96:111]
  ds_read_b128 v[84:87], v9 offset:17408
  ds_read_b64_tr_b16 v[52:53], v8 offset:10240
  ds_read_b64_tr_b16 v[54:55], v8 offset:10752
  v_mfma_f32_32x32x16_bf16 v[96:111], v[40:43], v[72:75], v[96:111]
  ds_read_b128 v[88:91], v9 offset:18432
  ds_read_b64_tr_b16 v[56:57], v8 offset:12288
  ds_read_b64_tr_b16 v[58:59], v8 offset:12800
  v_mfma_f32_32x32x16_bf16 v[96:111], v[44:47], v[76:79], v[96:111]
  ds_read_b128 v[92:95], v9 offset:19456
  ds_read_b64_tr_b16 v[60:61], v8 offset:14336
  ds_read_b64_tr_b16 v[62:63], v8 offset:14848
  s_barrier
  s_waitcnt lgkmcnt(0)
  v_mfma_f32_32x32x16_bf16 v[96:111], v[48:51], v[80:83], v[96:111]
  ds_read_b128 v[64:67], v9 offset:32768
  ds_read_b64_tr_b16 v[32:33], v8 offset:16384
  ds_read_b64_tr_b16 v[34:35], v8 offset:16896
  v_mfma_f32_32x32x16_bf16 v[96:111], v[52:55], v[84:87], v[96:111]
  ds_read_b128 v[68:71], v9 offset:33792
  ds_read_b64_tr_b16 v[36:37], v8 offset:18432
  ds_read_b64_tr_b16 v[38:39], v8 offset:18944
  v_mfma_f32_32x32x16_bf16 v[96:111], v[56:59], v[88:91], v[96:111]
  ds_read_b128 v[72:75], v9 offset:34816
  ds_read_b64_tr_b16 v[40:41], v8 offset:20480
  ds_read_b64_tr_b16 v[42:43], v8 offset:20992
  v_mfma_f32_32x32x16_bf16 v[96:111], v[60:63], v[92:95], v[96:111]
  ds_read_b128 v[76:79], v9 offset:35840
  ds_read_b64_tr_b16 v[44:45], v8 offset:22528
  ds_read_b64_tr_b16 v[46:47], v8 offset:23040
  s_barrier
  s_waitcnt lgkmcnt(0)
  v_mfma_f32_32x32x16_bf16 v[96:111], v[32:35], v[64:67], v[96:111]
  ds_read_b128 v[80:83], v9 offset:49152
  ds_read_b64_tr_b16 v[48:49], v8 offset:0
  ds_read_b64_tr_b16 v[50:51], v8 offset:512
  v_mfma_f32_32x32x16_bf16 v[96:111], v[36:39], v[68:71], v[96:111]
  ds_read_b128 v[84:87], v9 offset:50176
  ds_read_b64_tr_b16 v[52:53], v8 offset:2048
  ds_read_b64_tr_b16 v[54:55], v8 offset:2560
  v_mfma_f32_32x32x16_bf16 v[96:111], v[40:43], v[72:75], v[96:111]
  ds_read_b128 v[88:91], v9 offset:51200
  ds_read_b64_tr_b16 v[56:57], v8 offset:4096
  ds_read_b64_tr_b16 v[58:59], v8 offset:4608
  v_mfma_f32_32x32x16_bf16 v[96:111], v[44:47], v[76:79], v[96:111]
  ds_read_b128 v[92:95], v9 offset:52224
  ds_read_b64_tr_b16 v[60:61], v8 offset:6144
  ds_read_b64_tr_b16 v[62:63], v8 offset:6656
  s_barrier
  s_waitcnt lgkmcnt(0)
  v_mfma_f32_32x32x16_bf16 v[96:111], v[48:51], v[80:83], v[96:111]
  ds_read_b128 v[64:67], v28 offset:0
  ds_read_b64_tr_b16 v[32:33], v8 offset:8192
  ds_read_b64_tr_b16 v[34:35], v8 offset:8704
  v_mfma_f32_32x32x16_bf16 v[96:111], v[52:55], v[84:87], v[96:111]
  ds_read_b128 v[68:71], v28 offset:1024
  ds_read_b64_tr_b16 v[36:37], v8 offset:10240
  ds_read_b64_tr_b16 v[38:39], v8 offset:10752
  v_mfma_f32_32x32x16_bf16 v[96:111], v[56:59], v[88:91], v[96:111]
  ds_read_b128 v[72:75], v28 offset:2048
  ds_read_b64_tr_b16 v[40:41], v8 offset:12288
  ds_read_b64_tr_b16 v[42:43], v8 offset:12800
  v_mfma_f32_32x32x16_bf16 v[96:111], v[60:63], v[92:95], v[96:111]
  ds_read_b128 v[76:79], v28 offset:3072
  ds_read_b64_tr_b16 v[44:45], v8 offset:14336
  ds_read_b64_tr_b16 v[46:47], v8 offset:14848
  s_barrier
  s_waitcnt lgkmcnt(0)
  v_mfma_f32_32x32x16_bf16 v[96:111], v[32:35], v[64:67], v[96:111]
  ds_read_b128 v[80:83], v28 offset:16384
  ds_read_b64_tr_b16 v[48:49], v8 offset:16384
  ds_read_b64_tr_b16 v[50:51], v8 offset:16896
  v_mfma_f32_32x32x16_bf16 v[96:111], v[36:39], v[68:71], v[96:111]
  ds_read_b128 v[84:87], v28 offset:17408
  ds_read_b64_tr_b16 v[52:53], v8 offset:18432
  ds_read_b64_tr_b16 v[54:55], v8 offset:18944
  v_mfma_f32_32x32x16_bf16 v[96:111], v[40:43], v[72:75], v[96:111]
  ds_read_b128 v[88:91], v28 offset:18432
  ds_read_b64_tr_b16 v[56:57], v8 offset:20480
  ds_read_b64_tr_b16 v[58:59], v8 offset:20992
  v_mfma_f32_32x32x16_bf16 v[96:111], v[44:47], v[76:79], v[96:111]
  ds_read_b128 v[92:95], v28 offset:19456
  ds_read_b64_tr_b16 v[60:61], v8 offset:22528
  ds_read_b64_tr_b16 v[62:63], v8 offset:23040
  s_barrier
  s_waitcnt lgkmcnt(0)
  v_mfma_f32_32x32x16_bf16 v[96:111], v[48:51], v[80:83], v[96:111]
  ds_read_b128 v[64:67], v28 offset:32768
  ds_read_b64_tr_b16 v[32:33], v8 offset:0
  ds_read_b64_tr_b16 v[34:35], v8 offset:512
  v_mfma_f32_32x32x16_bf16 v[96:111], v[52:55], v[84:87], v[96:111]
  ds_read_b128 v[68:71], v28 offset:33792
  ds_read_b64_tr_b16 v[36:37], v8 offset:2048
  ds_read_b64_tr_b16 v[38:39], v8 offset:2560
  v_mfma_f32_32x32x16_bf16 v[96:111], v[56:59], v[88:91], v[96:111]
  ds_read_b128 v[72:75], v28 offset:34816
  ds_read_b64_tr_b16 v[40:41], v8 offset:4096
  ds_read_b64_tr_b16 v[42:43], v8 offset:4608
  v_mfma_f32_32x32x16_bf16 v[96:111], v[60:63], v[92:95], v[96:111]
  ds_read_b128 v[76:79], v28 offset:35840
  ds_read_b64_tr_b16 v[44:45], v8 offset:6144
  ds_read_b64_tr_b16 v[46:47], v8 offset:6656
  s_barrier
  s_waitcnt lgkmcnt(0)
  v_mfma_f32_32x32x16_bf16 v[96:111], v[32:35], v[64:67], v[96:111]
  ds_read_b128 v[80:83], v28 offset:49152
  ds_read_b64_tr_b16 v[48:49], v8 offset:8192
  ds_read_b64_tr_b16 v[50:51], v8 offset:8704
  v_mfma_f32_32x32x16_bf16 v[96:111], v[36:39], v[68:71], v[96:111]
  ds_read_b128 v[84:87], v28 offset:50176
  ds_read_b64_tr_b16 v[52:53], v8 offset:10240
  ds_read_b64_tr_b16 v[54:55], v8 offset:10752
  v_mfma_f32_32x32x16_bf16 v[96:111], v[40:43], v[72:75], v[96:111]
  ds_read_b128 v[88:91], v28 offset:51200
  ds_read_b64_tr_b16 v[56:57], v8 offset:12288
  ds_read_b64_tr_b16 v[58:59], v8 offset:12800
  v_mfma_f32_32x32x16_bf16 v[96:111], v[44:47], v[76:79], v[96:111]
  ds_read_b128 v[92:95], v28 offset:52224
  ds_read_b64_tr_b16 v[60:61], v8 offset:14336
  ds_read_b64_tr_b16 v[62:63], v8 offset:14848
  s_barrier
  s_waitcnt lgkmcnt(0)
  v_mfma_f32_32x32x16_bf16 v[96:111], v[48:51], v[80:83], v[96:111]
  ds_read_b128 v[64:67], v9 offset:0
  ds_read_b64_tr_b16 v[32:33], v8 offset:16384
  ds_read_b64_tr_b16 v[34:35], v8 offset:16896
  v_mfma_f32_32x32x16_bf16 v[96:111], v[52:55], v[84:87], v[96:111]
  ds_read_b128 v[68:71], v9 offset:1024
  ds_read_b64_tr_b16 v[36:37], v8 offset:18432
  ds_read_b64_tr_b16 v[38:39], v8 offset:18944
  v_mfma_f32_32x32x16_bf16 v[96:111], v[56:59], v[88:91], v[96:111]
  ds_read_b128 v[72:75], v9 offset:2048
  ds_read_b64_tr_b16 v[40:41], v8 offset:20480
  ds_read_b64_tr_b16 v[42:43], v8 offset:20992
  v_mfma_f32_32x32x16_bf16 v[96:111], v[60:63], v[92:95], v[96:111]
  ds_read_b128 v[76:79], v9 offset:3072
  ds_read_b64_tr_b16 v[44:45], v8 offset:22528
  ds_read_b64_tr_b16 v[46:47], v8 offset:23040
  ds_read_b64 v[16:17], v11
  ds_read_b128 v[128:131], v10 offset:0
  ds_read_b128 v[132:135], v10 offset:32
  ds_read_b128 v[136:139], v10 offset:64
  ds_read_b128 v[140:143], v10 offset:96
  s_waitcnt lgkmcnt(0)
  s_nop 7
  s_barrier
  s_waitcnt lgkmcnt(0)
  v_mfma_f32_32x32x16_bf16 v[112:127], v[32:35], v[64:67], v[112:127]
  ds_read_b128 v[80:83], v9 offset:16384
  ds_read_b64_tr_b16 v[48:49], v8 offset:0
  ds_read_b64_tr_b16 v[50:51], v8 offset:512
  v_mul_f32 v96, v96, v16
  v_fmac_f32 v96, v128, v17
  v_mul_f32 v97, v97, v16
  v_fmac_f32 v97, v129, v17
  v_mul_f32 v98, v98, v16
  v_fmac_f32 v98, v130, v17
  v_mul_f32 v99, v99, v16
  v_fmac_f32 v99, v131, v17
  v_mul_f32 v100, v100, v16
  v_fmac_f32 v100, v132, v17
  v_mul_f32 v101, v101, v16
  v_fmac_f32 v101, v133, v17
  v_mul_f32 v102, v102, v16
  v_fmac_f32 v102, v134, v17
  v_mfma_f32_32x32x16_bf16 v[112:127], v[36:39], v[68:71], v[112:127]
  ds_read_b128 v[84:87], v9 offset:17408
  ds_read_b64_tr_b16 v[52:53], v8 offset:2048
  ds_read_b64_tr_b16 v[54:55], v8 offset:2560
  v_mul_f32 v103, v103, v16
  v_fmac_f32 v103, v135, v17
  v_mul_f32 v104, v104, v16
  v_fmac_f32 v104, v136, v17
  v_mul_f32 v105, v105, v16
  v_fmac_f32 v105, v137, v17
  v_mul_f32 v106, v106, v16
  v_fmac_f32 v106, v138, v17
  v_mul_f32 v107, v107, v16
  v_fmac_f32 v107, v139, v17
  v_mul_f32 v108, v108, v16
  v_fmac_f32 v108, v140, v17
  v_mul_f32 v109, v109, v16
  v_fmac_f32 v109, v141, v17
  v_mfma_f32_32x32x16_bf16 v[112:127], v[40:43], v[72:75], v[112:127]
  ds_read_b128 v[88:91], v9 offset:18432
  ds_read_b64_tr_b16 v[56:57], v8 offset:4096
  ds_read_b64_tr_b16 v[58:59], v8 offset:4608
  v_mul_f32 v110, v110, v16
  v_fmac_f32 v110, v142, v17
  v_mul_f32 v111, v111, v16
  v_fmac_f32 v111, v143, v17
  v_mul_f32 v144, v96, v96
  v_mul_f32 v145, v97, v97
  v_mul_f32 v146, v98, v98
  v_mul_f32 v147, v99, v99
  v_mul_f32 v148, v100, v100
  v_mul_f32 v149, v101, v101
  v_mul_f32 v150, v102, v102
  v_mul_f32 v151, v103, v103
  v_mul_f32 v152, v104, v104
  v_mul_f32 v153, v105, v105
  v_mfma_f32_32x32x16_bf16 v[112:127], v[44:47], v[76:79], v[112:127]
  ds_read_b128 v[92:95], v9 offset:19456
  ds_read_b64_tr_b16 v[60:61], v8 offset:6144
  ds_read_b64_tr_b16 v[62:63], v8 offset:6656
  v_mul_f32 v154, v106, v106
  v_mul_f32 v155, v107, v107
  v_mul_f32 v156, v108, v108
  v_mul_f32 v157, v109, v109
  v_mul_f32 v158, v110, v110
  v_mul_f32 v159, v111, v111
  v_fma_f32 v144, v144, v14, s46
  v_fma_f32 v145, v145, v14, s46
  v_fma_f32 v146, v146, v14, s46
  v_fma_f32 v147, v147, v14, s46
  v_fma_f32 v148, v148, v14, s46
  s_barrier
  s_waitcnt lgkmcnt(0)
  v_mfma_f32_32x32x16_bf16 v[112:127], v[48:51], v[80:83], v[112:127]
  ds_read_b128 v[64:67], v9 offset:32768
  ds_read_b64_tr_b16 v[32:33], v8 offset:8192
  ds_read_b64_tr_b16 v[34:35], v8 offset:8704
  v_fma_f32 v149, v149, v14, s46
  v_fma_f32 v150, v150, v14, s46
  v_fma_f32 v151, v151, v14, s46
  v_fma_f32 v152, v152, v14, s46
  v_fma_f32 v153, v153, v14, s46
  v_fma_f32 v154, v154, v14, s46
  v_fma_f32 v155, v155, v14, s46
  v_fma_f32 v156, v156, v14, s46
  v_fma_f32 v157, v157, v14, s46
  v_fma_f32 v158, v158, v14, s46
  v_mfma_f32_32x32x16_bf16 v[112:127], v[52:55], v[84:87], v[112:127]
  ds_read_b128 v[68:71], v9 offset:33792
  ds_read_b64_tr_b16 v[36:37], v8 offset:10240
  ds_read_b64_tr_b16 v[38:39], v8 offset:10752
  v_fma_f32 v159, v159, v14, s46
  v_mul_f32 v144, v144, v96
  v_mul_f32 v145, v145, v97
  v_mul_f32 v146, v146, v98
  v_mul_f32 v147, v147, v99
  v_mul_f32 v148, v148, v100
  v_mul_f32 v149, v149, v101
  v_mul_f32 v150, v150, v102
  v_mul_f32 v151, v151, v103
  v_mul_f32 v152, v152, v104
  v_mfma_f32_32x32x16_bf16 v[112:127], v[56:59], v[88:91], v[112:127]
  ds_read_b128 v[72:75], v9 offset:34816
  ds_read_b64_tr_b16 v[40:41], v8 offset:12288
  ds_read_b64_tr_b16 v[42:43], v8 offset:12800
  v_mul_f32 v153, v153, v105
  v_mul_f32 v154, v154, v106
  v_mul_f32 v155, v155, v107
  v_mul_f32 v156, v156, v108
  v_mul_f32 v157, v157, v109
  v_mul_f32 v158, v158, v110
  v_mul_f32 v159, v159, v111
  v_exp_f32 v144, v144
  v_exp_f32 v145, v145
  v_exp_f32 v146, v146
  v_mfma_f32_32x32x16_bf16 v[112:127], v[60:63], v[92:95], v[112:127]
  ds_read_b128 v[76:79], v9 offset:35840
  ds_read_b64_tr_b16 v[44:45], v8 offset:14336
  ds_read_b64_tr_b16 v[46:47], v8 offset:14848
  v_exp_f32 v147, v147
  v_exp_f32 v148, v148
  v_exp_f32 v149, v149
  v_exp_f32 v150, v150
  v_exp_f32 v151, v151
  v_exp_f32 v152, v152
  v_exp_f32 v153, v153
  v_exp_f32 v154, v154
  v_exp_f32 v155, v155
  v_exp_f32 v156, v156
  s_barrier
  s_waitcnt lgkmcnt(0)
  v_mfma_f32_32x32x16_bf16 v[112:127], v[32:35], v[64:67], v[112:127]
  ds_read_b128 v[80:83], v9 offset:49152
  ds_read_b64_tr_b16 v[48:49], v8 offset:16384
  ds_read_b64_tr_b16 v[50:51], v8 offset:16896
  v_exp_f32 v157, v157
  v_exp_f32 v158, v158
  v_exp_f32 v159, v159
  v_add_f32 v144, 1.0, v144
  v_add_f32 v145, 1.0, v145
  v_add_f32 v146, 1.0, v146
  v_add_f32 v147, 1.0, v147
  v_add_f32 v148, 1.0, v148
  v_add_f32 v149, 1.0, v149
  v_mfma_f32_32x32x16_bf16 v[112:127], v[36:39], v[68:71], v[112:127]
  ds_read_b128 v[84:87], v9 offset:50176
  ds_read_b64_tr_b16 v[52:53], v8 offset:18432
  ds_read_b64_tr_b16 v[54:55], v8 offset:18944
  v_add_f32 v150, 1.0, v150
  v_add_f32 v151, 1.0, v151
  v_add_f32 v152, 1.0, v152
  v_add_f32 v153, 1.0, v153
  v_add_f32 v154, 1.0, v154
  v_add_f32 v155, 1.0, v155
  v_add_f32 v156, 1.0, v156
  v_add_f32 v157, 1.0, v157
  v_add_f32 v158, 1.0, v158
  v_mfma_f32_32x32x16_bf16 v[112:127], v[40:43], v[72:75], v[112:127]
  ds_read_b128 v[88:91], v9 offset:51200
  ds_read_b64_tr_b16 v[56:57], v8 offset:20480
  ds_read_b64_tr_b16 v[58:59], v8 offset:20992
  v_add_f32 v159, 1.0, v159
  v_rcp_f32 v144, v144
  v_rcp_f32 v145, v145
  v_rcp_f32 v146, v146
  v_rcp_f32 v147, v147
  v_rcp_f32 v148, v148
  v_rcp_f32 v149, v149
  v_rcp_f32 v150, v150
  v_rcp_f32 v151, v151
  v_mfma_f32_32x32x16_bf16 v[112:127], v[44:47], v[76:79], v[112:127]
  ds_read_b128 v[92:95], v9 offset:52224
  ds_read_b64_tr_b16 v[60:61], v8 offset:22528
  ds_read_b64_tr_b16 v[62:63], v8 offset:23040
  v_rcp_f32 v152, v152
  v_rcp_f32 v153, v153
  v_rcp_f32 v154, v154
  v_rcp_f32 v155, v155
  v_rcp_f32 v156, v156
  v_rcp_f32 v157, v157
  v_rcp_f32 v158, v158
  s_barrier
  s_waitcnt lgkmcnt(0)
  v_mfma_f32_32x32x16_bf16 v[112:127], v[48:51], v[80:83], v[112:127]
  ds_read_b128 v[64:67], v28 offset:0
  ds_read_b64_tr_b16 v[32:33], v8 offset:0
  ds_read_b64_tr_b16 v[34:35], v8 offset:512
  v_rcp_f32 v159, v159
  v_mul_f32 v96, v96, v144
  v_mul_f32 v97, v97, v145
  v_mul_f32 v98, v98, v146
  v_mul_f32 v99, v99, v147
  v_mul_f32 v100, v100, v148
  v_mul_f32 v101, v101, v149
  v_mul_f32 v102, v102, v150
  v_mul_f32 v103, v103, v151
  v_mul_f32 v104, v104, v152
  v_mul_f32 v105, v105, v153
  v_mul_f32 v106, v106, v154
  v_mul_f32 v107, v107, v155
  v_mfma_f32_32x32x16_bf16 v[112:127], v[52:55], v[84:87], v[112:127]
  ds_read_b128 v[68:71], v28 offset:1024
  ds_read_b64_tr_b16 v[36:37], v8 offset:2048
  ds_read_b64_tr_b16 v[38:39], v8 offset:2560
  v_mul_f32 v108, v108, v156
  v_mul_f32 v109, v109, v157
  v_mul_f32 v110, v110, v158
  v_mul_f32 v111, v111, v159
  v_add_f32 v24, v96, v98
  v_mul_f32 v25, v96, v96
  v_add_f32 v26, v97, v99
  v_mul_f32 v27, v97, v97
  v_fmac_f32 v25, v98, v98
  v_fmac_f32 v27, v99, v99
  v_add_f32 v24, v24, v100
  v_fmac_f32 v25, v100, v100
  v_add_f32 v26, v26, v101
  v_mfma_f32_32x32x16_bf16 v[112:127], v[56:59], v[88:91], v[112:127]
  ds_read_b128 v[72:75], v28 offset:2048
  ds_read_b64_tr_b16 v[40:41], v8 offset:4096
  ds_read_b64_tr_b16 v[42:43], v8 offset:4608
  v_fmac_f32 v27, v101, v101
  v_add_f32 v24, v24, v102
  v_fmac_f32 v25, v102, v102
  v_add_f32 v26, v26, v103
  v_fmac_f32 v27, v103, v103
  v_add_f32 v24, v24, v104
  v_fmac_f32 v25, v104, v104
  v_add_f32 v26, v26, v105
  v_fmac_f32 v27, v105, v105
  v_add_f32 v24, v24, v106
  v_fmac_f32 v25, v106, v106
  v_add_f32 v26, v26, v107
  v_fmac_f32 v27, v107, v107
  v_mfma_f32_32x32x16_bf16 v[112:127], v[60:63], v[92:95], v[112:127]
  ds_read_b128 v[76:79], v28 offset:3072
  ds_read_b64_tr_b16 v[44:45], v8 offset:6144
  ds_read_b64_tr_b16 v[46:47], v8 offset:6656
  v_add_f32 v24, v24, v108
  v_fmac_f32 v25, v108, v108
  v_add_f32 v26, v26, v109
  v_fmac_f32 v27, v109, v109
  v_add_f32 v24, v24, v110
  v_fmac_f32 v25, v110, v110
  v_add_f32 v26, v26, v111
  v_fmac_f32 v27, v111, v111
  v_add_f32 v24, v24, v26
  v_add_f32 v25, v25, v27
  ds_write_b64 v12, v[24:25]
  s_waitcnt lgkmcnt(0)
  s_barrier
  s_waitcnt lgkmcnt(0)
  v_mfma_f32_32x32x16_bf16 v[112:127], v[32:35], v[64:67], v[112:127]
  ds_read_b64 v[26:27], v12 offset:2048
  ds_read_b128 v[80:83], v28 offset:16384
  ds_read_b64_tr_b16 v[48:49], v8 offset:8192
  v_mfma_f32_32x32x16_bf16 v[112:127], v[36:39], v[68:71], v[112:127]
  ds_read_b64_tr_b16 v[50:51], v8 offset:8704
  ds_read_b128 v[84:87], v28 offset:17408
  ds_read_b64_tr_b16 v[52:53], v8 offset:10240
  v_mfma_f32_32x32x16_bf16 v[112:127], v[40:43], v[72:75], v[112:127]
  ds_read_b64_tr_b16 v[54:55], v8 offset:10752
  ds_read_b128 v[88:91], v28 offset:18432
  ds_read_b64_tr_b16 v[56:57], v8 offset:12288
  v_mfma_f32_32x32x16_bf16 v[112:127], v[44:47], v[76:79], v[112:127]
  ds_read_b64_tr_b16 v[58:59], v8 offset:12800
  ds_read_b128 v[92:95], v28 offset:19456
  ds_read_b64_tr_b16 v[60:61], v8 offset:14336
  ds_read_b64_tr_b16 v[62:63], v8 offset:14848
  s_waitcnt lgkmcnt(4)
  s_cmp_lg_u32 s44, 0
  s_cbranch_scc1 L_sequential_preLN__mha_block__mixer_gmlp__prompt_kernel_p4c_nopub
  v_add_f32 v20, v24, v26
  v_add_f32 v21, v25, v27
  v_mov_b32 v3, v20
  v_mov_b32 v4, v21
  s_nop 1
  v_permlane32_swap_b32 v3, v20
  v_permlane32_swap_b32 v4, v21
  s_nop 1
  v_add_f32 v20, v20, v3
  v_add_f32 v21, v21, v4
  s_mov_b32 exec_hi, 0
  buffer_store_dwordx4 v[20:23], v2, s[28:31], s53 offen sc1
  s_mov_b32 exec_hi, -1
L_sequential_preLN__mha_block__mixer_gmlp__prompt_kernel_p4c_nopub:
  s_barrier
  s_waitcnt lgkmcnt(0)
  v_mfma_f32_32x32x16_bf16 v[112:127], v[48:51], v[80:83], v[112:127]
  ds_read_b128 v[64:67], v28 offset:32768
  ds_read_b64_tr_b16 v[32:33], v8 offset:16384
  ds_read_b64_tr_b16 v[34:35], v8 offset:16896
  v_mfma_f32_32x32x16_bf16 v[112:127], v[52:55], v[84:87], v[112:127]
  ds_read_b128 v[68:71], v28 offset:33792
  ds_read_b64_tr_b16 v[36:37], v8 offset:18432
  ds_read_b64_tr_b16 v[38:39], v8 offset:18944
  v_mfma_f32_32x32x16_bf16 v[112:127], v[56:59], v[88:91], v[112:127]
  ds_read_b128 v[72:75], v28 offset:34816
  ds_read_b64_tr_b16 v[40:41], v8 offset:20480
  ds_read_b64_tr_b16 v[42:43], v8 offset:20992
  v_mfma_f32_32x32x16_bf16 v[112:127], v[60:63], v[92:95], v[112:127]
  ds_read_b128 v[76:79], v28 offset:35840
  ds_read_b64_tr_b16 v[44:45], v8 offset:22528
  ds_read_b64_tr_b16 v[46:47], v8 offset:23040
  s_barrier
  s_waitcnt lgkmcnt(0)
  v_mfma_f32_32x32x16_bf16 v[112:127], v[32:35], v[64:67], v[112:127]
  ds_read_b128 v[80:83], v28 offset:49152
  ds_read_b64_tr_b16 v[48:49], v8 offset:0
  ds_read_b64_tr_b16 v[50:51], v8 offset:512
  v_mfma_f32_32x32x16_bf16 v[112:127], v[36:39], v[68:71], v[112:127]
  ds_read_b128 v[84:87], v28 offset:50176
  ds_read_b64_tr_b16 v[52:53], v8 offset:2048
  ds_read_b64_tr_b16 v[54:55], v8 offset:2560
  v_mfma_f32_32x32x16_bf16 v[112:127], v[40:43], v[72:75], v[112:127]
  ds_read_b128 v[88:91], v28 offset:51200
  ds_read_b64_tr_b16 v[56:57], v8 offset:4096
  ds_read_b64_tr_b16 v[58:59], v8 offset:4608
  v_mfma_f32_32x32x16_bf16 v[112:127], v[44:47], v[76:79], v[112:127]
  ds_read_b128 v[92:95], v28 offset:52224
  ds_read_b64_tr_b16 v[60:61], v8 offset:6144
  ds_read_b64_tr_b16 v[62:63], v8 offset:6656
  s_waitcnt lgkmcnt(0)
  v_mfma_f32_32x32x16_bf16 v[112:127], v[48:51], v[80:83], v[112:127]
  v_mfma_f32_32x32x16_bf16 v[112:127], v[52:55], v[84:87], v[112:127]
  v_mfma_f32_32x32x16_bf16 v[112:127], v[56:59], v[88:91], v[112:127]
  v_mfma_f32_32x32x16_bf16 v[112:127], v[60:63], v[92:95], v[112:127]
  buffer_load_dwordx4 v[128:131], v2, s[28:31], s47 offen offset:0 sc1
  buffer_load_dwordx4 v[132:135], v2, s[28:31], s47 offen offset:1024 sc1
  buffer_load_dwordx4 v[136:139], v2, s[28:31], s47 offen offset:2048 sc1
  buffer_load_dwordx4 v[140:143], v2, s[28:31], s47 offen offset:3072 sc1
  buffer_load_dwordx4 v[144:147], v2, s[28:31], s48 offen offset:0 sc1
  buffer_load_dwordx4 v[148:151], v2, s[28:31], s48 offen offset:1024 sc1
  buffer_load_dwordx4 v[152:155], v2, s[28:31], s48 offen offset:2048 sc1
L_sequential_preLN__mha_block__mixer_gmlp__prompt_kernel_p4c_nogl:
  s_setprio 1
  s_lshl_b32 s32, s34, 11
  s_add_u32 s32, s32, 131072
  v_add_u32 v13, s32, v13
  v_lshrrev_b32 v3, 5, v1
  v_lshl_add_u32 v12, v3, 9, s32
  v_bfe_u32 v3, v1, 4, 1
  v_lshl_add_u32 v12, v3, 7, v12
  v_bfe_u32 v3, v1, 0, 1
  v_lshl_add_u32 v12, v3, 6, v12
  v_bfe_u32 v3, v1, 2, 2
  v_lshl_add_u32 v12, v3, 4, v12
  v_bfe_u32 v3, v1, 1, 1
  v_lshl_add_u32 v12, v3, 3, v12
  s_barrier
  ds_read_b128 v[32:35], v10 offset:256
  ds_read_b128 v[36:39], v10 offset:288
  ds_read_b128 v[40:43], v10 offset:320
  ds_read_b128 v[44:47], v10 offset:352
  s_mov_b32 s37, 100000
  s_branch L_sequential_preLN__mha_block__mixer_gmlp__prompt_kernel_p4c_chk
L_sequential_preLN__mha_block__mixer_gmlp__prompt_kernel_p4c_spoll:
  s_sleep 2
  s_mov_b64 exec, s[54:55]
  s_cbranch_execz L_sequential_preLN__mha_block__mixer_gmlp__prompt_kernel_p4c_sk0
  buffer_load_dwordx4 v[128:131], v2, s[28:31], s47 offen offset:0 sc1
L_sequential_preLN__mha_block__mixer_gmlp__prompt_kernel_p4c_sk0:
  s_mov_b64 exec, s[56:57]
  s_cbranch_execz L_sequential_preLN__mha_block__mixer_gmlp__prompt_kernel_p4c_sk1
  buffer_load_dwordx4 v[132:135], v2, s[28:31], s47 offen offset:1024 sc1
L_sequential_preLN__mha_block__mixer_gmlp__prompt_kernel_p4c_sk1:
  s_mov_b64 exec, s[58:59]
  s_cbranch_execz L_sequential_preLN__mha_block__mixer_gmlp__prompt_kernel_p4c_sk2
  buffer_load_dwordx4 v[136:139], v2, s[28:31], s47 offen offset:2048 sc1
L_sequential_preLN__mha_block__mixer_gmlp__prompt_kernel_p4c_sk2:
  s_mov_b64 exec, s[60:61]
  s_cbranch_execz L_sequential_preLN__mha_block__mixer_gmlp__prompt_kernel_p4c_sk3
  buffer_load_dwordx4 v[140:143], v2, s[28:31], s47 offen offset:3072 sc1
L_sequential_preLN__mha_block__mixer_gmlp__prompt_kernel_p4c_sk3:
  s_mov_b64 exec, s[62:63]
  s_cbranch_execz L_sequential_preLN__mha_block__mixer_gmlp__prompt_kernel_p4c_sk4
  buffer_load_dwordx4 v[144:147], v2, s[28:31], s48 offen offset:0 sc1
L_sequential_preLN__mha_block__mixer_gmlp__prompt_kernel_p4c_sk4:
  s_mov_b64 exec, s[64:65]
  s_cbranch_execz L_sequential_preLN__mha_block__mixer_gmlp__prompt_kernel_p4c_sk5
  buffer_load_dwordx4 v[148:151], v2, s[28:31], s48 offen offset:1024 sc1
L_sequential_preLN__mha_block__mixer_gmlp__prompt_kernel_p4c_sk5:
  s_mov_b64 exec, s[66:67]
  s_cbranch_execz L_sequential_preLN__mha_block__mixer_gmlp__prompt_kernel_p4c_sk6
  buffer_load_dwordx4 v[152:155], v2, s[28:31], s48 offen offset:2048 sc1
L_sequential_preLN__mha_block__mixer_gmlp__prompt_kernel_p4c_sk6:
  s_mov_b64 exec, -1
L_sequential_preLN__mha_block__mixer_gmlp__prompt_kernel_p4c_chk:
  s_waitcnt vmcnt(0)
  s_sub_u32 s37, s37, 1
  s_cbranch_scc1 L_sequential_preLN__mha_block__mixer_gmlp__prompt_kernel_p4c_gotit
  v_cmp_ne_u64 s[54:55], s[38:39], v[130:131]
  v_cmp_ne_u64 s[56:57], s[38:39], v[134:135]
  v_cmp_ne_u64 s[58:59], s[38:39], v[138:139]
  v_cmp_ne_u64 s[60:61], s[38:39], v[142:143]
  v_cmp_ne_u64 s[62:63], s[38:39], v[146:147]
  v_cmp_ne_u64 s[64:65], s[38:39], v[150:151]
  v_cmp_ne_u64 s[66:67], s[38:39], v[154:155]
  s_or_b64 vcc, s[54:55], s[56:57]
  s_or_b64 vcc, vcc, s[58:59]
  s_or_b64 vcc, vcc, s[60:61]
  s_or_b64 vcc, vcc, s[62:63]
  s_or_b64 vcc, vcc, s[64:65]
  s_or_b64 vcc, vcc, s[66:67]
  s_cbranch_scc1 L_sequential_preLN__mha_block__mixer_gmlp__prompt_kernel_p4c_spoll
L_sequential_preLN__mha_block__mixer_gmlp__prompt_kernel_p4c_gotit:
  v_pk_add_f32 v[128:129], v[128:129], v[132:133]
  v_pk_add_f32 v[128:129], v[128:129], v[136:137]
  v_pk_add_f32 v[128:129], v[128:129], v[140:141]
  v_pk_add_f32 v[128:129], v[128:129], v[144:145]
  v_pk_add_f32 v[128:129], v[128:129], v[148:149]
  v_pk_add_f32 v[128:129], v[128:129], v[152:153]
  v_mov_b32 v3, v128
  v_mov_b32 v4, v129
  s_nop 1
  v_permlane32_swap_b32 v3, v128
  v_permlane32_swap_b32 v4, v129
  s_nop 1
  v_add_f32 v128, v128, v3
  v_add_f32 v129, v129, v4
  v_mul_f32 v128, 0x3a924925, v128
  v_mul_f32 v129, 0x3a924925, v129
  v_fma_f32 v129, -v128, v128, v129
  v_max_f32 v129, 0, v129
  v_add_f32 v129, 0x3727c5ac, v129
  v_rsq_f32 v130, v129
  s_nop 0
  v_mul_f32 v131, v128, v130
  v_sub_f32 v131, 0, v131
  v_pk_fma_f32 v[96:97], v[96:97], v[130:131], v[130:131] op_sel:[0,0,1] op_sel_hi:[1,0,1]
  v_pk_fma_f32 v[98:99], v[98:99], v[130:131], v[130:131] op_sel:[0,0,1] op_sel_hi:[1,0,1]
  v_pk_fma_f32 v[100:101], v[100:101], v[130:131], v[130:131] op_sel:[0,0,1] op_sel_hi:[1,0,1]
  v_pk_fma_f32 v[102:103], v[102:103], v[130:131], v[130:131] op_sel:[0,0,1] op_sel_hi:[1,0,1]
  v_cvt_pk_bf16_f32 v64, v96, v97
  v_cvt_pk_bf16_f32 v65, v98, v99
  v_cvt_pk_bf16_f32 v66, v100, v101
  v_cvt_pk_bf16_f32 v67, v102, v103
  ds_write_b128 v13, v[64:67] offset:0
  v_pk_fma_f32 v[104:105], v[104:105], v[130:131], v[130:131] op_sel:[0,0,1] op_sel_hi:[1,0,1]
  v_pk_fma_f32 v[106:107], v[106:107], v[130:131], v[130:131] op_sel:[0,0,1] op_sel_hi:[1,0,1]
  v_pk_fma_f32 v[108:109], v[108:109], v[130:131], v[130:131] op_sel:[0,0,1] op_sel_hi:[1,0,1]
  v_pk_fma_f32 v[110:111], v[110:111], v[130:131], v[130:131] op_sel:[0,0,1] op_sel_hi:[1,0,1]
  v_cvt_pk_bf16_f32 v68, v104, v105
  v_cvt_pk_bf16_f32 v69, v106, v107
  v_cvt_pk_bf16_f32 v70, v108, v109
  v_cvt_pk_bf16_f32 v71, v110, v111
  ds_write_b128 v13, v[68:71] offset:1024
  s_waitcnt lgkmcnt(0)
  ds_read_b64_tr_b16 v[72:73], v12 offset:0
  ds_read_b64_tr_b16 v[74:75], v12 offset:256
  ds_read_b64_tr_b16 v[76:77], v12 offset:1024
  ds_read_b64_tr_b16 v[78:79], v12 offset:1280
  v_mov_b32 v6, s46
  v_mov_b32 v7, v14
  s_lshl_b32 s49, s49, 7
  s_add_u32 s49, s49, 0x1700000
  v_lshlrev_b32 v3, 15, v1
  v_mov_b32 v20, s38
  v_mov_b32 v21, s39
  s_waitcnt lgkmcnt(2)
  buffer_store_dwordx4 v[72:75], v2, s[28:31], s50 offen sc1
  s_waitcnt lgkmcnt(0)
  buffer_store_dwordx4 v[76:79], v2, s[28:31], s51 offen sc1
  s_setprio 0
  v_pk_mul_f32 v[112:113], v[112:113], v[16:17] op_sel_hi:[1,0]
  v_pk_mul_f32 v[114:115], v[114:115], v[16:17] op_sel_hi:[1,0]
  v_pk_mul_f32 v[116:117], v[116:117], v[16:17] op_sel_hi:[1,0]
  v_pk_mul_f32 v[118:119], v[118:119], v[16:17] op_sel_hi:[1,0]
  v_pk_mul_f32 v[120:121], v[120:121], v[16:17] op_sel_hi:[1,0]
  v_pk_mul_f32 v[122:123], v[122:123], v[16:17] op_sel_hi:[1,0]
  v_pk_mul_f32 v[124:125], v[124:125], v[16:17] op_sel_hi:[1,0]
  v_pk_mul_f32 v[126:127], v[126:127], v[16:17] op_sel_hi:[1,0]
  v_pk_fma_f32 v[112:113], v[32:33], v[16:17], v[112:113] op_sel:[0,1,0] op_sel_hi:[1,1,1]
  v_pk_fma_f32 v[114:115], v[34:35], v[16:17], v[114:115] op_sel:[0,1,0] op_sel_hi:[1,1,1]
  v_pk_fma_f32 v[116:117], v[36:37], v[16:17], v[116:117] op_sel:[0,1,0] op_sel_hi:[1,1,1]
  v_pk_fma_f32 v[118:119], v[38:39], v[16:17], v[118:119] op_sel:[0,1,0] op_sel_hi:[1,1,1]
  v_pk_fma_f32 v[120:121], v[40:41], v[16:17], v[120:121] op_sel:[0,1,0] op_sel_hi:[1,1,1]
  v_pk_fma_f32 v[122:123], v[42:43], v[16:17], v[122:123] op_sel:[0,1,0] op_sel_hi:[1,1,1]
  v_pk_fma_f32 v[124:125], v[44:45], v[16:17], v[124:125] op_sel:[0,1,0] op_sel_hi:[1,1,1]
  v_pk_fma_f32 v[126:127], v[46:47], v[16:17], v[126:127] op_sel:[0,1,0] op_sel_hi:[1,1,1]
  v_pk_mul_f32 v[48:49], v[112:113], v[112:113]
  v_pk_mul_f32 v[50:51], v[114:115], v[114:115]
  v_pk_mul_f32 v[52:53], v[116:117], v[116:117]
  v_pk_mul_f32 v[54:55], v[118:119], v[118:119]
  v_pk_mul_f32 v[56:57], v[120:121], v[120:121]
  v_pk_mul_f32 v[58:59], v[122:123], v[122:123]
  v_pk_mul_f32 v[60:61], v[124:125], v[124:125]
  v_pk_mul_f32 v[62:63], v[126:127], v[126:127]
  v_pk_fma_f32 v[48:49], v[48:49], v[6:7], v[6:7] op_sel:[0,1,0] op_sel_hi:[1,1,0]
  v_pk_fma_f32 v[50:51], v[50:51], v[6:7], v[6:7] op_sel:[0,1,0] op_sel_hi:[1,1,0]
  v_pk_fma_f32 v[52:53], v[52:53], v[6:7], v[6:7] op_sel:[0,1,0] op_sel_hi:[1,1,0]
  v_pk_fma_f32 v[54:55], v[54:55], v[6:7], v[6:7] op_sel:[0,1,0] op_sel_hi:[1,1,0]
  v_pk_fma_f32 v[56:57], v[56:57], v[6:7], v[6:7] op_sel:[0,1,0] op_sel_hi:[1,1,0]
  v_pk_fma_f32 v[58:59], v[58:59], v[6:7], v[6:7] op_sel:[0,1,0] op_sel_hi:[1,1,0]
  v_pk_fma_f32 v[60:61], v[60:61], v[6:7], v[6:7] op_sel:[0,1,0] op_sel_hi:[1,1,0]
  v_pk_fma_f32 v[62:63], v[62:63], v[6:7], v[6:7] op_sel:[0,1,0] op_sel_hi:[1,1,0]
  v_pk_mul_f32 v[48:49], v[48:49], v[112:113]
  v_pk_mul_f32 v[50:51], v[50:51], v[114:115]
  v_pk_mul_f32 v[52:53], v[52:53], v[116:117]
  v_pk_mul_f32 v[54:55], v[54:55], v[118:119]
  v_pk_mul_f32 v[56:57], v[56:57], v[120:121]
  v_pk_mul_f32 v[58:59], v[58:59], v[122:123]
  v_pk_mul_f32 v[60:61], v[60:61], v[124:125]
  v_pk_mul_f32 v[62:63], v[62:63], v[126:127]
  v_exp_f32 v48, v48
  v_exp_f32 v49, v49
  v_exp_f32 v50, v50
  v_exp_f32 v51, v51
  v_exp_f32 v52, v52
  v_exp_f32 v53, v53
  v_exp_f32 v54, v54
  v_exp_f32 v55, v55
  s_waitcnt vmcnt(0)
  s_barrier
  s_cmp_lg_u32 s34, 0
  s_cbranch_scc1 L_sequential_preLN__mha_block__mixer_gmlp__prompt_kernel_p4c_nofl
  s_mov_b64 exec, 255
  buffer_store_dwordx2 v[20:21], v3, s[28:31], s49 offen sc1
  s_mov_b64 exec, -1
L_sequential_preLN__mha_block__mixer_gmlp__prompt_kernel_p4c_nofl:
  v_exp_f32 v56, v56
  v_exp_f32 v57, v57
  v_exp_f32 v58, v58
  v_exp_f32 v59, v59
  v_exp_f32 v60, v60
  v_exp_f32 v61, v61
  v_exp_f32 v62, v62
  v_exp_f32 v63, v63
  v_pk_add_f32 v[48:49], v[48:49], 1.0 op_sel_hi:[1,0]
  v_pk_add_f32 v[50:51], v[50:51], 1.0 op_sel_hi:[1,0]
  v_pk_add_f32 v[52:53], v[52:53], 1.0 op_sel_hi:[1,0]
  v_pk_add_f32 v[54:55], v[54:55], 1.0 op_sel_hi:[1,0]
  v_pk_add_f32 v[56:57], v[56:57], 1.0 op_sel_hi:[1,0]
  v_pk_add_f32 v[58:59], v[58:59], 1.0 op_sel_hi:[1,0]
  v_pk_add_f32 v[60:61], v[60:61], 1.0 op_sel_hi:[1,0]
  v_pk_add_f32 v[62:63], v[62:63], 1.0 op_sel_hi:[1,0]
  v_rcp_f32 v48, v48
  v_rcp_f32 v49, v49
  v_rcp_f32 v50, v50
  v_rcp_f32 v51, v51
  v_rcp_f32 v52, v52
  v_rcp_f32 v53, v53
  v_rcp_f32 v54, v54
  v_rcp_f32 v55, v55
  v_rcp_f32 v56, v56
  v_rcp_f32 v57, v57
  v_rcp_f32 v58, v58
  v_rcp_f32 v59, v59
  v_rcp_f32 v60, v60
  v_rcp_f32 v61, v61
  v_rcp_f32 v62, v62
  v_rcp_f32 v63, v63
  v_pk_mul_f32 v[112:113], v[112:113], v[48:49]
  v_pk_mul_f32 v[114:115], v[114:115], v[50:51]
  v_pk_mul_f32 v[116:117], v[116:117], v[52:53]
  v_pk_mul_f32 v[118:119], v[118:119], v[54:55]
  v_pk_mul_f32 v[120:121], v[120:121], v[56:57]
  v_pk_mul_f32 v[122:123], v[122:123], v[58:59]
  v_pk_mul_f32 v[124:125], v[124:125], v[60:61]
  v_pk_mul_f32 v[126:127], v[126:127], v[62:63]
  v_cvt_pk_bf16_f32 v80, v112, v113
  v_cvt_pk_bf16_f32 v81, v114, v115
  v_cvt_pk_bf16_f32 v82, v116, v117
  v_cvt_pk_bf16_f32 v83, v118, v119
  v_cvt_pk_bf16_f32 v84, v120, v121
  v_cvt_pk_bf16_f32 v85, v122, v123
  v_cvt_pk_bf16_f32 v86, v124, v125
  v_cvt_pk_bf16_f32 v87, v126, v127
  buffer_store_dwordx4 v[80:83], v2, s[28:31], s52 offen offset:0 sc1
  buffer_store_dwordx4 v[84:87], v2, s[28:31], s52 offen offset:1024 sc1
L_sequential_preLN__mha_block__mixer_gmlp__prompt_kernel_p4c_end:
  s_and_b32 s32, s35, 3
  s_lshl_b32 s32, s32, 3
  s_and_b32 s33, s36, 7
  s_add_u32 s41, s32, s33
  s_lshr_b32 s32, s35, 2
  s_lshl_b32 s32, s32, 2
  s_lshr_b32 s42, s36, 3
  s_add_u32 s42, s42, s32
  s_and_b32 s44, s34, 3
  s_lshr_b32 s43, s34, 2
  s_lshl_b32 s32, s41, 1
  s_add_u32 s32, s32, s43
  s_lshl_b32 s47, s32, 6
  s_mul_i32 s45, s32, 56
  s_mul_i32 s33, s42, 7
  s_add_u32 s45, s45, s33
  s_lshl_b32 s33, s44, 1
  s_add_u32 s45, s45, s33
  s_lshl_b32 s45, s45, 10
  s_lshl_b32 s48, s41, 3
  s_add_u32 s48, s48, s42
  s_add_u32 s48, s48, 8192
  s_mul_i32 s56, s42, 458752
  s_mul_i32 s32, s43, 14336
  s_add_u32 s56, s56, s32
  s_lshl_b32 s32, s44, 11
  s_add_u32 s56, s56, s32
  s_add_u32 s56, s56, 0xe00000
  s_lshl_b32 s57, s35, 1
  s_and_b32 s58, s36, 0
  v_and_b32 v8, 15, v1
  v_lshlrev_b32 v17, 1, v8
  v_lshrrev_b32 v5, 4, v1
  v_lshrrev_b32 v4, 5, v1
  v_lshl_add_u32 v19, v4, 4, v8
  v_and_b32 v4, 1, v5
  v_lshl_add_u32 v19, v4, 5, v19
  v_lshlrev_b32 v19, 4, v19
  v_lshrrev_b32 v4, 1, v8
  v_xor_b32 v4, v4, v5
  s_mul_i32 s32, s43, 12288
  v_lshl_add_u32 v8, v8, 7, s32
  v_lshl_add_u32 v9, v4, 4, v8
  v_xor_b32 v10, 4096, v9
  v_xor_b32 v11, 64, v9
  v_xor_b32 v12, 64, v10
  v_mov_b32 v124, 0
  v_mov_b32 v125, 0
  v_mov_b32 v126, 0
  v_mov_b32 v127, 0
  v_mov_b32 v128, 0
  v_mov_b32 v129, 0
  v_mov_b32 v130, 0
  v_mov_b32 v131, 0
  v_mov_b32 v132, 0
  v_mov_b32 v133, 0
  v_mov_b32 v134, 0
  v_mov_b32 v135, 0
  v_mov_b32 v136, 0
  v_mov_b32 v137, 0
  v_mov_b32 v138, 0
  v_mov_b32 v139, 0
  v_mov_b32 v140, 0
  v_mov_b32 v141, 0
  v_mov_b32 v142, 0
  v_mov_b32 v143, 0
  v_mov_b32 v144, 0
  v_mov_b32 v145, 0
  v_mov_b32 v146, 0
  v_mov_b32 v147, 0
  v_mov_b32 v148, 0
  v_mov_b32 v149, 0
  v_mov_b32 v150, 0
  v_mov_b32 v151, 0
  v_mov_b32 v152, 0
  v_mov_b32 v153, 0
  v_mov_b32 v154, 0
  v_mov_b32 v155, 0
  s_mov_b32 s46, 0
  s_mov_b32 s52, s16
  s_and_b32 s53, s17, 0xffff
  s_mov_b32 s54, 0x1000
  s_mov_b32 s55, 0x20000
  buffer_load_ushort v18, v17, s[52:55], s47 offen offset:32
  buffer_load_ushort v17, v17, s[52:55], s47 offen
  s_barrier
  s_waitcnt vmcnt(0)
  s_cmp_eq_u32 s44, 3
  s_cbranch_scc1 L_sequential_preLN__mha_block__mixer_gmlp__prompt_kernel_p5c_one
  s_add_u32 s33, s57, s58
  s_and_b32 s33, s33, 3
  s_and_b32 s59, s57, 12
  s_or_b32 s59, s59, s33
  s_mul_i32 s59, s59, 28672
  s_add_u32 s59, s59, s56
  s_add_u32 s57, s57, 1
  s_add_u32 s60, s59, 7168
  buffer_load_dwordx4 v[60:63], v2, s[28:31], s59 offen offset:0 sc1
  buffer_load_dwordx4 v[64:67], v2, s[28:31], s59 offen offset:1024 sc1
  buffer_load_dwordx4 v[68:71], v2, s[28:31], s60 offen offset:0 sc1
  buffer_load_dwordx4 v[72:75], v2, s[28:31], s60 offen offset:1024 sc1
  v_add_u32 v13, s46, v9
  v_add_u32 v14, s46, v10
  v_add_u32 v15, s46, v11
  v_add_u32 v16, s46, v12
  s_add_u32 s46, s46, 16384
  s_cmp_eq_u32 s46, 163840
  s_cselect_b32 s46, 0, s46
  ds_read_b128 v[28:31], v13 offset:0
  ds_read_b128 v[32:35], v13 offset:2048
  ds_read_b128 v[36:39], v14 offset:0
  ds_read_b128 v[40:43], v14 offset:2048
  s_add_u32 s33, s57, s58
  s_and_b32 s33, s33, 3
  s_and_b32 s59, s57, 12
  s_or_b32 s59, s59, s33
  s_mul_i32 s59, s59, 28672
  s_add_u32 s59, s59, s56
  s_add_u32 s57, s57, 1
  s_add_u32 s60, s59, 7168
  buffer_load_dwordx4 v[76:79], v2, s[28:31], s59 offen offset:0 sc1
  buffer_load_dwordx4 v[80:83], v2, s[28:31], s59 offen offset:1024 sc1
  buffer_load_dwordx4 v[84:87], v2, s[28:31], s60 offen offset:0 sc1
  buffer_load_dwordx4 v[88:91], v2, s[28:31], s60 offen offset:1024 sc1
  s_add_u32 s33, s57, s58
  s_and_b32 s33, s33, 3
  s_and_b32 s59, s57, 12
  s_or_b32 s59, s59, s33
  s_mul_i32 s59, s59, 28672
  s_add_u32 s59, s59, s56
  s_add_u32 s57, s57, 1
  s_add_u32 s60, s59, 7168
  buffer_load_dwordx4 v[92:95], v2, s[28:31], s59 offen offset:0 sc1
  buffer_load_dwordx4 v[96:99], v2, s[28:31], s59 offen offset:1024 sc1
  buffer_load_dwordx4 v[100:103], v2, s[28:31], s60 offen offset:0 sc1
  buffer_load_dwordx4 v[104:107], v2, s[28:31], s60 offen offset:1024 sc1
  s_add_u32 s33, s57, s58
  s_and_b32 s33, s33, 3
  s_and_b32 s59, s57, 12
  s_or_b32 s59, s59, s33
  s_mul_i32 s59, s59, 28672
  s_add_u32 s59, s59, s56
  s_add_u32 s57, s57, 1
  s_add_u32 s60, s59, 7168
  buffer_load_dwordx4 v[108:111], v2, s[28:31], s59 offen offset:0 sc1
  buffer_load_dwordx4 v[112:115], v2, s[28:31], s59 offen offset:1024 sc1
  buffer_load_dwordx4 v[116:119], v2, s[28:31], s60 offen offset:0 sc1
  buffer_load_dwordx4 v[120:123], v2, s[28:31], s60 offen offset:1024 sc1
  s_mov_b32 s37, 3
L_sequential_preLN__mha_block__mixer_gmlp__prompt_kernel_p5c_loopa:
  s_waitcnt vmcnt(14) lgkmcnt(0)
  v_mfma_f32_16x16x32_bf16 v[124:127], v[60:63], v[28:31], v[124:127]
  ds_read_b128 v[44:47], v15 offset:0
  ds_read_b128 v[48:51], v15 offset:2048
  v_mfma_f32_16x16x32_bf16 v[128:131], v[60:63], v[32:35], v[128:131]
  ds_read_b128 v[52:55], v16 offset:0
  ds_read_b128 v[56:59], v16 offset:2048
  v_mfma_f32_16x16x32_bf16 v[140:143], v[60:63], v[36:39], v[140:143]
  s_add_u32 s33, s57, s58
  s_and_b32 s33, s33, 3
  v_mfma_f32_16x16x32_bf16 v[144:147], v[60:63], v[40:43], v[144:147]
  s_and_b32 s59, s57, 12
  s_or_b32 s59, s59, s33
  v_mfma_f32_16x16x32_bf16 v[132:135], v[64:67], v[28:31], v[132:135]
  s_mul_i32 s59, s59, 28672
  s_add_u32 s59, s59, s56
  v_mfma_f32_16x16x32_bf16 v[136:139], v[64:67], v[32:35], v[136:139]
  s_add_u32 s57, s57, 1
  s_add_u32 s60, s59, 7168
  v_mfma_f32_16x16x32_bf16 v[148:151], v[64:67], v[36:39], v[148:151]
  v_add_u32 v13, s46, v9
  v_add_u32 v14, s46, v10
  v_mfma_f32_16x16x32_bf16 v[152:155], v[64:67], v[40:43], v[152:155]
  v_add_u32 v15, s46, v11
  v_add_u32 v16, s46, v12
  s_add_u32 s46, s46, 16384
  s_cmp_eq_u32 s46, 163840
  s_cselect_b32 s46, 0, s46
  buffer_load_dwordx4 v[60:63], v2, s[28:31], s59 offen offset:0 sc1
  buffer_load_dwordx4 v[64:67], v2, s[28:31], s59 offen offset:1024 sc1
  s_waitcnt vmcnt(14) lgkmcnt(0)
  v_mfma_f32_16x16x32_bf16 v[124:127], v[68:71], v[44:47], v[124:127]
  ds_read_b128 v[28:31], v13 offset:0
  ds_read_b128 v[32:35], v13 offset:2048
  v_mfma_f32_16x16x32_bf16 v[128:131], v[68:71], v[48:51], v[128:131]
  ds_read_b128 v[36:39], v14 offset:0
  ds_read_b128 v[40:43], v14 offset:2048
  v_mfma_f32_16x16x32_bf16 v[140:143], v[68:71], v[52:55], v[140:143]
  v_mfma_f32_16x16x32_bf16 v[144:147], v[68:71], v[56:59], v[144:147]
  v_mfma_f32_16x16x32_bf16 v[132:135], v[72:75], v[44:47], v[132:135]
  v_mfma_f32_16x16x32_bf16 v[136:139], v[72:75], v[48:51], v[136:139]
  v_mfma_f32_16x16x32_bf16 v[148:151], v[72:75], v[52:55], v[148:151]
  v_mfma_f32_16x16x32_bf16 v[152:155], v[72:75], v[56:59], v[152:155]
  buffer_load_dwordx4 v[68:71], v2, s[28:31], s60 offen offset:0 sc1
  buffer_load_dwordx4 v[72:75], v2, s[28:31], s60 offen offset:1024 sc1
  s_waitcnt vmcnt(14) lgkmcnt(0)
  v_mfma_f32_16x16x32_bf16 v[124:127], v[76:79], v[28:31], v[124:127]
  ds_read_b128 v[44:47], v15 offset:0
  ds_read_b128 v[48:51], v15 offset:2048
  v_mfma_f32_16x16x32_bf16 v[128:131], v[76:79], v[32:35], v[128:131]
  ds_read_b128 v[52:55], v16 offset:0
  ds_read_b128 v[56:59], v16 offset:2048
  v_mfma_f32_16x16x32_bf16 v[140:143], v[76:79], v[36:39], v[140:143]
  s_add_u32 s33, s57, s58
  s_and_b32 s33, s33, 3
  v_mfma_f32_16x16x32_bf16 v[144:147], v[76:79], v[40:43], v[144:147]
  s_and_b32 s59, s57, 12
  s_or_b32 s59, s59, s33
  v_mfma_f32_16x16x32_bf16 v[132:135], v[80:83], v[28:31], v[132:135]
  s_mul_i32 s59, s59, 28672
  s_add_u32 s59, s59, s56
  v_mfma_f32_16x16x32_bf16 v[136:139], v[80:83], v[32:35], v[136:139]
  s_add_u32 s57, s57, 1
  s_add_u32 s60, s59, 7168
  v_mfma_f32_16x16x32_bf16 v[148:151], v[80:83], v[36:39], v[148:151]
  v_add_u32 v13, s46, v9
  v_add_u32 v14, s46, v10
  v_mfma_f32_16x16x32_bf16 v[152:155], v[80:83], v[40:43], v[152:155]
  v_add_u32 v15, s46, v11
  v_add_u32 v16, s46, v12
  s_add_u32 s46, s46, 16384
  s_cmp_eq_u32 s46, 163840
  s_cselect_b32 s46, 0, s46
  buffer_load_dwordx4 v[76:79], v2, s[28:31], s59 offen offset:0 sc1
  buffer_load_dwordx4 v[80:83], v2, s[28:31], s59 offen offset:1024 sc1
  s_waitcnt vmcnt(14) lgkmcnt(0)
  v_mfma_f32_16x16x32_bf16 v[124:127], v[84:87], v[44:47], v[124:127]
  ds_read_b128 v[28:31], v13 offset:0
  ds_read_b128 v[32:35], v13 offset:2048
  v_mfma_f32_16x16x32_bf16 v[128:131], v[84:87], v[48:51], v[128:131]
  ds_read_b128 v[36:39], v14 offset:0
  ds_read_b128 v[40:43], v14 offset:2048
  v_mfma_f32_16x16x32_bf16 v[140:143], v[84:87], v[52:55], v[140:143]
  v_mfma_f32_16x16x32_bf16 v[144:147], v[84:87], v[56:59], v[144:147]
  v_mfma_f32_16x16x32_bf16 v[132:135], v[88:91], v[44:47], v[132:135]
  v_mfma_f32_16x16x32_bf16 v[136:139], v[88:91], v[48:51], v[136:139]
  v_mfma_f32_16x16x32_bf16 v[148:151], v[88:91], v[52:55], v[148:151]
  v_mfma_f32_16x16x32_bf16 v[152:155], v[88:91], v[56:59], v[152:155]
  buffer_load_dwordx4 v[84:87], v2, s[28:31], s60 offen offset:0 sc1
  buffer_load_dwordx4 v[88:91], v2, s[28:31], s60 offen offset:1024 sc1
  s_waitcnt vmcnt(14) lgkmcnt(0)
  v_mfma_f32_16x16x32_bf16 v[124:127], v[92:95], v[28:31], v[124:127]
  ds_read_b128 v[44:47], v15 offset:0
  ds_read_b128 v[48:51], v15 offset:2048
  v_mfma_f32_16x16x32_bf16 v[128:131], v[92:95], v[32:35], v[128:131]
  ds_read_b128 v[52:55], v16 offset:0
  ds_read_b128 v[56:59], v16 offset:2048
  v_mfma_f32_16x16x32_bf16 v[140:143], v[92:95], v[36:39], v[140:143]
  s_add_u32 s33, s57, s58
  s_and_b32 s33, s33, 3
  v_mfma_f32_16x16x32_bf16 v[144:147], v[92:95], v[40:43], v[144:147]
  s_and_b32 s59, s57, 12
  s_or_b32 s59, s59, s33
  v_mfma_f32_16x16x32_bf16 v[132:135], v[96:99], v[28:31], v[132:135]
  s_mul_i32 s59, s59, 28672
  s_add_u32 s59, s59, s56
  v_mfma_f32_16x16x32_bf16 v[136:139], v[96:99], v[32:35], v[136:139]
  s_add_u32 s57, s57, 1
  s_add_u32 s60, s59, 7168
  v_mfma_f32_16x16x32_bf16 v[148:151], v[96:99], v[36:39], v[148:151]
  v_add_u32 v13, s46, v9
  v_add_u32 v14, s46, v10
  v_mfma_f32_16x16x32_bf16 v[152:155], v[96:99], v[40:43], v[152:155]
  v_add_u32 v15, s46, v11
  v_add_u32 v16, s46, v12
  s_add_u32 s46, s46, 16384
  s_cmp_eq_u32 s46, 163840
  s_cselect_b32 s46, 0, s46
  buffer_load_dwordx4 v[92:95], v2, s[28:31], s59 offen offset:0 sc1
  buffer_load_dwordx4 v[96:99], v2, s[28:31], s59 offen offset:1024 sc1
  s_waitcnt vmcnt(14) lgkmcnt(0)
  v_mfma_f32_16x16x32_bf16 v[124:127], v[100:103], v[44:47], v[124:127]
  ds_read_b128 v[28:31], v13 offset:0
  ds_read_b128 v[32:35], v13 offset:2048
  v_mfma_f32_16x16x32_bf16 v[128:131], v[100:103], v[48:51], v[128:131]
  ds_read_b128 v[36:39], v14 offset:0
  ds_read_b128 v[40:43], v14 offset:2048
  v_mfma_f32_16x16x32_bf16 v[140:143], v[100:103], v[52:55], v[140:143]
  v_mfma_f32_16x16x32_bf16 v[144:147], v[100:103], v[56:59], v[144:147]
  v_mfma_f32_16x16x32_bf16 v[132:135], v[104:107], v[44:47], v[132:135]
  v_mfma_f32_16x16x32_bf16 v[136:139], v[104:107], v[48:51], v[136:139]
  v_mfma_f32_16x16x32_bf16 v[148:151], v[104:107], v[52:55], v[148:151]
  v_mfma_f32_16x16x32_bf16 v[152:155], v[104:107], v[56:59], v[152:155]
  buffer_load_dwordx4 v[100:103], v2, s[28:31], s60 offen offset:0 sc1
  buffer_load_dwordx4 v[104:107], v2, s[28:31], s60 offen offset:1024 sc1
  s_waitcnt vmcnt(14) lgkmcnt(0)
  v_mfma_f32_16x16x32_bf16 v[124:127], v[108:111], v[28:31], v[124:127]
  ds_read_b128 v[44:47], v15 offset:0
  ds_read_b128 v[48:51], v15 offset:2048
  v_mfma_f32_16x16x32_bf16 v[128:131], v[108:111], v[32:35], v[128:131]
  ds_read_b128 v[52:55], v16 offset:0
  ds_read_b128 v[56:59], v16 offset:2048
  v_mfma_f32_16x16x32_bf16 v[140:143], v[108:111], v[36:39], v[140:143]
  s_add_u32 s33, s57, s58
  s_and_b32 s33, s33, 3
  v_mfma_f32_16x16x32_bf16 v[144:147], v[108:111], v[40:43], v[144:147]
  s_and_b32 s59, s57, 12
  s_or_b32 s59, s59, s33
  v_mfma_f32_16x16x32_bf16 v[132:135], v[112:115], v[28:31], v[132:135]
  s_mul_i32 s59, s59, 28672
  s_add_u32 s59, s59, s56
  v_mfma_f32_16x16x32_bf16 v[136:139], v[112:115], v[32:35], v[136:139]
  s_add_u32 s57, s57, 1
  s_add_u32 s60, s59, 7168
  v_mfma_f32_16x16x32_bf16 v[148:151], v[112:115], v[36:39], v[148:151]
  v_add_u32 v13, s46, v9
  v_add_u32 v14, s46, v10
  v_mfma_f32_16x16x32_bf16 v[152:155], v[112:115], v[40:43], v[152:155]
  v_add_u32 v15, s46, v11
  v_add_u32 v16, s46, v12
  s_add_u32 s46, s46, 16384
  s_cmp_eq_u32 s46, 163840
  s_cselect_b32 s46, 0, s46
  buffer_load_dwordx4 v[108:111], v2, s[28:31], s59 offen offset:0 sc1
  buffer_load_dwordx4 v[112:115], v2, s[28:31], s59 offen offset:1024 sc1
  s_waitcnt vmcnt(14) lgkmcnt(0)
  v_mfma_f32_16x16x32_bf16 v[124:127], v[116:119], v[44:47], v[124:127]
  ds_read_b128 v[28:31], v13 offset:0
  ds_read_b128 v[32:35], v13 offset:2048
  v_mfma_f32_16x16x32_bf16 v[128:131], v[116:119], v[48:51], v[128:131]
  ds_read_b128 v[36:39], v14 offset:0
  ds_read_b128 v[40:43], v14 offset:2048
  v_mfma_f32_16x16x32_bf16 v[140:143], v[116:119], v[52:55], v[140:143]
  s_sub_u32 s37, s37, 1
  s_cmp_lg_u32 s37, 0
  v_mfma_f32_16x16x32_bf16 v[144:147], v[116:119], v[56:59], v[144:147]
  v_mfma_f32_16x16x32_bf16 v[132:135], v[120:123], v[44:47], v[132:135]
  v_mfma_f32_16x16x32_bf16 v[136:139], v[120:123], v[48:51], v[136:139]
  v_mfma_f32_16x16x32_bf16 v[148:151], v[120:123], v[52:55], v[148:151]
  v_mfma_f32_16x16x32_bf16 v[152:155], v[120:123], v[56:59], v[152:155]
  buffer_load_dwordx4 v[116:119], v2, s[28:31], s60 offen offset:0 sc1
  buffer_load_dwordx4 v[120:123], v2, s[28:31], s60 offen offset:1024 sc1
  s_barrier
  s_cbranch_scc1 L_sequential_preLN__mha_block__mixer_gmlp__prompt_kernel_p5c_loopa
  s_add_u32 s32, s45, 0xa00000
  buffer_load_dwordx4 v[20:23], v19, s[28:31], s32 offen offset:0 sc1
  buffer_load_dwordx4 v[24:27], v19, s[28:31], s32 offen offset:1024 sc1
  s_waitcnt vmcnt(16) lgkmcnt(0)
  v_mfma_f32_16x16x32_bf16 v[124:127], v[60:63], v[28:31], v[124:127]
  ds_read_b128 v[44:47], v15 offset:0
  ds_read_b128 v[48:51], v15 offset:2048
  v_mfma_f32_16x16x32_bf16 v[128:131], v[60:63], v[32:35], v[128:131]
  ds_read_b128 v[52:55], v16 offset:0
  ds_read_b128 v[56:59], v16 offset:2048
  v_mfma_f32_16x16x32_bf16 v[140:143], v[60:63], v[36:39], v[140:143]
  v_add_u32 v13, s46, v9
  v_add_u32 v14, s46, v10
  v_mfma_f32_16x16x32_bf16 v[144:147], v[60:63], v[40:43], v[144:147]
  v_add_u32 v15, s46, v11
  v_add_u32 v16, s46, v12
  v_mfma_f32_16x16x32_bf16 v[132:135], v[64:67], v[28:31], v[132:135]
  s_add_u32 s46, s46, 16384
  s_cmp_eq_u32 s46, 163840
  v_mfma_f32_16x16x32_bf16 v[136:139], v[64:67], v[32:35], v[136:139]
  s_cselect_b32 s46, 0, s46
  v_mfma_f32_16x16x32_bf16 v[148:151], v[64:67], v[36:39], v[148:151]
  v_mfma_f32_16x16x32_bf16 v[152:155], v[64:67], v[40:43], v[152:155]
  s_waitcnt vmcnt(14) lgkmcnt(0)
  v_mfma_f32_16x16x32_bf16 v[124:127], v[68:71], v[44:47], v[124:127]
  ds_read_b128 v[28:31], v13 offset:0
  ds_read_b128 v[32:35], v13 offset:2048
  v_mfma_f32_16x16x32_bf16 v[128:131], v[68:71], v[48:51], v[128:131]
  ds_read_b128 v[36:39], v14 offset:0
  ds_read_b128 v[40:43], v14 offset:2048
  v_mfma_f32_16x16x32_bf16 v[140:143], v[68:71], v[52:55], v[140:143]
  v_mfma_f32_16x16x32_bf16 v[144:147], v[68:71], v[56:59], v[144:147]
  v_mfma_f32_16x16x32_bf16 v[132:135], v[72:75], v[44:47], v[132:135]
  v_mfma_f32_16x16x32_bf16 v[136:139], v[72:75], v[48:51], v[136:139]
  v_mfma_f32_16x16x32_bf16 v[148:151], v[72:75], v[52:55], v[148:151]
  v_mfma_f32_16x16x32_bf16 v[152:155], v[72:75], v[56:59], v[152:155]
  s_waitcnt vmcnt(12) lgkmcnt(0)
  v_mfma_f32_16x16x32_bf16 v[124:127], v[76:79], v[28:31], v[124:127]
  ds_read_b128 v[44:47], v15 offset:0
  ds_read_b128 v[48:51], v15 offset:2048
  v_mfma_f32_16x16x32_bf16 v[128:131], v[76:79], v[32:35], v[128:131]
  ds_read_b128 v[52:55], v16 offset:0
  ds_read_b128 v[56:59], v16 offset:2048
  v_mfma_f32_16x16x32_bf16 v[140:143], v[76:79], v[36:39], v[140:143]
  v_add_u32 v13, s46, v9
  v_add_u32 v14, s46, v10
  v_mfma_f32_16x16x32_bf16 v[144:147], v[76:79], v[40:43], v[144:147]
  v_add_u32 v15, s46, v11
  v_add_u32 v16, s46, v12
  v_mfma_f32_16x16x32_bf16 v[132:135], v[80:83], v[28:31], v[132:135]
  s_add_u32 s46, s46, 16384
  s_cmp_eq_u32 s46, 163840
  v_mfma_f32_16x16x32_bf16 v[136:139], v[80:83], v[32:35], v[136:139]
  s_cselect_b32 s46, 0, s46
  v_mfma_f32_16x16x32_bf16 v[148:151], v[80:83], v[36:39], v[148:151]
  v_mfma_f32_16x16x32_bf16 v[152:155], v[80:83], v[40:43], v[152:155]
  s_waitcnt vmcnt(10) lgkmcnt(0)
  v_mfma_f32_16x16x32_bf16 v[124:127], v[84:87], v[44:47], v[124:127]
  ds_read_b128 v[28:31], v13 offset:0
  ds_read_b128 v[32:35], v13 offset:2048
  v_mfma_f32_16x16x32_bf16 v[128:131], v[84:87], v[48:51], v[128:131]
  ds_read_b128 v[36:39], v14 offset:0
  ds_read_b128 v[40:43], v14 offset:2048
  v_mfma_f32_16x16x32_bf16 v[140:143], v[84:87], v[52:55], v[140:143]
  v_mfma_f32_16x16x32_bf16 v[144:147], v[84:87], v[56:59], v[144:147]
  v_mfma_f32_16x16x32_bf16 v[132:135], v[88:91], v[44:47], v[132:135]
  v_mfma_f32_16x16x32_bf16 v[136:139], v[88:91], v[48:51], v[136:139]
  v_mfma_f32_16x16x32_bf16 v[148:151], v[88:91], v[52:55], v[148:151]
  v_mfma_f32_16x16x32_bf16 v[152:155], v[88:91], v[56:59], v[152:155]
  s_waitcnt vmcnt(8) lgkmcnt(0)
  v_mfma_f32_16x16x32_bf16 v[124:127], v[92:95], v[28:31], v[124:127]
  ds_read_b128 v[44:47], v15 offset:0
  ds_read_b128 v[48:51], v15 offset:2048
  v_mfma_f32_16x16x32_bf16 v[128:131], v[92:95], v[32:35], v[128:131]
  ds_read_b128 v[52:55], v16 offset:0
  ds_read_b128 v[56:59], v16 offset:2048
  v_mfma_f32_16x16x32_bf16 v[140:143], v[92:95], v[36:39], v[140:143]
  v_add_u32 v13, s46, v9
  v_add_u32 v14, s46, v10
  v_mfma_f32_16x16x32_bf16 v[144:147], v[92:95], v[40:43], v[144:147]
  v_add_u32 v15, s46, v11
  v_add_u32 v16, s46, v12
  v_mfma_f32_16x16x32_bf16 v[132:135], v[96:99], v[28:31], v[132:135]
  s_add_u32 s46, s46, 16384
  s_cmp_eq_u32 s46, 163840
  v_mfma_f32_16x16x32_bf16 v[136:139], v[96:99], v[32:35], v[136:139]
  s_cselect_b32 s46, 0, s46
  v_mfma_f32_16x16x32_bf16 v[148:151], v[96:99], v[36:39], v[148:151]
  v_mfma_f32_16x16x32_bf16 v[152:155], v[96:99], v[40:43], v[152:155]
  s_waitcnt vmcnt(6) lgkmcnt(0)
  v_mfma_f32_16x16x32_bf16 v[124:127], v[100:103], v[44:47], v[124:127]
  ds_read_b128 v[28:31], v13 offset:0
  ds_read_b128 v[32:35], v13 offset:2048
  v_mfma_f32_16x16x32_bf16 v[128:131], v[100:103], v[48:51], v[128:131]
  ds_read_b128 v[36:39], v14 offset:0
  ds_read_b128 v[40:43], v14 offset:2048
  v_mfma_f32_16x16x32_bf16 v[140:143], v[100:103], v[52:55], v[140:143]
  v_mfma_f32_16x16x32_bf16 v[144:147], v[100:103], v[56:59], v[144:147]
  v_mfma_f32_16x16x32_bf16 v[132:135], v[104:107], v[44:47], v[132:135]
  v_mfma_f32_16x16x32_bf16 v[136:139], v[104:107], v[48:51], v[136:139]
  v_mfma_f32_16x16x32_bf16 v[148:151], v[104:107], v[52:55], v[148:151]
  v_mfma_f32_16x16x32_bf16 v[152:155], v[104:107], v[56:59], v[152:155]
  s_waitcnt vmcnt(4) lgkmcnt(0)
  v_mfma_f32_16x16x32_bf16 v[124:127], v[108:111], v[28:31], v[124:127]
  ds_read_b128 v[44:47], v15 offset:0
  ds_read_b128 v[48:51], v15 offset:2048
  v_mfma_f32_16x16x32_bf16 v[128:131], v[108:111], v[32:35], v[128:131]
  ds_read_b128 v[52:55], v16 offset:0
  ds_read_b128 v[56:59], v16 offset:2048
  v_mfma_f32_16x16x32_bf16 v[140:143], v[108:111], v[36:39], v[140:143]
  v_add_u32 v13, s46, v9
  v_add_u32 v14, s46, v10
  v_mfma_f32_16x16x32_bf16 v[144:147], v[108:111], v[40:43], v[144:147]
  v_add_u32 v15, s46, v11
  v_add_u32 v16, s46, v12
  v_mfma_f32_16x16x32_bf16 v[132:135], v[112:115], v[28:31], v[132:135]
  s_add_u32 s46, s46, 16384
  s_cmp_eq_u32 s46, 163840
  v_mfma_f32_16x16x32_bf16 v[136:139], v[112:115], v[32:35], v[136:139]
  s_cselect_b32 s46, 0, s46
  v_mfma_f32_16x16x32_bf16 v[148:151], v[112:115], v[36:39], v[148:151]
  v_mfma_f32_16x16x32_bf16 v[152:155], v[112:115], v[40:43], v[152:155]
  s_waitcnt vmcnt(2) lgkmcnt(0)
  v_mfma_f32_16x16x32_bf16 v[124:127], v[116:119], v[44:47], v[124:127]
  v_mfma_f32_16x16x32_bf16 v[128:131], v[116:119], v[48:51], v[128:131]
  v_mfma_f32_16x16x32_bf16 v[140:143], v[116:119], v[52:55], v[140:143]
  v_mfma_f32_16x16x32_bf16 v[144:147], v[116:119], v[56:59], v[144:147]
  v_mfma_f32_16x16x32_bf16 v[132:135], v[120:123], v[44:47], v[132:135]
  v_mfma_f32_16x16x32_bf16 v[136:139], v[120:123], v[48:51], v[136:139]
  v_mfma_f32_16x16x32_bf16 v[148:151], v[120:123], v[52:55], v[148:151]
  v_mfma_f32_16x16x32_bf16 v[152:155], v[120:123], v[56:59], v[152:155]
  s_lshl_b32 s32, s34, 12
  s_add_u32 s32, s32, 114688
  v_add_u32 v4, s32, v2
  s_xor_b32 s32, s34, 4
  s_lshl_b32 s32, s32, 12
  s_add_u32 s32, s32, 114688
  v_add_u32 v5, s32, v2
  s_nop 1
  ds_write_b128 v4, v[140:143] offset:0
  ds_write_b128 v4, v[144:147] offset:1024
  ds_write_b128 v4, v[148:151] offset:2048
  ds_write_b128 v4, v[152:155] offset:3072
  s_waitcnt vmcnt(0)
  v_lshlrev_b32 v17, 16, v17
  v_lshlrev_b32 v18, 16, v18
  v_permlane32_swap_b32 v20, v22
  v_permlane32_swap_b32 v21, v23
  v_permlane32_swap_b32 v24, v26
  v_permlane32_swap_b32 v25, v27
  s_waitcnt lgkmcnt(0)
  s_barrier
  ds_read_b128 v[44:47], v5 offset:0
  ds_read_b128 v[48:51], v5 offset:1024
  ds_read_b128 v[52:55], v5 offset:2048
  ds_read_b128 v[56:59], v5 offset:3072
  s_add_u32 s32, s45, 0x1200000
  v_lshlrev_b32 v28, 16, v20
  v_and_b32 v29, 0xffff0000, v20
  v_lshlrev_b32 v30, 16, v21
  v_and_b32 v31, 0xffff0000, v21
  v_lshlrev_b32 v32, 16, v22
  v_and_b32 v33, 0xffff0000, v22
  v_lshlrev_b32 v34, 16, v23
  v_and_b32 v35, 0xffff0000, v23
  v_lshlrev_b32 v36, 16, v24
  v_and_b32 v37, 0xffff0000, v24
  v_lshlrev_b32 v38, 16, v25
  v_and_b32 v39, 0xffff0000, v25
  v_lshlrev_b32 v40, 16, v26
  v_and_b32 v41, 0xffff0000, v26
  v_lshlrev_b32 v42, 16, v27
  v_and_b32 v43, 0xffff0000, v27
  v_add_f32 v124, v124, v17
  v_add_f32 v125, v125, v17
  v_add_f32 v126, v126, v17
  v_add_f32 v127, v127, v17
  v_add_f32 v128, v128, v18
  v_add_f32 v129, v129, v18
  v_add_f32 v130, v130, v18
  v_add_f32 v131, v131, v18
  v_add_f32 v132, v132, v17
  v_add_f32 v133, v133, v17
  v_add_f32 v134, v134, v17
  v_add_f32 v135, v135, v17
  v_add_f32 v136, v136, v18
  v_add_f32 v137, v137, v18
  v_add_f32 v138, v138, v18
  v_add_f32 v139, v139, v18
  s_waitcnt lgkmcnt(0)
  v_add_f32 v124, v124, v44
  v_mul_f32 v124, v124, v28
  v_add_f32 v125, v125, v45
  v_mul_f32 v125, v125, v29
  v_add_f32 v126, v126, v46
  v_mul_f32 v126, v126, v30
  v_add_f32 v127, v127, v47
  v_mul_f32 v127, v127, v31
  v_add_f32 v128, v128, v48
  v_mul_f32 v128, v128, v32
  v_add_f32 v129, v129, v49
  v_mul_f32 v129, v129, v33
  v_add_f32 v130, v130, v50
  v_mul_f32 v130, v130, v34
  v_add_f32 v131, v131, v51
  v_mul_f32 v131, v131, v35
  v_add_f32 v132, v132, v52
  v_mul_f32 v132, v132, v36
  v_add_f32 v133, v133, v53
  v_mul_f32 v133, v133, v37
  v_add_f32 v134, v134, v54
  v_mul_f32 v134, v134, v38
  v_add_f32 v135, v135, v55
  v_mul_f32 v135, v135, v39
  v_add_f32 v136, v136, v56
  v_mul_f32 v136, v136, v40
  v_add_f32 v137, v137, v57
  v_mul_f32 v137, v137, v41
  v_add_f32 v138, v138, v58
  v_mul_f32 v138, v138, v42
  v_add_f32 v139, v139, v59
  v_mul_f32 v139, v139, v43
  v_cvt_pk_bf16_f32 v20, v124, v125
  v_cvt_pk_bf16_f32 v21, v126, v127
  v_cvt_pk_bf16_f32 v22, v128, v129
  v_cvt_pk_bf16_f32 v23, v130, v131
  v_cvt_pk_bf16_f32 v24, v132, v133
  v_cvt_pk_bf16_f32 v25, v134, v135
  v_cvt_pk_bf16_f32 v26, v136, v137
  v_cvt_pk_bf16_f32 v27, v138, v139
  s_nop 1
  v_permlane32_swap_b32 v20, v22
  v_permlane32_swap_b32 v21, v23
  buffer_store_dwordx4 v[20:23], v19, s[28:31], s32 offen offset:0 sc1
  v_permlane32_swap_b32 v24, v26
  v_permlane32_swap_b32 v25, v27
  buffer_store_dwordx4 v[24:27], v19, s[28:31], s32 offen offset:1024 sc1
  s_branch L_sequential_preLN__mha_block__mixer_gmlp__prompt_kernel_p5c_fin
L_sequential_preLN__mha_block__mixer_gmlp__prompt_kernel_p5c_one:
  s_add_u32 s33, s57, s58
  s_and_b32 s33, s33, 3
  s_and_b32 s59, s57, 12
  s_or_b32 s59, s59, s33
  s_mul_i32 s59, s59, 28672
  s_add_u32 s59, s59, s56
  s_add_u32 s57, s57, 1
  s_add_u32 s60, s59, 7168
  buffer_load_dwordx4 v[60:63], v2, s[28:31], s59 offen offset:0 sc1
  buffer_load_dwordx4 v[68:71], v2, s[28:31], s60 offen offset:0 sc1
  v_add_u32 v13, s46, v9
  v_add_u32 v14, s46, v10
  v_add_u32 v15, s46, v11
  v_add_u32 v16, s46, v12
  s_add_u32 s46, s46, 16384
  s_cmp_eq_u32 s46, 163840
  s_cselect_b32 s46, 0, s46
  ds_read_b128 v[28:31], v13 offset:0
  ds_read_b128 v[32:35], v13 offset:2048
  ds_read_b128 v[36:39], v14 offset:0
  ds_read_b128 v[40:43], v14 offset:2048
  s_add_u32 s33, s57, s58
  s_and_b32 s33, s33, 3
  s_and_b32 s59, s57, 12
  s_or_b32 s59, s59, s33
  s_mul_i32 s59, s59, 28672
  s_add_u32 s59, s59, s56
  s_add_u32 s57, s57, 1
  s_add_u32 s60, s59, 7168
  buffer_load_dwordx4 v[76:79], v2, s[28:31], s59 offen offset:0 sc1
  buffer_load_dwordx4 v[84:87], v2, s[28:31], s60 offen offset:0 sc1
  s_add_u32 s33, s57, s58
  s_and_b32 s33, s33, 3
  s_and_b32 s59, s57, 12
  s_or_b32 s59, s59, s33
  s_mul_i32 s59, s59, 28672
  s_add_u32 s59, s59, s56
  s_add_u32 s57, s57, 1
  s_add_u32 s60, s59, 7168
  buffer_load_dwordx4 v[92:95], v2, s[28:31], s59 offen offset:0 sc1
  buffer_load_dwordx4 v[100:103], v2, s[28:31], s60 offen offset:0 sc1
  s_add_u32 s33, s57, s58
  s_and_b32 s33, s33, 3
  s_and_b32 s59, s57, 12
  s_or_b32 s59, s59, s33
  s_mul_i32 s59, s59, 28672
  s_add_u32 s59, s59, s56
  s_add_u32 s57, s57, 1
  s_add_u32 s60, s59, 7168
  buffer_load_dwordx4 v[108:111], v2, s[28:31], s59 offen offset:0 sc1
  buffer_load_dwordx4 v[116:119], v2, s[28:31], s60 offen offset:0 sc1
  s_mov_b32 s37, 3
L_sequential_preLN__mha_block__mixer_gmlp__prompt_kernel_p5c_loopb:
  s_waitcnt vmcnt(7) lgkmcnt(0)
  v_mfma_f32_16x16x32_bf16 v[124:127], v[60:63], v[28:31], v[124:127]
  ds_read_b128 v[44:47], v15 offset:0
  ds_read_b128 v[48:51], v15 offset:2048
  v_mfma_f32_16x16x32_bf16 v[128:131], v[60:63], v[32:35], v[128:131]
  ds_read_b128 v[52:55], v16 offset:0
  ds_read_b128 v[56:59], v16 offset:2048
  v_mfma_f32_16x16x32_bf16 v[140:143], v[60:63], v[36:39], v[140:143]
  s_add_u32 s33, s57, s58
  s_and_b32 s33, s33, 3
  v_mfma_f32_16x16x32_bf16 v[144:147], v[60:63], v[40:43], v[144:147]
  s_and_b32 s59, s57, 12
  s_or_b32 s59, s59, s33
  s_mul_i32 s59, s59, 28672
  s_add_u32 s59, s59, s56
  s_add_u32 s57, s57, 1
  s_add_u32 s60, s59, 7168
  v_add_u32 v13, s46, v9
  v_add_u32 v14, s46, v10
  v_add_u32 v15, s46, v11
  v_add_u32 v16, s46, v12
  s_add_u32 s46, s46, 16384
  s_cmp_eq_u32 s46, 163840
  s_cselect_b32 s46, 0, s46
  buffer_load_dwordx4 v[60:63], v2, s[28:31], s59 offen offset:0 sc1
  s_waitcnt vmcnt(7) lgkmcnt(0)
  v_mfma_f32_16x16x32_bf16 v[124:127], v[68:71], v[44:47], v[124:127]
  ds_read_b128 v[28:31], v13 offset:0
  ds_read_b128 v[32:35], v13 offset:2048
  v_mfma_f32_16x16x32_bf16 v[128:131], v[68:71], v[48:51], v[128:131]
  ds_read_b128 v[36:39], v14 offset:0
  ds_read_b128 v[40:43], v14 offset:2048
  v_mfma_f32_16x16x32_bf16 v[140:143], v[68:71], v[52:55], v[140:143]
  v_mfma_f32_16x16x32_bf16 v[144:147], v[68:71], v[56:59], v[144:147]
  buffer_load_dwordx4 v[68:71], v2, s[28:31], s60 offen offset:0 sc1
  s_waitcnt vmcnt(7) lgkmcnt(0)
  v_mfma_f32_16x16x32_bf16 v[124:127], v[76:79], v[28:31], v[124:127]
  ds_read_b128 v[44:47], v15 offset:0
  ds_read_b128 v[48:51], v15 offset:2048
  v_mfma_f32_16x16x32_bf16 v[128:131], v[76:79], v[32:35], v[128:131]
  ds_read_b128 v[52:55], v16 offset:0
  ds_read_b128 v[56:59], v16 offset:2048
  v_mfma_f32_16x16x32_bf16 v[140:143], v[76:79], v[36:39], v[140:143]
  s_add_u32 s33, s57, s58
  s_and_b32 s33, s33, 3
  v_mfma_f32_16x16x32_bf16 v[144:147], v[76:79], v[40:43], v[144:147]
  s_and_b32 s59, s57, 12
  s_or_b32 s59, s59, s33
  s_mul_i32 s59, s59, 28672
  s_add_u32 s59, s59, s56
  s_add_u32 s57, s57, 1
  s_add_u32 s60, s59, 7168
  v_add_u32 v13, s46, v9
  v_add_u32 v14, s46, v10
  v_add_u32 v15, s46, v11
  v_add_u32 v16, s46, v12
  s_add_u32 s46, s46, 16384
  s_cmp_eq_u32 s46, 163840
  s_cselect_b32 s46, 0, s46
  buffer_load_dwordx4 v[76:79], v2, s[28:31], s59 offen offset:0 sc1
  s_waitcnt vmcnt(7) lgkmcnt(0)
  v_mfma_f32_16x16x32_bf16 v[124:127], v[84:87], v[44:47], v[124:127]
  ds_read_b128 v[28:31], v13 offset:0
  ds_read_b128 v[32:35], v13 offset:2048
  v_mfma_f32_16x16x32_bf16 v[128:131], v[84:87], v[48:51], v[128:131]
  ds_read_b128 v[36:39], v14 offset:0
  ds_read_b128 v[40:43], v14 offset:2048
  v_mfma_f32_16x16x32_bf16 v[140:143], v[84:87], v[52:55], v[140:143]
  v_mfma_f32_16x16x32_bf16 v[144:147], v[84:87], v[56:59], v[144:147]
  buffer_load_dwordx4 v[84:87], v2, s[28:31], s60 offen offset:0 sc1
  s_waitcnt vmcnt(7) lgkmcnt(0)
  v_mfma_f32_16x16x32_bf16 v[124:127], v[92:95], v[28:31], v[124:127]
  ds_read_b128 v[44:47], v15 offset:0
  ds_read_b128 v[48:51], v15 offset:2048
  v_mfma_f32_16x16x32_bf16 v[128:131], v[92:95], v[32:35], v[128:131]
  ds_read_b128 v[52:55], v16 offset:0
  ds_read_b128 v[56:59], v16 offset:2048
  v_mfma_f32_16x16x32_bf16 v[140:143], v[92:95], v[36:39], v[140:143]
  s_add_u32 s33, s57, s58
  s_and_b32 s33, s33, 3
  v_mfma_f32_16x16x32_bf16 v[144:147], v[92:95], v[40:43], v[144:147]
  s_and_b32 s59, s57, 12
  s_or_b32 s59, s59, s33
  s_mul_i32 s59, s59, 28672
  s_add_u32 s59, s59, s56
  s_add_u32 s57, s57, 1
  s_add_u32 s60, s59, 7168
  v_add_u32 v13, s46, v9
  v_add_u32 v14, s46, v10
  v_add_u32 v15, s46, v11
  v_add_u32 v16, s46, v12
  s_add_u32 s46, s46, 16384
  s_cmp_eq_u32 s46, 163840
  s_cselect_b32 s46, 0, s46
  buffer_load_dwordx4 v[92:95], v2, s[28:31], s59 offen offset:0 sc1
  s_waitcnt vmcnt(7) lgkmcnt(0)
  v_mfma_f32_16x16x32_bf16 v[124:127], v[100:103], v[44:47], v[124:127]
  ds_read_b128 v[28:31], v13 offset:0
  ds_read_b128 v[32:35], v13 offset:2048
  v_mfma_f32_16x16x32_bf16 v[128:131], v[100:103], v[48:51], v[128:131]
  ds_read_b128 v[36:39], v14 offset:0
  ds_read_b128 v[40:43], v14 offset:2048
  v_mfma_f32_16x16x32_bf16 v[140:143], v[100:103], v[52:55], v[140:143]
  v_mfma_f32_16x16x32_bf16 v[144:147], v[100:103], v[56:59], v[144:147]
  buffer_load_dwordx4 v[100:103], v2, s[28:31], s60 offen offset:0 sc1
  s_waitcnt vmcnt(7) lgkmcnt(0)
  v_mfma_f32_16x16x32_bf16 v[124:127], v[108:111], v[28:31], v[124:127]
  ds_read_b128 v[44:47], v15 offset:0
  ds_read_b128 v[48:51], v15 offset:2048
  v_mfma_f32_16x16x32_bf16 v[128:131], v[108:111], v[32:35], v[128:131]
  ds_read_b128 v[52:55], v16 offset:0
  ds_read_b128 v[56:59], v16 offset:2048
  v_mfma_f32_16x16x32_bf16 v[140:143], v[108:111], v[36:39], v[140:143]
  s_add_u32 s33, s57, s58
  s_and_b32 s33, s33, 3
  v_mfma_f32_16x16x32_bf16 v[144:147], v[108:111], v[40:43], v[144:147]
  s_and_b32 s59, s57, 12
  s_or_b32 s59, s59, s33
  s_mul_i32 s59, s59, 28672
  s_add_u32 s59, s59, s56
  s_add_u32 s57, s57, 1
  s_add_u32 s60, s59, 7168
  v_add_u32 v13, s46, v9
  v_add_u32 v14, s46, v10
  v_add_u32 v15, s46, v11
  v_add_u32 v16, s46, v12
  s_add_u32 s46, s46, 16384
  s_cmp_eq_u32 s46, 163840
  s_cselect_b32 s46, 0, s46
  buffer_load_dwordx4 v[108:111], v2, s[28:31], s59 offen offset:0 sc1
  s_waitcnt vmcnt(7) lgkmcnt(0)
  v_mfma_f32_16x16x32_bf16 v[124:127], v[116:119], v[44:47], v[124:127]
  ds_read_b128 v[28:31], v13 offset:0
  ds_read_b128 v[32:35], v13 offset:2048
  v_mfma_f32_16x16x32_bf16 v[128:131], v[116:119], v[48:51], v[128:131]
  ds_read_b128 v[36:39], v14 offset:0
  ds_read_b128 v[40:43], v14 offset:2048
  v_mfma_f32_16x16x32_bf16 v[140:143], v[116:119], v[52:55], v[140:143]
  s_sub_u32 s37, s37, 1
  s_cmp_lg_u32 s37, 0
  v_mfma_f32_16x16x32_bf16 v[144:147], v[116:119], v[56:59], v[144:147]
  buffer_load_dwordx4 v[116:119], v2, s[28:31], s60 offen offset:0 sc1
  s_barrier
  s_cbranch_scc1 L_sequential_preLN__mha_block__mixer_gmlp__prompt_kernel_p5c_loopb
  s_add_u32 s32, s45, 0xa00000
  buffer_load_dwordx4 v[20:23], v19, s[28:31], s32 offen offset:0 sc1
  s_waitcnt vmcnt(8) lgkmcnt(0)
  v_mfma_f32_16x16x32_bf16 v[124:127], v[60:63], v[28:31], v[124:127]
  ds_read_b128 v[44:47], v15 offset:0
  ds_read_b128 v[48:51], v15 offset:2048
  v_mfma_f32_16x16x32_bf16 v[128:131], v[60:63], v[32:35], v[128:131]
  ds_read_b128 v[52:55], v16 offset:0
  ds_read_b128 v[56:59], v16 offset:2048
  v_mfma_f32_16x16x32_bf16 v[140:143], v[60:63], v[36:39], v[140:143]
  v_add_u32 v13, s46, v9
  v_add_u32 v14, s46, v10
  v_mfma_f32_16x16x32_bf16 v[144:147], v[60:63], v[40:43], v[144:147]
  v_add_u32 v15, s46, v11
  v_add_u32 v16, s46, v12
  s_add_u32 s46, s46, 16384
  s_cmp_eq_u32 s46, 163840
  s_cselect_b32 s46, 0, s46
  s_waitcnt vmcnt(7) lgkmcnt(0)
  v_mfma_f32_16x16x32_bf16 v[124:127], v[68:71], v[44:47], v[124:127]
  ds_read_b128 v[28:31], v13 offset:0
  ds_read_b128 v[32:35], v13 offset:2048
  v_mfma_f32_16x16x32_bf16 v[128:131], v[68:71], v[48:51], v[128:131]
  ds_read_b128 v[36:39], v14 offset:0
  ds_read_b128 v[40:43], v14 offset:2048
  v_mfma_f32_16x16x32_bf16 v[140:143], v[68:71], v[52:55], v[140:143]
  v_mfma_f32_16x16x32_bf16 v[144:147], v[68:71], v[56:59], v[144:147]
  s_waitcnt vmcnt(6) lgkmcnt(0)
  v_mfma_f32_16x16x32_bf16 v[124:127], v[76:79], v[28:31], v[124:127]
  ds_read_b128 v[44:47], v15 offset:0
  ds_read_b128 v[48:51], v15 offset:2048
  v_mfma_f32_16x16x32_bf16 v[128:131], v[76:79], v[32:35], v[128:131]
  ds_read_b128 v[52:55], v16 offset:0
  ds_read_b128 v[56:59], v16 offset:2048
  v_mfma_f32_16x16x32_bf16 v[140:143], v[76:79], v[36:39], v[140:143]
  v_add_u32 v13, s46, v9
  v_add_u32 v14, s46, v10
  v_mfma_f32_16x16x32_bf16 v[144:147], v[76:79], v[40:43], v[144:147]
  v_add_u32 v15, s46, v11
  v_add_u32 v16, s46, v12
  s_add_u32 s46, s46, 16384
  s_cmp_eq_u32 s46, 163840
  s_cselect_b32 s46, 0, s46
  s_waitcnt vmcnt(5) lgkmcnt(0)
  v_mfma_f32_16x16x32_bf16 v[124:127], v[84:87], v[44:47], v[124:127]
  ds_read_b128 v[28:31], v13 offset:0
  ds_read_b128 v[32:35], v13 offset:2048
  v_mfma_f32_16x16x32_bf16 v[128:131], v[84:87], v[48:51], v[128:131]
  ds_read_b128 v[36:39], v14 offset:0
  ds_read_b128 v[40:43], v14 offset:2048
  v_mfma_f32_16x16x32_bf16 v[140:143], v[84:87], v[52:55], v[140:143]
  v_mfma_f32_16x16x32_bf16 v[144:147], v[84:87], v[56:59], v[144:147]
  s_waitcnt vmcnt(4) lgkmcnt(0)
  v_mfma_f32_16x16x32_bf16 v[124:127], v[92:95], v[28:31], v[124:127]
  ds_read_b128 v[44:47], v15 offset:0
  ds_read_b128 v[48:51], v15 offset:2048
  v_mfma_f32_16x16x32_bf16 v[128:131], v[92:95], v[32:35], v[128:131]
  ds_read_b128 v[52:55], v16 offset:0
  ds_read_b128 v[56:59], v16 offset:2048
  v_mfma_f32_16x16x32_bf16 v[140:143], v[92:95], v[36:39], v[140:143]
  v_add_u32 v13, s46, v9
  v_add_u32 v14, s46, v10
  v_mfma_f32_16x16x32_bf16 v[144:147], v[92:95], v[40:43], v[144:147]
  v_add_u32 v15, s46, v11
  v_add_u32 v16, s46, v12
  s_add_u32 s46, s46, 16384
  s_cmp_eq_u32 s46, 163840
  s_cselect_b32 s46, 0, s46
  s_waitcnt vmcnt(3) lgkmcnt(0)
  v_mfma_f32_16x16x32_bf16 v[124:127], v[100:103], v[44:47], v[124:127]
  ds_read_b128 v[28:31], v13 offset:0
  ds_read_b128 v[32:35], v13 offset:2048
  v_mfma_f32_16x16x32_bf16 v[128:131], v[100:103], v[48:51], v[128:131]
  ds_read_b128 v[36:39], v14 offset:0
  ds_read_b128 v[40:43], v14 offset:2048
  v_mfma_f32_16x16x32_bf16 v[140:143], v[100:103], v[52:55], v[140:143]
  v_mfma_f32_16x16x32_bf16 v[144:147], v[100:103], v[56:59], v[144:147]
  s_waitcnt vmcnt(2) lgkmcnt(0)
  v_mfma_f32_16x16x32_bf16 v[124:127], v[108:111], v[28:31], v[124:127]
  ds_read_b128 v[44:47], v15 offset:0
  ds_read_b128 v[48:51], v15 offset:2048
  v_mfma_f32_16x16x32_bf16 v[128:131], v[108:111], v[32:35], v[128:131]
  ds_read_b128 v[52:55], v16 offset:0
  ds_read_b128 v[56:59], v16 offset:2048
  v_mfma_f32_16x16x32_bf16 v[140:143], v[108:111], v[36:39], v[140:143]
  v_add_u32 v13, s46, v9
  v_add_u32 v14, s46, v10
  v_mfma_f32_16x16x32_bf16 v[144:147], v[108:111], v[40:43], v[144:147]
  v_add_u32 v15, s46, v11
  v_add_u32 v16, s46, v12
  s_add_u32 s46, s46, 16384
  s_cmp_eq_u32 s46, 163840
  s_cselect_b32 s46, 0, s46
  s_waitcnt vmcnt(1) lgkmcnt(0)
  v_mfma_f32_16x16x32_bf16 v[124:127], v[116:119], v[44:47], v[124:127]
  v_mfma_f32_16x16x32_bf16 v[128:131], v[116:119], v[48:51], v[128:131]
  v_mfma_f32_16x16x32_bf16 v[140:143], v[116:119], v[52:55], v[140:143]
  v_mfma_f32_16x16x32_bf16 v[144:147], v[116:119], v[56:59], v[144:147]
  s_lshl_b32 s32, s34, 12
  s_add_u32 s32, s32, 114688
  v_add_u32 v4, s32, v2
  s_xor_b32 s32, s34, 4
  s_lshl_b32 s32, s32, 12
  s_add_u32 s32, s32, 114688
  v_add_u32 v5, s32, v2
  s_nop 1
  ds_write_b128 v4, v[140:143] offset:0
  ds_write_b128 v4, v[144:147] offset:1024
  s_waitcnt vmcnt(0)
  v_lshlrev_b32 v17, 16, v17
  v_lshlrev_b32 v18, 16, v18
  v_permlane32_swap_b32 v20, v22
  v_permlane32_swap_b32 v21, v23
  s_waitcnt lgkmcnt(0)
  s_barrier
  ds_read_b128 v[44:47], v5 offset:0
  ds_read_b128 v[48:51], v5 offset:1024
  s_add_u32 s32, s45, 0x1200000
  v_lshlrev_b32 v28, 16, v20
  v_and_b32 v29, 0xffff0000, v20
  v_lshlrev_b32 v30, 16, v21
  v_and_b32 v31, 0xffff0000, v21
  v_lshlrev_b32 v32, 16, v22
  v_and_b32 v33, 0xffff0000, v22
  v_lshlrev_b32 v34, 16, v23
  v_and_b32 v35, 0xffff0000, v23
  v_add_f32 v124, v124, v17
  v_add_f32 v125, v125, v17
  v_add_f32 v126, v126, v17
  v_add_f32 v127, v127, v17
  v_add_f32 v128, v128, v18
  v_add_f32 v129, v129, v18
  v_add_f32 v130, v130, v18
  v_add_f32 v131, v131, v18
  s_waitcnt lgkmcnt(0)
  v_add_f32 v124, v124, v44
  v_mul_f32 v124, v124, v28
  v_add_f32 v125, v125, v45
  v_mul_f32 v125, v125, v29
  v_add_f32 v126, v126, v46
  v_mul_f32 v126, v126, v30
  v_add_f32 v127, v127, v47
  v_mul_f32 v127, v127, v31
  v_add_f32 v128, v128, v48
  v_mul_f32 v128, v128, v32
  v_add_f32 v129, v129, v49
  v_mul_f32 v129, v129, v33
  v_add_f32 v130, v130, v50
  v_mul_f32 v130, v130, v34
  v_add_f32 v131, v131, v51
  v_mul_f32 v131, v131, v35
  v_cvt_pk_bf16_f32 v20, v124, v125
  v_cvt_pk_bf16_f32 v21, v126, v127
  v_cvt_pk_bf16_f32 v22, v128, v129
  v_cvt_pk_bf16_f32 v23, v130, v131
  s_nop 1
  v_permlane32_swap_b32 v20, v22
  v_permlane32_swap_b32 v21, v23
  buffer_store_dwordx4 v[20:23], v19, s[28:31], s32 offen offset:0 sc1
L_sequential_preLN__mha_block__mixer_gmlp__prompt_kernel_p5c_fin:
  s_lshl_b32 s48, s48, 7
  s_add_u32 s48, s48, 0x1700000
  v_lshlrev_b32 v8, 15, v1
  v_mov_b32 v4, s38
  v_mov_b32 v5, s39
  s_waitcnt vmcnt(0)
  s_barrier
  s_cmp_lg_u32 s34, 0
  s_cbranch_scc1 L_sequential_preLN__mha_block__mixer_gmlp__prompt_kernel_p5c_nofl
  s_mov_b64 exec, 3
  buffer_store_dwordx2 v[4:5], v8, s[28:31], s48 offen sc1
  s_mov_b64 exec, -1
L_sequential_preLN__mha_block__mixer_gmlp__prompt_kernel_p5c_nofl:
  s_lshl_b32 s32, s35, 2
  s_and_b32 s33, s36, 3
  s_add_u32 s41, s32, s33
  s_lshr_b32 s42, s36, 2
  s_cmp_ge_u32 s34, 4
  s_cbranch_scc1 L_sequential_preLN__mha_block__mixer_gmlp__prompt_kernel_p6c_idle
  s_and_b32 s43, s34, 1
  s_lshr_b32 s44, s34, 1
  s_lshl_b32 s45, s41, 1
  s_add_u32 s45, s45, s43
  s_lshl_b32 s48, s45, 4
  s_lshl_b32 s33, s42, 1
  s_add_u32 s48, s48, s33
  s_add_u32 s48, s48, s44
  s_lshl_b32 s46, s48, 11
  s_add_u32 s46, s46, 0x800000
  s_lshl_b32 s47, s45, 15
  s_lshl_b32 s33, s42, 7
  s_add_u32 s47, s47, s33
  s_lshl_b32 s33, s44, 6
  s_add_u32 s47, s47, s33
  v_lshrrev_b32 v3, 5, v1
  v_lshlrev_b32 v8, 8, v3
  v_bfe_u32 v3, v1, 2, 2
  v_lshl_add_u32 v8, v3, 6, v8
  v_bfe_u32 v3, v1, 4, 1
  v_lshl_add_u32 v8, v3, 5, v8
  v_and_b32 v3, 3, v1
  v_lshl_add_u32 v8, v3, 3, v8
  s_lshl_b32 s32, s44, 10
  v_add_u32 v8, s32, v8
  s_lshl_b32 s32, s43, 12
  v_add_u32 v9, s32, v2
  v_add_u32 v132, 65536, v8
  v_add_u32 v133, 131072, v8
  v_add_u32 v134, 65536, v9
  v_add_u32 v135, 131072, v9
  v_mov_b32 v100, 0
  v_mov_b32 v101, 0
  v_mov_b32 v102, 0
  v_mov_b32 v103, 0
  v_mov_b32 v104, 0
  v_mov_b32 v105, 0
  v_mov_b32 v106, 0
  v_mov_b32 v107, 0
  v_mov_b32 v108, 0
  v_mov_b32 v109, 0
  v_mov_b32 v110, 0
  v_mov_b32 v111, 0
  v_mov_b32 v112, 0
  v_mov_b32 v113, 0
  v_mov_b32 v114, 0
  v_mov_b32 v115, 0
  v_and_b32 v3, 31, v1
  v_lshrrev_b32 v6, 5, v1
  s_lshl_b32 s32, s44, 2
  v_add_u32 v6, s32, v6
  v_and_b32 v4, 7, v1
  v_xor_b32 v6, v6, v4
  s_lshl_b32 s32, s43, 12
  s_add_u32 s32, s32, 81920
  v_lshl_add_u32 v136, v3, 7, s32
  v_lshl_add_u32 v136, v6, 4, v136
  v_xor_b32 v137, 32, v136
  s_lshl_b32 s32, s34, 11
  s_add_u32 s32, s32, 81920
  v_add_u32 v138, s32, v2
  v_lshrrev_b32 v6, 3, v1
  v_xor_b32 v4, v4, v6
  v_lshlrev_b32 v3, 10, v6
  v_lshl_add_u32 v3, v4, 4, v3
  s_lshl_b32 s47, s41, 16
  s_lshl_b32 s33, s34, 14
  s_add_u32 s47, s47, s33
  s_lshl_b32 s33, s42, 7
  s_add_u32 s47, s47, s33
  s_mov_b32 s52, s20
  s_and_b32 s53, s21, 0xffff
  s_mov_b32 s54, 0x200000
  s_mov_b32 s55, 0x20000
  buffer_load_dwordx4 v[12:15], v2, s[28:31], s46 offen sc1
  buffer_load_dwordx4 v[16:19], v2, s[28:31], s46 offen offset:1024 sc1
  s_barrier
  ds_read_b64_tr_b16 v[20:21], v8 offset:0
  ds_read_b64_tr_b16 v[22:23], v8 offset:512
  ds_read_b64_tr_b16 v[24:25], v8 offset:2048
  ds_read_b64_tr_b16 v[26:27], v8 offset:2560
  ds_read_b64_tr_b16 v[28:29], v8 offset:4096
  ds_read_b64_tr_b16 v[30:31], v8 offset:4608
  ds_read_b64_tr_b16 v[32:33], v8 offset:6144
  ds_read_b64_tr_b16 v[34:35], v8 offset:6656
  s_barrier
  ds_read_b128 v[68:71], v134 offset:49152
  ds_read_b128 v[72:75], v134 offset:50176
  ds_read_b128 v[76:79], v134 offset:51200
  ds_read_b128 v[80:83], v134 offset:52224
  ds_read_b64_tr_b16 v[36:37], v8 offset:8192
  ds_read_b64_tr_b16 v[38:39], v8 offset:8704
  ds_read_b64_tr_b16 v[40:41], v8 offset:10240
  ds_read_b64_tr_b16 v[42:43], v8 offset:10752
  ds_read_b64_tr_b16 v[44:45], v8 offset:12288
  ds_read_b64_tr_b16 v[46:47], v8 offset:12800
  ds_read_b64_tr_b16 v[48:49], v8 offset:14336
  ds_read_b64_tr_b16 v[50:51], v8 offset:14848
  s_waitcnt lgkmcnt(8)
  s_barrier
  ds_read_b128 v[84:87], v134 offset:57344
  ds_read_b128 v[88:91], v134 offset:58368
  v_mfma_f32_32x32x16_bf16 v[100:115], v[20:23], v[68:71], v[100:115]
  ds_read_b128 v[92:95], v134 offset:59392
  ds_read_b128 v[96:99], v134 offset:60416
  ds_read_b64_tr_b16 v[52:53], v8 offset:16384
  v_mfma_f32_32x32x16_bf16 v[100:115], v[24:27], v[72:75], v[100:115]
  ds_read_b64_tr_b16 v[54:55], v8 offset:16896
  ds_read_b64_tr_b16 v[56:57], v8 offset:18432
  ds_read_b64_tr_b16 v[58:59], v8 offset:18944
  v_mfma_f32_32x32x16_bf16 v[100:115], v[28:31], v[76:79], v[100:115]
  ds_read_b64_tr_b16 v[60:61], v8 offset:20480
  ds_read_b64_tr_b16 v[62:63], v8 offset:20992
  ds_read_b64_tr_b16 v[64:65], v8 offset:22528
  v_mfma_f32_32x32x16_bf16 v[100:115], v[32:35], v[80:83], v[100:115]
  ds_read_b64_tr_b16 v[66:67], v8 offset:23040
  s_waitcnt lgkmcnt(8)
  s_barrier
  ds_read_b128 v[68:71], v135 offset:0
  ds_read_b128 v[72:75], v135 offset:1024
  v_mfma_f32_32x32x16_bf16 v[100:115], v[36:39], v[84:87], v[100:115]
  ds_read_b128 v[76:79], v135 offset:2048
  ds_read_b128 v[80:83], v135 offset:3072
  ds_read_b64_tr_b16 v[20:21], v8 offset:24576
  v_mfma_f32_32x32x16_bf16 v[100:115], v[40:43], v[88:91], v[100:115]
  ds_read_b64_tr_b16 v[22:23], v8 offset:25088
  ds_read_b64_tr_b16 v[24:25], v8 offset:26624
  ds_read_b64_tr_b16 v[26:27], v8 offset:27136
  v_mfma_f32_32x32x16_bf16 v[100:115], v[44:47], v[92:95], v[100:115]
  ds_read_b64_tr_b16 v[28:29], v8 offset:28672
  ds_read_b64_tr_b16 v[30:31], v8 offset:29184
  ds_read_b64_tr_b16 v[32:33], v8 offset:30720
  v_mfma_f32_32x32x16_bf16 v[100:115], v[48:51], v[96:99], v[100:115]
  ds_read_b64_tr_b16 v[34:35], v8 offset:31232
  s_waitcnt lgkmcnt(8)
  s_barrier
  ds_read_b128 v[84:87], v135 offset:8192
  ds_read_b128 v[88:91], v135 offset:9216
  v_mfma_f32_32x32x16_bf16 v[100:115], v[52:55], v[68:71], v[100:115]
  ds_read_b128 v[92:95], v135 offset:10240
  ds_read_b128 v[96:99], v135 offset:11264
  ds_read_b64_tr_b16 v[36:37], v8 offset:32768
  v_mfma_f32_32x32x16_bf16 v[100:115], v[56:59], v[72:75], v[100:115]
  ds_read_b64_tr_b16 v[38:39], v8 offset:33280
  ds_read_b64_tr_b16 v[40:41], v8 offset:34816
  ds_read_b64_tr_b16 v[42:43], v8 offset:35328
  v_mfma_f32_32x32x16_bf16 v[100:115], v[60:63], v[76:79], v[100:115]
  ds_read_b64_tr_b16 v[44:45], v8 offset:36864
  ds_read_b64_tr_b16 v[46:47], v8 offset:37376
  ds_read_b64_tr_b16 v[48:49], v8 offset:38912
  v_mfma_f32_32x32x16_bf16 v[100:115], v[64:67], v[80:83], v[100:115]
  ds_read_b64_tr_b16 v[50:51], v8 offset:39424
  s_waitcnt vmcnt(0)
  v_lshlrev_b32 v116, 16, v12
  v_and_b32 v117, 0xffff0000, v12
  v_lshlrev_b32 v118, 16, v13
  v_and_b32 v119, 0xffff0000, v13
  v_lshlrev_b32 v120, 16, v14
  v_and_b32 v121, 0xffff0000, v14
  v_lshlrev_b32 v122, 16, v15
  v_and_b32 v123, 0xffff0000, v15
  v_lshlrev_b32 v124, 16, v16
  v_and_b32 v125, 0xffff0000, v16
  v_lshlrev_b32 v126, 16, v17
  v_and_b32 v127, 0xffff0000, v17
  v_lshlrev_b32 v128, 16, v18
  v_and_b32 v129, 0xffff0000, v18
  v_lshlrev_b32 v130, 16, v19
  v_and_b32 v131, 0xffff0000, v19
  s_waitcnt lgkmcnt(8)
  s_barrier
  ds_read_b128 v[68:71], v135 offset:16384
  ds_read_b128 v[72:75], v135 offset:17408
  v_mfma_f32_32x32x16_bf16 v[100:115], v[20:23], v[84:87], v[100:115]
  ds_read_b128 v[76:79], v135 offset:18432
  ds_read_b128 v[80:83], v135 offset:19456
  ds_read_b64_tr_b16 v[52:53], v8 offset:40960
  v_mfma_f32_32x32x16_bf16 v[100:115], v[24:27], v[88:91], v[100:115]
  ds_read_b64_tr_b16 v[54:55], v8 offset:41472
  ds_read_b64_tr_b16 v[56:57], v8 offset:43008
  ds_read_b64_tr_b16 v[58:59], v8 offset:43520
  v_mfma_f32_32x32x16_bf16 v[100:115], v[28:31], v[92:95], v[100:115]
  ds_read_b64_tr_b16 v[60:61], v8 offset:45056
  ds_read_b64_tr_b16 v[62:63], v8 offset:45568
  ds_read_b64_tr_b16 v[64:65], v8 offset:47104
  v_mfma_f32_32x32x16_bf16 v[100:115], v[32:35], v[96:99], v[100:115]
  ds_read_b64_tr_b16 v[66:67], v8 offset:47616
  s_waitcnt lgkmcnt(8)
  s_barrier
  ds_read_b128 v[84:87], v135 offset:24576
  ds_read_b128 v[88:91], v135 offset:25600
  v_mfma_f32_32x32x16_bf16 v[100:115], v[36:39], v[68:71], v[100:115]
  ds_read_b128 v[92:95], v135 offset:26624
  ds_read_b128 v[96:99], v135 offset:27648
  ds_read_b64_tr_b16 v[20:21], v8 offset:49152
  v_mfma_f32_32x32x16_bf16 v[100:115], v[40:43], v[72:75], v[100:115]
  ds_read_b64_tr_b16 v[22:23], v8 offset:49664
  ds_read_b64_tr_b16 v[24:25], v8 offset:51200
  ds_read_b64_tr_b16 v[26:27], v8 offset:51712
  v_mfma_f32_32x32x16_bf16 v[100:115], v[44:47], v[76:79], v[100:115]
  ds_read_b64_tr_b16 v[28:29], v8 offset:53248
  ds_read_b64_tr_b16 v[30:31], v8 offset:53760
  ds_read_b64_tr_b16 v[32:33], v8 offset:55296
  v_mfma_f32_32x32x16_bf16 v[100:115], v[48:51], v[80:83], v[100:115]
  ds_read_b64_tr_b16 v[34:35], v8 offset:55808
  s_waitcnt lgkmcnt(8)
  s_barrier
  ds_read_b128 v[68:71], v9 offset:0
  ds_read_b128 v[72:75], v9 offset:1024
  v_mfma_f32_32x32x16_bf16 v[100:115], v[52:55], v[84:87], v[100:115]
  ds_read_b128 v[76:79], v9 offset:2048
  ds_read_b128 v[80:83], v9 offset:3072
  ds_read_b64_tr_b16 v[36:37], v8 offset:57344
  v_mfma_f32_32x32x16_bf16 v[100:115], v[56:59], v[88:91], v[100:115]
  ds_read_b64_tr_b16 v[38:39], v8 offset:57856
  ds_read_b64_tr_b16 v[40:41], v8 offset:59392
  ds_read_b64_tr_b16 v[42:43], v8 offset:59904
  v_mfma_f32_32x32x16_bf16 v[100:115], v[60:63], v[92:95], v[100:115]
  ds_read_b64_tr_b16 v[44:45], v8 offset:61440
  ds_read_b64_tr_b16 v[46:47], v8 offset:61952
  ds_read_b64_tr_b16 v[48:49], v8 offset:63488
  v_mfma_f32_32x32x16_bf16 v[100:115], v[64:67], v[96:99], v[100:115]
  ds_read_b64_tr_b16 v[50:51], v8 offset:64000
  s_waitcnt lgkmcnt(8)
  s_barrier
  ds_read_b128 v[84:87], v134 offset:49152
  ds_read_b128 v[88:91], v134 offset:50176
  v_mfma_f32_32x32x16_bf16 v[100:115], v[20:23], v[68:71], v[100:115]
  ds_read_b128 v[92:95], v134 offset:51200
  ds_read_b128 v[96:99], v134 offset:52224
  ds_read_b64_tr_b16 v[52:53], v132 offset:0
  v_mfma_f32_32x32x16_bf16 v[100:115], v[24:27], v[72:75], v[100:115]
  ds_read_b64_tr_b16 v[54:55], v132 offset:512
  ds_read_b64_tr_b16 v[56:57], v132 offset:2048
  ds_read_b64_tr_b16 v[58:59], v132 offset:2560
  v_mfma_f32_32x32x16_bf16 v[100:115], v[28:31], v[76:79], v[100:115]
  ds_read_b64_tr_b16 v[60:61], v132 offset:4096
  ds_read_b64_tr_b16 v[62:63], v132 offset:4608
  ds_read_b64_tr_b16 v[64:65], v132 offset:6144
  v_mfma_f32_32x32x16_bf16 v[100:115], v[32:35], v[80:83], v[100:115]
  ds_read_b64_tr_b16 v[66:67], v132 offset:6656
  s_waitcnt lgkmcnt(8)
  s_barrier
  ds_read_b128 v[68:71], v9 offset:8192
  ds_read_b128 v[72:75], v9 offset:9216
  v_mfma_f32_32x32x16_bf16 v[100:115], v[36:39], v[84:87], v[100:115]
  ds_read_b128 v[76:79], v9 offset:10240
  ds_read_b128 v[80:83], v9 offset:11264
  ds_read_b64_tr_b16 v[20:21], v132 offset:8192
  v_mfma_f32_32x32x16_bf16 v[100:115], v[40:43], v[88:91], v[100:115]
  ds_read_b64_tr_b16 v[22:23], v132 offset:8704
  ds_read_b64_tr_b16 v[24:25], v132 offset:10240
  ds_read_b64_tr_b16 v[26:27], v132 offset:10752
  v_mfma_f32_32x32x16_bf16 v[100:115], v[44:47], v[92:95], v[100:115]
  ds_read_b64_tr_b16 v[28:29], v132 offset:12288
  ds_read_b64_tr_b16 v[30:31], v132 offset:12800
  ds_read_b64_tr_b16 v[32:33], v132 offset:14336
  v_mfma_f32_32x32x16_bf16 v[100:115], v[48:51], v[96:99], v[100:115]
  ds_read_b64_tr_b16 v[34:35], v132 offset:14848
  s_waitcnt lgkmcnt(8)
  s_barrier
  ds_read_b128 v[84:87], v134 offset:57344
  ds_read_b128 v[88:91], v134 offset:58368
  v_mfma_f32_32x32x16_bf16 v[100:115], v[52:55], v[68:71], v[100:115]
  ds_read_b128 v[92:95], v134 offset:59392
  ds_read_b128 v[96:99], v134 offset:60416
  ds_read_b64_tr_b16 v[36:37], v132 offset:16384
  v_mfma_f32_32x32x16_bf16 v[100:115], v[56:59], v[72:75], v[100:115]
  ds_read_b64_tr_b16 v[38:39], v132 offset:16896
  ds_read_b64_tr_b16 v[40:41], v132 offset:18432
  ds_read_b64_tr_b16 v[42:43], v132 offset:18944
  v_mfma_f32_32x32x16_bf16 v[100:115], v[60:63], v[76:79], v[100:115]
  ds_read_b64_tr_b16 v[44:45], v132 offset:20480
  ds_read_b64_tr_b16 v[46:47], v132 offset:20992
  ds_read_b64_tr_b16 v[48:49], v132 offset:22528
  v_mfma_f32_32x32x16_bf16 v[100:115], v[64:67], v[80:83], v[100:115]
  ds_read_b64_tr_b16 v[50:51], v132 offset:23040
  s_waitcnt lgkmcnt(8)
  s_barrier
  ds_read_b128 v[68:71], v9 offset:16384
  ds_read_b128 v[72:75], v9 offset:17408
  v_mfma_f32_32x32x16_bf16 v[100:115], v[20:23], v[84:87], v[100:115]
  ds_read_b128 v[76:79], v9 offset:18432
  ds_read_b128 v[80:83], v9 offset:19456
  ds_read_b64_tr_b16 v[52:53], v132 offset:24576
  v_mfma_f32_32x32x16_bf16 v[100:115], v[24:27], v[88:91], v[100:115]
  ds_read_b64_tr_b16 v[54:55], v132 offset:25088
  ds_read_b64_tr_b16 v[56:57], v132 offset:26624
  ds_read_b64_tr_b16 v[58:59], v132 offset:27136
  v_mfma_f32_32x32x16_bf16 v[100:115], v[28:31], v[92:95], v[100:115]
  ds_read_b64_tr_b16 v[60:61], v132 offset:28672
  ds_read_b64_tr_b16 v[62:63], v132 offset:29184
  ds_read_b64_tr_b16 v[64:65], v132 offset:30720
  v_mfma_f32_32x32x16_bf16 v[100:115], v[32:35], v[96:99], v[100:115]
  ds_read_b64_tr_b16 v[66:67], v132 offset:31232
  s_waitcnt lgkmcnt(8)
  s_barrier
  ds_read_b128 v[84:87], v135 offset:0
  ds_read_b128 v[88:91], v135 offset:1024
  v_mfma_f32_32x32x16_bf16 v[100:115], v[36:39], v[68:71], v[100:115]
  ds_read_b128 v[92:95], v135 offset:2048
  ds_read_b128 v[96:99], v135 offset:3072
  ds_read_b64_tr_b16 v[20:21], v132 offset:32768
  v_mfma_f32_32x32x16_bf16 v[100:115], v[40:43], v[72:75], v[100:115]
  ds_read_b64_tr_b16 v[22:23], v132 offset:33280
  ds_read_b64_tr_b16 v[24:25], v132 offset:34816
  ds_read_b64_tr_b16 v[26:27], v132 offset:35328
  v_mfma_f32_32x32x16_bf16 v[100:115], v[44:47], v[76:79], v[100:115]
  ds_read_b64_tr_b16 v[28:29], v132 offset:36864
  ds_read_b64_tr_b16 v[30:31], v132 offset:37376
  ds_read_b64_tr_b16 v[32:33], v132 offset:38912
  v_mfma_f32_32x32x16_bf16 v[100:115], v[48:51], v[80:83], v[100:115]
  ds_read_b64_tr_b16 v[34:35], v132 offset:39424
  s_waitcnt lgkmcnt(8)
  s_barrier
  ds_read_b128 v[68:71], v9 offset:24576
  ds_read_b128 v[72:75], v9 offset:25600
  v_mfma_f32_32x32x16_bf16 v[100:115], v[52:55], v[84:87], v[100:115]
  ds_read_b128 v[76:79], v9 offset:26624
  ds_read_b128 v[80:83], v9 offset:27648
  ds_read_b64_tr_b16 v[36:37], v132 offset:40960
  v_mfma_f32_32x32x16_bf16 v[100:115], v[56:59], v[88:91], v[100:115]
  ds_read_b64_tr_b16 v[38:39], v132 offset:41472
  ds_read_b64_tr_b16 v[40:41], v132 offset:43008
  ds_read_b64_tr_b16 v[42:43], v132 offset:43520
  v_mfma_f32_32x32x16_bf16 v[100:115], v[60:63], v[92:95], v[100:115]
  ds_read_b64_tr_b16 v[44:45], v132 offset:45056
  ds_read_b64_tr_b16 v[46:47], v132 offset:45568
  ds_read_b64_tr_b16 v[48:49], v132 offset:47104
  v_mfma_f32_32x32x16_bf16 v[100:115], v[64:67], v[96:99], v[100:115]
  ds_read_b64_tr_b16 v[50:51], v132 offset:47616
  s_waitcnt lgkmcnt(8)
  s_barrier
  ds_read_b128 v[84:87], v135 offset:8192
  ds_read_b128 v[88:91], v135 offset:9216
  v_mfma_f32_32x32x16_bf16 v[100:115], v[20:23], v[68:71], v[100:115]
  ds_read_b128 v[92:95], v135 offset:10240
  ds_read_b128 v[96:99], v135 offset:11264
  v_mfma_f32_32x32x16_bf16 v[100:115], v[24:27], v[72:75], v[100:115]
  v_mfma_f32_32x32x16_bf16 v[100:115], v[28:31], v[76:79], v[100:115]
  v_mfma_f32_32x32x16_bf16 v[100:115], v[32:35], v[80:83], v[100:115]
  s_waitcnt lgkmcnt(3)
  v_mfma_f32_32x32x16_bf16 v[100:115], v[36:39], v[84:87], v[100:115]
  s_waitcnt lgkmcnt(2)
  v_mfma_f32_32x32x16_bf16 v[100:115], v[40:43], v[88:91], v[100:115]
  s_waitcnt lgkmcnt(1)
  v_mfma_f32_32x32x16_bf16 v[100:115], v[44:47], v[92:95], v[100:115]
  s_waitcnt lgkmcnt(0)
  v_mfma_f32_32x32x16_bf16 v[100:115], v[48:51], v[96:99], v[100:115]
  s_nop 11
  v_add_f32 v100, v100, v116
  v_add_f32 v101, v101, v117
  v_add_f32 v102, v102, v118
  v_add_f32 v103, v103, v119
  v_add_f32 v104, v104, v120
  v_add_f32 v105, v105, v121
  v_add_f32 v106, v106, v122
  v_add_f32 v107, v107, v123
  v_add_f32 v108, v108, v124
  v_add_f32 v109, v109, v125
  v_add_f32 v110, v110, v126
  v_add_f32 v111, v111, v127
  v_add_f32 v112, v112, v128
  v_add_f32 v113, v113, v129
  v_add_f32 v114, v114, v130
  v_add_f32 v115, v115, v131
  v_cvt_pk_bf16_f32 v12, v100, v101
  v_cvt_pk_bf16_f32 v13, v102, v103
  v_cvt_pk_bf16_f32 v14, v104, v105
  v_cvt_pk_bf16_f32 v15, v106, v107
  v_cvt_pk_bf16_f32 v16, v108, v109
  v_cvt_pk_bf16_f32 v17, v110, v111
  v_cvt_pk_bf16_f32 v18, v112, v113
  v_cvt_pk_bf16_f32 v19, v114, v115
  s_nop 1
  v_permlane32_swap_b32 v12, v14
  v_permlane32_swap_b32 v13, v15
  v_permlane32_swap_b32 v16, v18
  v_permlane32_swap_b32 v17, v19
  ds_write_b128 v136, v[12:15]
  ds_write_b128 v137, v[16:19]
  s_waitcnt lgkmcnt(0)
  s_barrier
  ds_read_b128 v[12:15], v138
  ds_read_b128 v[16:19], v138 offset:1024
  s_add_u32 s32, s47, 8192
  s_waitcnt lgkmcnt(1)
  buffer_store_dwordx4 v[12:15], v3, s[52:55], s47 offen
  s_waitcnt lgkmcnt(0)
  buffer_store_dwordx4 v[16:19], v3, s[52:55], s32 offen
  s_or_b32 s32, s2, s34
  s_cbranch_scc1 L_sequential_preLN__mha_block__mixer_gmlp__prompt_kernel_p6c_end
  v_mov_b32 v6, 0
  v_mov_b32 v7, 0
  s_mov_b64 exec, 1
  global_store_dwordx2 v6, v[6:7], s[22:23]
  s_mov_b64 exec, -1
  s_branch L_sequential_preLN__mha_block__mixer_gmlp__prompt_kernel_p6c_end
L_sequential_preLN__mha_block__mixer_gmlp__prompt_kernel_p6c_idle:
  s_cmp_lg_u32 s34, 7
  s_cbranch_scc1 L_sequential_preLN__mha_block__mixer_gmlp__prompt_kernel_p6c_nopoll
  s_lshl_b32 s32, s41, 3
  s_add_u32 s32, s32, 8192
  s_and_b32 s33, s42, 1
  s_lshl_b32 s33, s33, 8
  s_add_u32 s32, s32, s33
  s_lshl_b32 s32, s32, 7
  s_add_u32 s32, s32, 0x1700000
  v_min_u32 v4, 7, v1
  v_lshlrev_b32 v4, 7, v4
  s_mov_b32 s37, 100000
  s_mov_b64 exec, 0xff
  s_branch L_sequential_preLN__mha_block__mixer_gmlp__prompt_kernel_p6c_pollg
L_sequential_preLN__mha_block__mixer_gmlp__prompt_kernel_p6c_poll:
  s_sleep 2
L_sequential_preLN__mha_block__mixer_gmlp__prompt_kernel_p6c_pollg:
  buffer_load_dwordx2 v[6:7], v4, s[28:31], s32 offen sc1
  s_sub_u32 s37, s37, 1
  s_cbranch_scc1 L_sequential_preLN__mha_block__mixer_gmlp__prompt_kernel_p6c_pollx
  s_waitcnt vmcnt(0)
  v_cmp_ne_u64 vcc, s[38:39], v[6:7]
  s_and_b64 exec, exec, vcc
  s_cbranch_scc1 L_sequential_preLN__mha_block__mixer_gmlp__prompt_kernel_p6c_poll
L_sequential_preLN__mha_block__mixer_gmlp__prompt_kernel_p6c_pollx:
  s_mov_b64 exec, -1
L_sequential_preLN__mha_block__mixer_gmlp__prompt_kernel_p6c_nopoll:
  s_barrier
  s_endpgm
L_sequential_preLN__mha_block__mixer_gmlp__prompt_kernel_p6c_end:
L_sequential_preLN__mha_block__mixer_gmlp__prompt_kernel_exit:
  s_endpgm
L_sequential_preLN__mha_block__mixer_gmlp__prompt_kernel_loader:
  s_setprio 3
  s_lshl_b32 s32, s36, 2
  s_add_u32 s32, s32, s40
  s_lshl_b32 s32, s32, 13
  s_cmp_ge_u32 s32, L_sequential_preLN__mha_block__mixer_gmlp__prompt_kernel_codeend-sequential_preLN__mha_block__mixer_gmlp__prompt_kernel
  s_cbranch_scc1 L_sequential_preLN__mha_block__mixer_gmlp__prompt_kernel_l0_noct
  s_getpc_b64 s[42:43]
L_sequential_preLN__mha_block__mixer_gmlp__prompt_kernel_l0_pc:
  s_sub_u32 s42, s42, L_sequential_preLN__mha_block__mixer_gmlp__prompt_kernel_l0_pc-sequential_preLN__mha_block__mixer_gmlp__prompt_kernel
  s_subb_u32 s43, s43, 0
  v_lshl_add_u32 v4, v1, 7, s32
  v_min_u32 v4, L_sequential_preLN__mha_block__mixer_gmlp__prompt_kernel_codeend-sequential_preLN__mha_block__mixer_gmlp__prompt_kernel-4, v4
  global_load_dword v3, v4, s[42:43]
L_sequential_preLN__mha_block__mixer_gmlp__prompt_kernel_l0_noct:
  s_and_b32 s32, s35, 3
  s_lshl_b32 s32, s32, 3
  s_and_b32 s33, s36, 7
  s_add_u32 s41, s32, s33
  s_lshr_b32 s32, s35, 2
  s_lshl_b32 s32, s32, 2
  s_lshr_b32 s42, s36, 3
  s_add_u32 s42, s42, s32
  s_and_b32 s50, s36, 7
  v_lshrrev_b32 v152, 2, v1
  v_mul_u32_u24 v152, 3072, v152
  v_and_b32 v153, 3, v1
  v_lshl_add_u32 v154, v153, 4, v152
  v_add_u32 v155, 64, v154
  v_add_u32 v154, 1024, v154
  s_mul_i32 s48, s40, 49152
  s_lshl_b32 s32, s42, 7
  s_add_u32 s48, s48, s32
  s_mul_i32 s49, s40, 6144
  s_add_u32 s49, s49, 65536
  s_waitcnt lgkmcnt(0)
  s_sub_u32 s44, s6, 1024
  s_subb_u32 s45, s7, 0
  s_and_b32 s45, s45, 0xffff
  s_mov_b32 s46, 0x180400
  s_mov_b32 s47, 0x20000
  s_barrier
  s_add_u32 m0, s49, 0
  s_mul_i32 s32, s50, 196608
  s_add_u32 s32, s32, s48
  buffer_load_dwordx4 v154, s[44:47], s32 offen lds
  buffer_load_dwordx4 v155, s[44:47], s32 offen offset:1024 lds
  s_add_u32 m0, m0, 2048
  s_add_u32 s32, s32, 1024
  buffer_load_dwordx4 v154, s[44:47], s32 offen lds
  buffer_load_dwordx4 v155, s[44:47], s32 offen offset:1024 lds
  s_add_u32 m0, m0, 2048
  s_add_u32 s32, s32, 1024
  buffer_load_dwordx4 v154, s[44:47], s32 offen lds
  buffer_load_dwordx4 v155, s[44:47], s32 offen offset:1024 lds
  s_add_u32 s50, s50, 1
  s_and_b32 s50, s50, 7
  s_add_u32 m0, s49, 24576
  s_mul_i32 s32, s50, 196608
  s_add_u32 s32, s32, s48
  buffer_load_dwordx4 v154, s[44:47], s32 offen lds
  buffer_load_dwordx4 v155, s[44:47], s32 offen offset:1024 lds
  s_add_u32 m0, m0, 2048
  s_add_u32 s32, s32, 1024
  buffer_load_dwordx4 v154, s[44:47], s32 offen lds
  buffer_load_dwordx4 v155, s[44:47], s32 offen offset:1024 lds
  s_add_u32 m0, m0, 2048
  s_add_u32 s32, s32, 1024
  buffer_load_dwordx4 v154, s[44:47], s32 offen lds
  buffer_load_dwordx4 v155, s[44:47], s32 offen offset:1024 lds
  s_add_u32 s50, s50, 1
  s_and_b32 s50, s50, 7
  s_mov_b32 s28, s24
  s_and_b32 s29, s25, 0xffff
  s_mov_b32 s30, 0x1a00000
  s_mov_b32 s31, 0x20000
  s_mov_b32 s52, s22
  s_and_b32 s53, s23, 0xffff
  s_mov_b32 s54, 0x100
  s_mov_b32 s55, 0x20000
  v_mov_b32 v158, 0
  s_lshl_b32 s32, s40, 8
  buffer_load_dwordx2 v[156:157], v158, s[52:55], s32 offen sc1
  s_waitcnt vmcnt(7)
  s_barrier
  s_add_u32 m0, s49, 49152
  s_mul_i32 s32, s50, 196608
  s_add_u32 s32, s32, s48
  buffer_load_dwordx4 v154, s[44:47], s32 offen lds
  buffer_load_dwordx4 v155, s[44:47], s32 offen offset:1024 lds
  s_add_u32 m0, m0, 2048
  s_add_u32 s32, s32, 1024
  buffer_load_dwordx4 v154, s[44:47], s32 offen lds
  buffer_load_dwordx4 v155, s[44:47], s32 offen offset:1024 lds
  s_add_u32 m0, m0, 2048
  s_add_u32 s32, s32, 1024
  buffer_load_dwordx4 v154, s[44:47], s32 offen lds
  buffer_load_dwordx4 v155, s[44:47], s32 offen offset:1024 lds
  s_add_u32 s50, s50, 1
  s_and_b32 s50, s50, 7
  s_waitcnt vmcnt(7)
  s_barrier
  s_add_u32 m0, s49, 73728
  s_mul_i32 s32, s50, 196608
  s_add_u32 s32, s32, s48
  buffer_load_dwordx4 v154, s[44:47], s32 offen lds
  buffer_load_dwordx4 v155, s[44:47], s32 offen offset:1024 lds
  s_add_u32 m0, m0, 2048
  s_add_u32 s32, s32, 1024
  buffer_load_dwordx4 v154, s[44:47], s32 offen lds
  buffer_load_dwordx4 v155, s[44:47], s32 offen offset:1024 lds
  s_add_u32 m0, m0, 2048
  s_add_u32 s32, s32, 1024
  buffer_load_dwordx4 v154, s[44:47], s32 offen lds
  buffer_load_dwordx4 v155, s[44:47], s32 offen offset:1024 lds
  s_add_u32 s50, s50, 1
  s_and_b32 s50, s50, 7
  s_waitcnt vmcnt(6)
  s_barrier
  s_add_u32 m0, s49, 0
  s_mul_i32 s32, s50, 196608
  s_add_u32 s32, s32, s48
  buffer_load_dwordx4 v154, s[44:47], s32 offen lds
  buffer_load_dwordx4 v155, s[44:47], s32 offen offset:1024 lds
  s_add_u32 m0, m0, 2048
  s_add_u32 s32, s32, 1024
  buffer_load_dwordx4 v154, s[44:47], s32 offen lds
  buffer_load_dwordx4 v155, s[44:47], s32 offen offset:1024 lds
  s_add_u32 m0, m0, 2048
  s_add_u32 s32, s32, 1024
  buffer_load_dwordx4 v154, s[44:47], s32 offen lds
  buffer_load_dwordx4 v155, s[44:47], s32 offen offset:1024 lds
  s_add_u32 s50, s50, 1
  s_and_b32 s50, s50, 7
  s_add_u32 m0, s49, 24576
  s_mul_i32 s32, s50, 196608
  s_add_u32 s32, s32, s48
  buffer_load_dwordx4 v154, s[44:47], s32 offen lds
  buffer_load_dwordx4 v155, s[44:47], s32 offen offset:1024 lds
  s_add_u32 m0, m0, 2048
  s_add_u32 s32, s32, 1024
  buffer_load_dwordx4 v154, s[44:47], s32 offen lds
  buffer_load_dwordx4 v155, s[44:47], s32 offen offset:1024 lds
  s_add_u32 m0, m0, 2048
  s_add_u32 s32, s32, 1024
  buffer_load_dwordx4 v154, s[44:47], s32 offen lds
  buffer_load_dwordx4 v155, s[44:47], s32 offen offset:1024 lds
  s_add_u32 s50, s50, 1
  s_and_b32 s50, s50, 7
  s_waitcnt vmcnt(12)
  s_barrier
  s_add_u32 m0, s49, 49152
  s_mul_i32 s32, s50, 196608
  s_add_u32 s32, s32, s48
  buffer_load_dwordx4 v154, s[44:47], s32 offen lds
  buffer_load_dwordx4 v155, s[44:47], s32 offen offset:1024 lds
  s_add_u32 m0, m0, 2048
  s_add_u32 s32, s32, 1024
  buffer_load_dwordx4 v154, s[44:47], s32 offen lds
  buffer_load_dwordx4 v155, s[44:47], s32 offen offset:1024 lds
  s_add_u32 m0, m0, 2048
  s_add_u32 s32, s32, 1024
  buffer_load_dwordx4 v154, s[44:47], s32 offen lds
  buffer_load_dwordx4 v155, s[44:47], s32 offen offset:1024 lds
  s_add_u32 s50, s50, 1
  s_and_b32 s50, s50, 7
  s_waitcnt vmcnt(12)
  s_barrier
  s_add_u32 m0, s49, 73728
  s_mul_i32 s32, s50, 196608
  s_add_u32 s32, s32, s48
  buffer_load_dwordx4 v154, s[44:47], s32 offen lds
  buffer_load_dwordx4 v155, s[44:47], s32 offen offset:1024 lds
  s_add_u32 m0, m0, 2048
  s_add_u32 s32, s32, 1024
  buffer_load_dwordx4 v154, s[44:47], s32 offen lds
  buffer_load_dwordx4 v155, s[44:47], s32 offen offset:1024 lds
  s_add_u32 m0, m0, 2048
  s_add_u32 s32, s32, 1024
  buffer_load_dwordx4 v154, s[44:47], s32 offen lds
  buffer_load_dwordx4 v155, s[44:47], s32 offen offset:1024 lds
  s_add_u32 s50, s50, 1
  s_and_b32 s50, s50, 7
  s_waitcnt vmcnt(12)
  s_barrier
  s_waitcnt vmcnt(6)
  s_barrier
  s_cmp_lg_u32 s40, 0
  s_cbranch_scc1 L_sequential_preLN__mha_block__mixer_gmlp__prompt_kernel_p1l_non
  v_readfirstlane_b32 s38, v156
  v_readfirstlane_b32 s39, v157
  s_cmp_ge_u32 s39, 0x80000000
  s_cbranch_scc1 L_sequential_preLN__mha_block__mixer_gmlp__prompt_kernel_p1l_nok
  s_mov_b32 s56, s22
  s_and_b32 s57, s23, 0xffff
  s_mov_b32 s58, 0x100
  s_mov_b32 s59, 0x20000
  v_mov_b32 v158, 0
  s_mov_b32 s37, 100000
L_sequential_preLN__mha_block__mixer_gmlp__prompt_kernel_p1l_nf:
  buffer_load_dwordx2 v[156:157], v158, s[56:59], 0 offen sc1
  s_waitcnt vmcnt(0)
  v_readfirstlane_b32 s39, v157
  v_readfirstlane_b32 s38, v156
  s_sub_u32 s37, s37, 1
  s_cbranch_scc1 L_sequential_preLN__mha_block__mixer_gmlp__prompt_kernel_p1l_nfx
  s_cmp_lt_u32 s39, 0x80000000
  s_cbranch_scc1 L_sequential_preLN__mha_block__mixer_gmlp__prompt_kernel_p1l_nf
L_sequential_preLN__mha_block__mixer_gmlp__prompt_kernel_p1l_nfx:
L_sequential_preLN__mha_block__mixer_gmlp__prompt_kernel_p1l_nok:
  v_mov_b32 v158, 90112
  ds_write_b64 v158, v[156:157]
  s_waitcnt lgkmcnt(0)
L_sequential_preLN__mha_block__mixer_gmlp__prompt_kernel_p1l_non:
  s_waitcnt vmcnt(0)
  s_barrier
  s_barrier
  s_lshl_b32 s32, s35, 2
  s_lshr_b32 s33, s36, 3
  s_add_u32 s41, s32, s33
  s_and_b32 s42, s36, 7
  s_lshl_b32 s43, s41, 17
  s_and_b32 s32, s40, 1
  s_lshl_b32 s32, s32, 10
  s_add_u32 s43, s43, s32
  s_add_u32 s43, s43, 0x200000
  s_lshr_b32 s33, s40, 1
  s_lshl_b32 s33, s33, 16
  s_add_u32 m0, s33, s32
  s_lshl_b32 s44, s42, 14
  s_add_u32 s44, s44, s33
  s_barrier
  s_and_b32 s44, s44, 0x1ffff
  s_add_u32 s32, s44, s43
  buffer_load_dwordx4 v2, s[28:31], s32 offen sc1 lds
  buffer_load_dwordx4 v2, s[28:31], s32 offen offset:2048 sc1 lds
  s_add_u32 m0, m0, 4096
  s_add_u32 s44, s44, 4096
  s_and_b32 s44, s44, 0x1ffff
  s_add_u32 s32, s44, s43
  buffer_load_dwordx4 v2, s[28:31], s32 offen sc1 lds
  buffer_load_dwordx4 v2, s[28:31], s32 offen offset:2048 sc1 lds
  s_add_u32 m0, m0, 4096
  s_add_u32 s44, s44, 4096
  s_and_b32 s44, s44, 0x1ffff
  s_add_u32 s32, s44, s43
  buffer_load_dwordx4 v2, s[28:31], s32 offen sc1 lds
  buffer_load_dwordx4 v2, s[28:31], s32 offen offset:2048 sc1 lds
  s_add_u32 m0, m0, 4096
  s_add_u32 s44, s44, 4096
  s_waitcnt vmcnt(2)
  s_barrier
  s_and_b32 s44, s44, 0x1ffff
  s_add_u32 s32, s44, s43
  buffer_load_dwordx4 v2, s[28:31], s32 offen sc1 lds
  buffer_load_dwordx4 v2, s[28:31], s32 offen offset:2048 sc1 lds
  s_add_u32 m0, m0, 4096
  s_add_u32 s44, s44, 4096
  s_and_b32 s44, s44, 0x1ffff
  s_add_u32 s32, s44, s43
  buffer_load_dwordx4 v2, s[28:31], s32 offen sc1 lds
  buffer_load_dwordx4 v2, s[28:31], s32 offen offset:2048 sc1 lds
  s_add_u32 m0, m0, 4096
  s_add_u32 s44, s44, 4096
  s_and_b32 s44, s44, 0x1ffff
  s_add_u32 s32, s44, s43
  buffer_load_dwordx4 v2, s[28:31], s32 offen sc1 lds
  buffer_load_dwordx4 v2, s[28:31], s32 offen offset:2048 sc1 lds
  s_add_u32 m0, m0, 4096
  s_add_u32 s44, s44, 4096
  s_and_b32 s44, s44, 0x1ffff
  s_add_u32 s32, s44, s43
  buffer_load_dwordx4 v2, s[28:31], s32 offen sc1 lds
  buffer_load_dwordx4 v2, s[28:31], s32 offen offset:2048 sc1 lds
  s_add_u32 m0, m0, 4096
  s_add_u32 s44, s44, 4096
  s_waitcnt vmcnt(4)
  s_barrier
  s_and_b32 s44, s44, 0x1ffff
  s_add_u32 s32, s44, s43
  buffer_load_dwordx4 v2, s[28:31], s32 offen sc1 lds
  buffer_load_dwordx4 v2, s[28:31], s32 offen offset:2048 sc1 lds
  s_add_u32 m0, m0, 4096
  s_add_u32 s44, s44, 4096
  s_and_b32 s44, s44, 0x1ffff
  s_add_u32 s32, s44, s43
  buffer_load_dwordx4 v2, s[28:31], s32 offen sc1 lds
  buffer_load_dwordx4 v2, s[28:31], s32 offen offset:2048 sc1 lds
  s_add_u32 m0, m0, 4096
  s_add_u32 s44, s44, 4096
  s_and_b32 s44, s44, 0x1ffff
  s_add_u32 s32, s44, s43
  buffer_load_dwordx4 v2, s[28:31], s32 offen sc1 lds
  buffer_load_dwordx4 v2, s[28:31], s32 offen offset:2048 sc1 lds
  s_add_u32 m0, m0, 4096
  s_add_u32 s44, s44, 4096
  s_and_b32 s44, s44, 0x1ffff
  s_add_u32 s32, s44, s43
  buffer_load_dwordx4 v2, s[28:31], s32 offen sc1 lds
  buffer_load_dwordx4 v2, s[28:31], s32 offen offset:2048 sc1 lds
  s_add_u32 m0, m0, 4096
  s_add_u32 s44, s44, 4096
  s_and_b32 s44, s44, 0x1ffff
  s_add_u32 s32, s44, s43
  buffer_load_dwordx4 v2, s[28:31], s32 offen sc1 lds
  buffer_load_dwordx4 v2, s[28:31], s32 offen offset:2048 sc1 lds
  s_add_u32 m0, m0, 4096
  s_add_u32 s44, s44, 4096
  s_and_b32 s44, s44, 0x1ffff
  s_add_u32 s32, s44, s43
  buffer_load_dwordx4 v2, s[28:31], s32 offen sc1 lds
  buffer_load_dwordx4 v2, s[28:31], s32 offen offset:2048 sc1 lds
  s_add_u32 m0, m0, 4096
  s_add_u32 s44, s44, 4096
  s_and_b32 s44, s44, 0x1ffff
  s_add_u32 s32, s44, s43
  buffer_load_dwordx4 v2, s[28:31], s32 offen sc1 lds
  buffer_load_dwordx4 v2, s[28:31], s32 offen offset:2048 sc1 lds
  s_add_u32 m0, m0, 4096
  s_add_u32 s44, s44, 4096
  s_and_b32 s44, s44, 0x1ffff
  s_add_u32 s32, s44, s43
  buffer_load_dwordx4 v2, s[28:31], s32 offen sc1 lds
  buffer_load_dwordx4 v2, s[28:31], s32 offen offset:2048 sc1 lds
  s_add_u32 m0, m0, 4096
  s_add_u32 s44, s44, 4096
  s_and_b32 s44, s44, 0x1ffff
  s_add_u32 s32, s44, s43
  buffer_load_dwordx4 v2, s[28:31], s32 offen sc1 lds
  buffer_load_dwordx4 v2, s[28:31], s32 offen offset:2048 sc1 lds
  s_add_u32 m0, m0, 4096
  s_add_u32 s44, s44, 4096
  s_lshl_b32 s52, s36, 2
  s_add_u32 s52, s52, s40
  s_waitcnt vmcnt(0)
  s_barrier
  s_mov_b32 s48, s8
  s_and_b32 s49, s9, 0xffff
  s_mov_b32 s50, 0x80000
  s_mov_b32 s51, 0x20000
  s_mul_i32 s32, s52, 4096
  v_mul_u32_u24 v152, 64, v1
  buffer_load_dword v3, v152, s[48:51], s32 offen
  s_lshl_b32 s32, s35, 1
  s_and_b32 s33, s36, 1
  s_add_u32 s53, s32, s33
  s_lshr_b32 s54, s36, 1
  s_lshl_b32 s57, s33, 2
  s_add_u32 s57, s57, s54
  s_and_b32 s57, s57, 0
  s_lshl_b32 s32, s53, 2
  s_add_u32 s32, s32, s40
  s_lshl_b32 s55, s32, 15
  s_add_u32 s55, s55, 0x800000
  s_lshl_b32 s56, s40, 12
  v_lshrrev_b32 v4, 2, v1
  v_mul_u32_u24 v4, 3584, v4
  v_and_b32 v5, 3, v1
  v_lshl_add_u32 v154, v5, 4, v4
  s_mul_i32 s64, s40, 57344
  s_lshl_b32 s32, s54, 7
  s_add_u32 s64, s64, s32
  s_mov_b32 s60, s12
  s_and_b32 s61, s13, 0xffff
  s_mov_b32 s62, 0x1c0000
  s_mov_b32 s63, 0x20000
  s_cmp_ge_u32 s36, 28
  s_cbranch_scc1 L_sequential_preLN__mha_block__mixer_gmlp__prompt_kernel_p4l_skipstage
  s_add_u32 s32, s57, 0
  s_and_b32 s32, s32, 7
  s_mul_i32 s32, s32, 229376
  s_add_u32 s32, s32, s64
  buffer_load_dwordx4 v[8:11], v154, s[60:63], s32 offen offset:1792
  buffer_load_dwordx4 v[12:15], v154, s[60:63], s32 offen offset:1856
  buffer_load_dwordx4 v[72:75], v154, s[60:63], s32 offen offset:0
  buffer_load_dwordx4 v[76:79], v154, s[60:63], s32 offen offset:64
  s_add_u32 s32, s57, 1
  s_and_b32 s32, s32, 7
  s_mul_i32 s32, s32, 229376
  s_add_u32 s32, s32, s64
  buffer_load_dwordx4 v[16:19], v154, s[60:63], s32 offen offset:1792
  buffer_load_dwordx4 v[20:23], v154, s[60:63], s32 offen offset:1856
  buffer_load_dwordx4 v[80:83], v154, s[60:63], s32 offen offset:0
  buffer_load_dwordx4 v[84:87], v154, s[60:63], s32 offen offset:64
  s_add_u32 s32, s57, 2
  s_and_b32 s32, s32, 7
  s_mul_i32 s32, s32, 229376
  s_add_u32 s32, s32, s64
  buffer_load_dwordx4 v[24:27], v154, s[60:63], s32 offen offset:1792
  buffer_load_dwordx4 v[28:31], v154, s[60:63], s32 offen offset:1856
  buffer_load_dwordx4 v[88:91], v154, s[60:63], s32 offen offset:0
  buffer_load_dwordx4 v[92:95], v154, s[60:63], s32 offen offset:64
  s_add_u32 s32, s57, 3
  s_and_b32 s32, s32, 7
  s_mul_i32 s32, s32, 229376
  s_add_u32 s32, s32, s64
  buffer_load_dwordx4 v[32:35], v154, s[60:63], s32 offen offset:1792
  buffer_load_dwordx4 v[36:39], v154, s[60:63], s32 offen offset:1856
  buffer_load_dwordx4 v[96:99], v154, s[60:63], s32 offen offset:0
  buffer_load_dwordx4 v[100:103], v154, s[60:63], s32 offen offset:64
  s_add_u32 s32, s57, 4
  s_and_b32 s32, s32, 7
  s_mul_i32 s32, s32, 229376
  s_add_u32 s32, s32, s64
  buffer_load_dwordx4 v[40:43], v154, s[60:63], s32 offen offset:1792
  buffer_load_dwordx4 v[44:47], v154, s[60:63], s32 offen offset:1856
  buffer_load_dwordx4 v[104:107], v154, s[60:63], s32 offen offset:0
  buffer_load_dwordx4 v[108:111], v154, s[60:63], s32 offen offset:64
  s_add_u32 s32, s57, 5
  s_and_b32 s32, s32, 7
  s_mul_i32 s32, s32, 229376
  s_add_u32 s32, s32, s64
  buffer_load_dwordx4 v[48:51], v154, s[60:63], s32 offen offset:1792
  buffer_load_dwordx4 v[52:55], v154, s[60:63], s32 offen offset:1856
  buffer_load_dwordx4 v[112:115], v154, s[60:63], s32 offen offset:0
  buffer_load_dwordx4 v[116:119], v154, s[60:63], s32 offen offset:64
  s_add_u32 s32, s57, 6
  s_and_b32 s32, s32, 7
  s_mul_i32 s32, s32, 229376
  s_add_u32 s32, s32, s64
  buffer_load_dwordx4 v[56:59], v154, s[60:63], s32 offen offset:1792
  buffer_load_dwordx4 v[60:63], v154, s[60:63], s32 offen offset:1856
  buffer_load_dwordx4 v[120:123], v154, s[60:63], s32 offen offset:0
  buffer_load_dwordx4 v[124:127], v154, s[60:63], s32 offen offset:64
  s_add_u32 s32, s57, 7
  s_and_b32 s32, s32, 7
  s_mul_i32 s32, s32, 229376
  s_add_u32 s32, s32, s64
  buffer_load_dwordx4 v[64:67], v154, s[60:63], s32 offen offset:1792
  buffer_load_dwordx4 v[68:71], v154, s[60:63], s32 offen offset:1856
  buffer_load_dwordx4 v[128:131], v154, s[60:63], s32 offen offset:0
  buffer_load_dwordx4 v[132:135], v154, s[60:63], s32 offen offset:64
  s_branch L_sequential_preLN__mha_block__mixer_gmlp__prompt_kernel_p4l_stagedone
L_sequential_preLN__mha_block__mixer_gmlp__prompt_kernel_p4l_skipstage:
  s_lshl_b32 s32, s35, 2
  s_and_b32 s33, s36, 3
  s_add_u32 s65, s32, s33
  s_lshr_b32 s66, s36, 2
  s_lshl_b32 s75, s33, 1
  s_add_u32 s75, s75, s66
  s_and_b32 s75, s75, 0
  s_mul_i32 s75, s75, 7
  s_lshr_b32 s75, s75, 2
  v_lshrrev_b32 v4, 2, v1
  v_lshlrev_b32 v4, 10, v4
  v_and_b32 v5, 3, v1
  v_lshl_add_u32 v155, v5, 4, v4
  v_add_u32 v156, 64, v155
  v_add_u32 v155, 1024, v155
  s_lshr_b32 s32, s40, 1
  s_lshl_b32 s33, s65, 1
  s_add_u32 s32, s32, s33
  s_mul_i32 s72, s32, 57344
  s_and_b32 s32, s40, 1
  s_lshl_b32 s32, s32, 11
  s_add_u32 s72, s72, s32
  s_add_u32 s72, s72, 0x1200000
  s_lshl_b32 s74, s40, 11
  s_lshl_b32 s73, s40, 14
  s_lshl_b32 s32, s66, 7
  s_add_u32 s73, s73, s32
  s_sub_u32 s68, s18, 1024
  s_subb_u32 s69, s19, 0
  s_and_b32 s69, s69, 0xffff
  s_mov_b32 s70, 0xe0400
  s_mov_b32 s71, 0x20000
  s_add_u32 s32, s75, 0
  s_sub_u32 s33, s32, 14
  s_cselect_b32 s32, s32, s33
  s_lshl_b32 s32, s32, 16
  s_add_u32 s32, s32, s73
  buffer_load_dwordx4 v[24:27], v155, s[68:71], s32 offen
  buffer_load_dwordx4 v[28:31], v156, s[68:71], s32 offen offset:1024
  s_add_u32 s32, s75, 1
  s_sub_u32 s33, s32, 14
  s_cselect_b32 s32, s32, s33
  s_lshl_b32 s32, s32, 16
  s_add_u32 s32, s32, s73
  buffer_load_dwordx4 v[32:35], v155, s[68:71], s32 offen
  buffer_load_dwordx4 v[36:39], v156, s[68:71], s32 offen offset:1024
  s_add_u32 s32, s75, 2
  s_sub_u32 s33, s32, 14
  s_cselect_b32 s32, s32, s33
  s_lshl_b32 s32, s32, 16
  s_add_u32 s32, s32, s73
  buffer_load_dwordx4 v[40:43], v155, s[68:71], s32 offen
  buffer_load_dwordx4 v[44:47], v156, s[68:71], s32 offen offset:1024
  s_add_u32 s32, s75, 3
  s_sub_u32 s33, s32, 14
  s_cselect_b32 s32, s32, s33
  s_lshl_b32 s32, s32, 16
  s_add_u32 s32, s32, s73
  buffer_load_dwordx4 v[48:51], v155, s[68:71], s32 offen
  buffer_load_dwordx4 v[52:55], v156, s[68:71], s32 offen offset:1024
  s_add_u32 s32, s75, 4
  s_sub_u32 s33, s32, 14
  s_cselect_b32 s32, s32, s33
  s_lshl_b32 s32, s32, 16
  s_add_u32 s32, s32, s73
  buffer_load_dwordx4 v[56:59], v155, s[68:71], s32 offen
  buffer_load_dwordx4 v[60:63], v156, s[68:71], s32 offen offset:1024
  s_add_u32 s32, s75, 5
  s_sub_u32 s33, s32, 14
  s_cselect_b32 s32, s32, s33
  s_lshl_b32 s32, s32, 16
  s_add_u32 s32, s32, s73
  buffer_load_dwordx4 v[64:67], v155, s[68:71], s32 offen
  buffer_load_dwordx4 v[68:71], v156, s[68:71], s32 offen offset:1024
  s_add_u32 s32, s75, 6
  s_sub_u32 s33, s32, 14
  s_cselect_b32 s32, s32, s33
  s_lshl_b32 s32, s32, 16
  s_add_u32 s32, s32, s73
  buffer_load_dwordx4 v[72:75], v155, s[68:71], s32 offen
  buffer_load_dwordx4 v[76:79], v156, s[68:71], s32 offen offset:1024
  s_add_u32 s32, s75, 7
  s_sub_u32 s33, s32, 14
  s_cselect_b32 s32, s32, s33
  s_lshl_b32 s32, s32, 16
  s_add_u32 s32, s32, s73
  buffer_load_dwordx4 v[80:83], v155, s[68:71], s32 offen
  buffer_load_dwordx4 v[84:87], v156, s[68:71], s32 offen offset:1024
  s_add_u32 s32, s75, 8
  s_sub_u32 s33, s32, 14
  s_cselect_b32 s32, s32, s33
  s_lshl_b32 s32, s32, 16
  s_add_u32 s32, s32, s73
  buffer_load_dwordx4 v[88:91], v155, s[68:71], s32 offen
  buffer_load_dwordx4 v[92:95], v156, s[68:71], s32 offen offset:1024
  s_add_u32 s32, s75, 9
  s_sub_u32 s33, s32, 14
  s_cselect_b32 s32, s32, s33
  s_lshl_b32 s32, s32, 16
  s_add_u32 s32, s32, s73
  buffer_load_dwordx4 v[96:99], v155, s[68:71], s32 offen
  buffer_load_dwordx4 v[100:103], v156, s[68:71], s32 offen offset:1024
  s_add_u32 s32, s75, 10
  s_sub_u32 s33, s32, 14
  s_cselect_b32 s32, s32, s33
  s_lshl_b32 s32, s32, 16
  s_add_u32 s32, s32, s73
  buffer_load_dwordx4 v[104:107], v155, s[68:71], s32 offen
  buffer_load_dwordx4 v[108:111], v156, s[68:71], s32 offen offset:1024
  s_add_u32 s32, s75, 11
  s_sub_u32 s33, s32, 14
  s_cselect_b32 s32, s32, s33
  s_lshl_b32 s32, s32, 16
  s_add_u32 s32, s32, s73
  buffer_load_dwordx4 v[112:115], v155, s[68:71], s32 offen
  buffer_load_dwordx4 v[116:119], v156, s[68:71], s32 offen offset:1024
  s_add_u32 s32, s75, 12
  s_sub_u32 s33, s32, 14
  s_cselect_b32 s32, s32, s33
  s_lshl_b32 s32, s32, 16
  s_add_u32 s32, s32, s73
  buffer_load_dwordx4 v[120:123], v155, s[68:71], s32 offen
  buffer_load_dwordx4 v[124:127], v156, s[68:71], s32 offen offset:1024
  s_add_u32 s32, s75, 13
  s_sub_u32 s33, s32, 14
  s_cselect_b32 s32, s32, s33
  s_lshl_b32 s32, s32, 16
  s_add_u32 s32, s32, s73
  buffer_load_dwordx4 v[128:131], v155, s[68:71], s32 offen
  buffer_load_dwordx4 v[132:135], v156, s[68:71], s32 offen offset:1024
L_sequential_preLN__mha_block__mixer_gmlp__prompt_kernel_p4l_stagedone:
  s_mov_b32 s48, s14
  s_and_b32 s49, s15, 0xffff
  s_mov_b32 s50, 0x800000
  s_mov_b32 s51, 0x20000
  s_mul_i32 s32, s52, 16384
  s_and_b32 s33, s35, 3
  s_mul_i32 s33, s33, 2097152
  s_add_u32 s32, s32, s33
  v_mul_u32_u24 v152, 128, v1
  buffer_load_dword v3, v152, s[48:51], s32 offen
  s_add_u32 s32, s32, 8192
  buffer_load_dword v3, v152, s[48:51], s32 offen
  s_mov_b32 s48, s18
  s_and_b32 s49, s19, 0xffff
  s_mov_b32 s50, 0xe0000
  s_mov_b32 s51, 0x20000
  s_mul_i32 s32, s52, 8192
  v_mul_u32_u24 v152, 128, v1
  buffer_load_dword v3, v152, s[48:51], s32 offen
  s_mov_b32 s48, s4
  s_and_b32 s49, s5, 0xffff
  s_mov_b32 s50, 0x200000
  s_mov_b32 s51, 0x20000
  s_mul_i32 s32, s52, 2048
  s_and_b32 s33, s35, 7
  s_mul_i32 s33, s33, 262144
  s_add_u32 s32, s32, s33
  v_mul_u32_u24 v152, 32, v1
  buffer_load_dword v3, v152, s[48:51], s32 offen
  s_cmp_lg_u32 s40, 3
  s_cbranch_scc1 L_sequential_preLN__mha_block__mixer_gmlp__prompt_kernel_p2l_nowarm
  v_lshlrev_b32 v152, 7, v1
  s_lshl_b32 s32, s2, 5
  s_add_u32 s32, s32, 2048
  s_mov_b32 exec_hi, 0
  s_lshl_b32 s32, s32, 7
  s_add_u32 s32, s32, 0x1700000
  buffer_load_dword v3, v152, s[28:31], s32 offen sc1
  s_mov_b64 exec, -1
  s_lshl_b32 s32, s2, 12
  s_add_u32 s32, s32, 0x1600000
  v_lshlrev_b32 v152, 6, v1
  buffer_load_dword v3, v152, s[28:31], s32 offen sc1
L_sequential_preLN__mha_block__mixer_gmlp__prompt_kernel_p2l_nowarm:
  s_barrier
  s_lshl_b32 s32, s35, 2
  s_and_b32 s33, s36, 3
  s_add_u32 s41, s32, s33
  s_lshr_b32 s42, s36, 2
  s_lshl_b32 s51, s33, 1
  s_add_u32 s51, s51, s42
  s_and_b32 s51, s51, 0
  v_lshrrev_b32 v154, 2, v1
  v_lshlrev_b32 v154, 10, v154
  v_and_b32 v155, 3, v1
  v_lshl_add_u32 v152, v155, 4, v154
  v_add_u32 v153, 64, v152
  v_add_u32 v152, 1024, v152
  s_lshr_b32 s32, s40, 1
  s_lshl_b32 s33, s41, 1
  s_add_u32 s32, s32, s33
  s_mul_i32 s48, s32, 32768
  s_and_b32 s32, s40, 1
  s_lshl_b32 s32, s32, 11
  s_add_u32 s48, s48, s32
  s_add_u32 s48, s48, 0x600000
  s_lshl_b32 s50, s40, 11
  s_lshl_b32 s49, s40, 14
  s_lshl_b32 s32, s42, 7
  s_add_u32 s49, s49, s32
  s_sub_u32 s44, s8, 1024
  s_subb_u32 s45, s9, 0
  s_and_b32 s45, s45, 0xffff
  s_mov_b32 s46, 0x80400
  s_mov_b32 s47, 0x20000
  s_add_u32 s32, s51, 0
  s_and_b32 s32, s32, 7
  s_add_u32 m0, s50, 0
  s_lshl_b32 s32, s32, 16
  s_add_u32 s32, s32, s49
  buffer_load_dwordx4 v152, s[44:47], s32 offen lds
  buffer_load_dwordx4 v153, s[44:47], s32 offen offset:1024 lds
  s_add_u32 s32, s51, 1
  s_and_b32 s32, s32, 7
  s_add_u32 m0, s50, 8192
  s_lshl_b32 s32, s32, 16
  s_add_u32 s32, s32, s49
  buffer_load_dwordx4 v152, s[44:47], s32 offen lds
  buffer_load_dwordx4 v153, s[44:47], s32 offen offset:1024 lds
  s_add_u32 s32, s51, 2
  s_and_b32 s32, s32, 7
  s_add_u32 m0, s50, 16384
  s_lshl_b32 s32, s32, 16
  s_add_u32 s32, s32, s49
  buffer_load_dwordx4 v152, s[44:47], s32 offen lds
  buffer_load_dwordx4 v153, s[44:47], s32 offen offset:1024 lds
  s_add_u32 s32, s51, 3
  s_and_b32 s32, s32, 7
  s_add_u32 m0, s50, 24576
  s_lshl_b32 s32, s32, 16
  s_add_u32 s32, s32, s49
  buffer_load_dwordx4 v152, s[44:47], s32 offen lds
  buffer_load_dwordx4 v153, s[44:47], s32 offen offset:1024 lds
  s_add_u32 s32, s51, 4
  s_and_b32 s32, s32, 7
  s_add_u32 m0, s50, 65536
  s_lshl_b32 s32, s32, 16
  s_add_u32 s32, s32, s49
  buffer_load_dwordx4 v152, s[44:47], s32 offen lds
  buffer_load_dwordx4 v153, s[44:47], s32 offen offset:1024 lds
  s_add_u32 s32, s51, 5
  s_and_b32 s32, s32, 7
  s_add_u32 m0, s50, 73728
  s_lshl_b32 s32, s32, 16
  s_add_u32 s32, s32, s49
  buffer_load_dwordx4 v152, s[44:47], s32 offen lds
  buffer_load_dwordx4 v153, s[44:47], s32 offen offset:1024 lds
  s_add_u32 s32, s51, 6
  s_and_b32 s32, s32, 7
  s_add_u32 m0, s50, 81920
  s_lshl_b32 s32, s32, 16
  s_add_u32 s32, s32, s49
  buffer_load_dwordx4 v152, s[44:47], s32 offen lds
  buffer_load_dwordx4 v153, s[44:47], s32 offen offset:1024 lds
  s_add_u32 s32, s51, 7
  s_and_b32 s32, s32, 7
  s_add_u32 m0, s50, 90112
  s_lshl_b32 s32, s32, 16
  s_add_u32 s32, s32, s49
  buffer_load_dwordx4 v152, s[44:47], s32 offen lds
  buffer_load_dwordx4 v153, s[44:47], s32 offen offset:1024 lds
  s_barrier
  s_mov_b32 s52, s4
  s_and_b32 s53, s5, 0xffff
  s_mov_b32 s54, 0x200000
  s_mov_b32 s55, 0x20000
  v_lshrrev_b32 v156, 4, v1
  v_xor_b32 v156, v155, v156
  v_lshl_add_u32 v156, v156, 4, v154
  s_lshl_b32 s32, s41, 16
  s_and_b32 s33, s40, 1
  s_lshl_b32 s33, s33, 15
  s_add_u32 s32, s32, s33
  s_lshl_b32 s33, s42, 7
  s_add_u32 s32, s32, s33
  s_lshr_b32 s33, s40, 1
  s_lshl_b32 s33, s33, 6
  s_add_u32 m0, s50, 131072
  s_add_u32 s32, s32, s33
  buffer_load_dwordx4 v156, s[52:55], s32 offen lds
  s_add_u32 m0, m0, 1024
  s_add_u32 s32, s32, 16384
  buffer_load_dwordx4 v156, s[52:55], s32 offen lds
  s_barrier
  s_cmp_ge_u32 s36, 28
  s_cbranch_scc1 L_sequential_preLN__mha_block__mixer_gmlp__prompt_kernel_p4s_skip
  v_and_b32 v4, 15, v1
  v_and_b32 v5, 1, v4
  v_lshlrev_b32 v5, 4, v5
  v_mov_b32 v160, 0x3f80
  v_lshlrev_b32 v5, v5, v160
  v_lshrrev_b32 v4, 1, v4
  v_cmp_eq_u32 vcc, 0, v4
  s_nop 1
  v_cndmask_b32 v160, 0, v5, vcc
  v_cmp_eq_u32 vcc, 1, v4
  s_nop 1
  v_cndmask_b32 v161, 0, v5, vcc
  v_cmp_eq_u32 vcc, 2, v4
  s_nop 1
  v_cndmask_b32 v162, 0, v5, vcc
  v_cmp_eq_u32 vcc, 3, v4
  s_nop 1
  v_cndmask_b32 v163, 0, v5, vcc
  v_mov_b32 v136, 0
  v_mov_b32 v137, 0
  v_mov_b32 v138, 0
  v_mov_b32 v139, 0
  v_mov_b32 v140, 0
  v_mov_b32 v141, 0
  v_mov_b32 v142, 0
  v_mov_b32 v143, 0
  v_mov_b32 v144, 0
  v_mov_b32 v145, 0
  v_mov_b32 v146, 0
  v_mov_b32 v147, 0
  v_mov_b32 v148, 0
  v_mov_b32 v149, 0
  v_mov_b32 v150, 0
  v_mov_b32 v151, 0
  s_waitcnt vmcnt(2)
  v_mfma_f32_16x16x32_bf16 v[136:139], v[160:163], v[8:11], v[136:139]
  v_mfma_f32_16x16x32_bf16 v[140:143], v[160:163], v[12:15], v[140:143]
  v_mfma_f32_16x16x32_bf16 v[144:147], v[160:163], v[72:75], v[144:147]
  v_mfma_f32_16x16x32_bf16 v[148:151], v[160:163], v[76:79], v[148:151]
  v_mfma_f32_16x16x32_bf16 v[136:139], v[160:163], v[16:19], v[136:139]
  v_mfma_f32_16x16x32_bf16 v[140:143], v[160:163], v[20:23], v[140:143]
  v_mfma_f32_16x16x32_bf16 v[144:147], v[160:163], v[80:83], v[144:147]
  v_mfma_f32_16x16x32_bf16 v[148:151], v[160:163], v[84:87], v[148:151]
  v_mfma_f32_16x16x32_bf16 v[136:139], v[160:163], v[24:27], v[136:139]
  v_mfma_f32_16x16x32_bf16 v[140:143], v[160:163], v[28:31], v[140:143]
  v_mfma_f32_16x16x32_bf16 v[144:147], v[160:163], v[88:91], v[144:147]
  v_mfma_f32_16x16x32_bf16 v[148:151], v[160:163], v[92:95], v[148:151]
  v_mfma_f32_16x16x32_bf16 v[136:139], v[160:163], v[32:35], v[136:139]
  v_mfma_f32_16x16x32_bf16 v[140:143], v[160:163], v[36:39], v[140:143]
  v_mfma_f32_16x16x32_bf16 v[144:147], v[160:163], v[96:99], v[144:147]
  v_mfma_f32_16x16x32_bf16 v[148:151], v[160:163], v[100:103], v[148:151]
  v_mfma_f32_16x16x32_bf16 v[136:139], v[160:163], v[40:43], v[136:139]
  v_mfma_f32_16x16x32_bf16 v[140:143], v[160:163], v[44:47], v[140:143]
  v_mfma_f32_16x16x32_bf16 v[144:147], v[160:163], v[104:107], v[144:147]
  v_mfma_f32_16x16x32_bf16 v[148:151], v[160:163], v[108:111], v[148:151]
  v_mfma_f32_16x16x32_bf16 v[136:139], v[160:163], v[48:51], v[136:139]
  v_mfma_f32_16x16x32_bf16 v[140:143], v[160:163], v[52:55], v[140:143]
  v_mfma_f32_16x16x32_bf16 v[144:147], v[160:163], v[112:115], v[144:147]
  v_mfma_f32_16x16x32_bf16 v[148:151], v[160:163], v[116:119], v[148:151]
  v_mfma_f32_16x16x32_bf16 v[136:139], v[160:163], v[56:59], v[136:139]
  v_mfma_f32_16x16x32_bf16 v[140:143], v[160:163], v[60:63], v[140:143]
  v_mfma_f32_16x16x32_bf16 v[144:147], v[160:163], v[120:123], v[144:147]
  v_mfma_f32_16x16x32_bf16 v[148:151], v[160:163], v[124:127], v[148:151]
  v_mfma_f32_16x16x32_bf16 v[136:139], v[160:163], v[64:67], v[136:139]
  v_mfma_f32_16x16x32_bf16 v[140:143], v[160:163], v[68:71], v[140:143]
  v_mfma_f32_16x16x32_bf16 v[144:147], v[160:163], v[128:131], v[144:147]
  v_mfma_f32_16x16x32_bf16 v[148:151], v[160:163], v[132:135], v[148:151]
  s_nop 7
  v_add_f32_dpp v136, v136, v136 row_ror:4 row_mask:0xf bank_mask:0xf
  v_add_f32_dpp v137, v137, v137 row_ror:4 row_mask:0xf bank_mask:0xf
  v_add_f32_dpp v138, v138, v138 row_ror:4 row_mask:0xf bank_mask:0xf
  v_add_f32_dpp v139, v139, v139 row_ror:4 row_mask:0xf bank_mask:0xf
  v_add_f32_dpp v140, v140, v140 row_ror:4 row_mask:0xf bank_mask:0xf
  v_add_f32_dpp v141, v141, v141 row_ror:4 row_mask:0xf bank_mask:0xf
  v_add_f32_dpp v142, v142, v142 row_ror:4 row_mask:0xf bank_mask:0xf
  v_add_f32_dpp v143, v143, v143 row_ror:4 row_mask:0xf bank_mask:0xf
  v_add_f32_dpp v144, v144, v144 row_ror:4 row_mask:0xf bank_mask:0xf
  v_add_f32_dpp v145, v145, v145 row_ror:4 row_mask:0xf bank_mask:0xf
  v_add_f32_dpp v146, v146, v146 row_ror:4 row_mask:0xf bank_mask:0xf
  v_add_f32_dpp v147, v147, v147 row_ror:4 row_mask:0xf bank_mask:0xf
  v_add_f32_dpp v148, v148, v148 row_ror:4 row_mask:0xf bank_mask:0xf
  v_add_f32_dpp v149, v149, v149 row_ror:4 row_mask:0xf bank_mask:0xf
  v_add_f32_dpp v150, v150, v150 row_ror:4 row_mask:0xf bank_mask:0xf
  v_add_f32_dpp v151, v151, v151 row_ror:4 row_mask:0xf bank_mask:0xf
  v_add_f32_dpp v136, v136, v136 row_ror:8 row_mask:0xf bank_mask:0xf
  v_add_f32_dpp v137, v137, v137 row_ror:8 row_mask:0xf bank_mask:0xf
  v_add_f32_dpp v138, v138, v138 row_ror:8 row_mask:0xf bank_mask:0xf
  v_add_f32_dpp v139, v139, v139 row_ror:8 row_mask:0xf bank_mask:0xf
  v_add_f32_dpp v140, v140, v140 row_ror:8 row_mask:0xf bank_mask:0xf
  v_add_f32_dpp v141, v141, v141 row_ror:8 row_mask:0xf bank_mask:0xf
  v_add_f32_dpp v142, v142, v142 row_ror:8 row_mask:0xf bank_mask:0xf
  v_add_f32_dpp v143, v143, v143 row_ror:8 row_mask:0xf bank_mask:0xf
  v_add_f32_dpp v144, v144, v144 row_ror:8 row_mask:0xf bank_mask:0xf
  v_add_f32_dpp v145, v145, v145 row_ror:8 row_mask:0xf bank_mask:0xf
  v_add_f32_dpp v146, v146, v146 row_ror:8 row_mask:0xf bank_mask:0xf
  v_add_f32_dpp v147, v147, v147 row_ror:8 row_mask:0xf bank_mask:0xf
  v_add_f32_dpp v148, v148, v148 row_ror:8 row_mask:0xf bank_mask:0xf
  v_add_f32_dpp v149, v149, v149 row_ror:8 row_mask:0xf bank_mask:0xf
  v_add_f32_dpp v150, v150, v150 row_ror:8 row_mask:0xf bank_mask:0xf
  v_add_f32_dpp v151, v151, v151 row_ror:8 row_mask:0xf bank_mask:0xf
L_sequential_preLN__mha_block__mixer_gmlp__prompt_kernel_p4s_skip:
  s_waitcnt vmcnt(0)
  s_barrier
  s_add_u32 s32, s51, 0
  s_and_b32 s32, s32, 7
  s_add_u32 m0, s50, 32768
  s_lshl_b32 s32, s32, 12
  s_add_u32 s32, s32, s48
  buffer_load_dwordx4 v2, s[28:31], s32 offen sc1 lds
  buffer_load_dwordx4 v2, s[28:31], s32 offen offset:1024 sc1 lds
  s_add_u32 s32, s51, 1
  s_and_b32 s32, s32, 7
  s_add_u32 m0, s50, 40960
  s_lshl_b32 s32, s32, 12
  s_add_u32 s32, s32, s48
  buffer_load_dwordx4 v2, s[28:31], s32 offen sc1 lds
  buffer_load_dwordx4 v2, s[28:31], s32 offen offset:1024 sc1 lds
  s_add_u32 s32, s51, 2
  s_and_b32 s32, s32, 7
  s_add_u32 m0, s50, 49152
  s_lshl_b32 s32, s32, 12
  s_add_u32 s32, s32, s48
  buffer_load_dwordx4 v2, s[28:31], s32 offen sc1 lds
  buffer_load_dwordx4 v2, s[28:31], s32 offen offset:1024 sc1 lds
  s_add_u32 s32, s51, 3
  s_and_b32 s32, s32, 7
  s_add_u32 m0, s50, 57344
  s_lshl_b32 s32, s32, 12
  s_add_u32 s32, s32, s48
  buffer_load_dwordx4 v2, s[28:31], s32 offen sc1 lds
  buffer_load_dwordx4 v2, s[28:31], s32 offen offset:1024 sc1 lds
  s_waitcnt vmcnt(6)
  s_barrier
  s_add_u32 s32, s51, 4
  s_and_b32 s32, s32, 7
  s_add_u32 m0, s50, 98304
  s_lshl_b32 s32, s32, 12
  s_add_u32 s32, s32, s48
  buffer_load_dwordx4 v2, s[28:31], s32 offen sc1 lds
  buffer_load_dwordx4 v2, s[28:31], s32 offen offset:1024 sc1 lds
  s_waitcnt vmcnt(6)
  s_barrier
  s_add_u32 s32, s51, 5
  s_and_b32 s32, s32, 7
  s_add_u32 m0, s50, 106496
  s_lshl_b32 s32, s32, 12
  s_add_u32 s32, s32, s48
  buffer_load_dwordx4 v2, s[28:31], s32 offen sc1 lds
  buffer_load_dwordx4 v2, s[28:31], s32 offen offset:1024 sc1 lds
  s_waitcnt vmcnt(6)
  s_barrier
  s_add_u32 s32, s51, 6
  s_and_b32 s32, s32, 7
  s_add_u32 m0, s50, 114688
  s_lshl_b32 s32, s32, 12
  s_add_u32 s32, s32, s48
  buffer_load_dwordx4 v2, s[28:31], s32 offen sc1 lds
  buffer_load_dwordx4 v2, s[28:31], s32 offen offset:1024 sc1 lds
  s_waitcnt vmcnt(6)
  s_barrier
  s_add_u32 s32, s51, 7
  s_and_b32 s32, s32, 7
  s_add_u32 m0, s50, 122880
  s_lshl_b32 s32, s32, 12
  s_add_u32 s32, s32, s48
  buffer_load_dwordx4 v2, s[28:31], s32 offen sc1 lds
  buffer_load_dwordx4 v2, s[28:31], s32 offen offset:1024 sc1 lds
  s_waitcnt vmcnt(6)
  s_barrier
  s_waitcnt vmcnt(4)
  s_barrier
  s_waitcnt vmcnt(2)
  s_barrier
  s_waitcnt vmcnt(0)
  s_barrier
  s_barrier
  s_lshl_b32 s32, s35, 1
  s_and_b32 s33, s36, 1
  s_add_u32 s41, s32, s33
  s_lshr_b32 s42, s36, 1
  s_lshl_b32 s45, s33, 2
  s_add_u32 s45, s45, s42
  s_and_b32 s45, s45, 0
  s_lshl_b32 s32, s41, 2
  s_add_u32 s32, s32, s40
  s_lshl_b32 s43, s32, 15
  s_add_u32 s43, s43, 0x800000
  s_lshl_b32 s44, s40, 12
  s_lshl_b32 s32, s40, 11
  s_add_u32 s32, s32, 131072
  v_add_u32 v152, s32, v2
  s_cmp_ge_u32 s36, 28
  s_cbranch_scc1 L_sequential_preLN__mha_block__mixer_gmlp__prompt_kernel_p4l_skippre
  ds_write_b128 v152, v[8:11] offset:0
  ds_write_b128 v152, v[12:15] offset:1024
  ds_write_b128 v152, v[16:19] offset:8192
  ds_write_b128 v152, v[20:23] offset:9216
  ds_write_b128 v152, v[24:27] offset:16384
  ds_write_b128 v152, v[28:31] offset:17408
  v_and_b32 v4, 3, v1
  v_lshlrev_b32 v4, 5, v4
  v_and_b32 v5, 16, v1
  s_lshl_b32 s32, s40, 9
  s_add_u32 s32, s32, 157696
  v_add3_u32 v4, v4, v5, s32
  s_mov_b64 exec, 0xf000f
  ds_write_b128 v4, v[136:139] offset:0
  ds_write_b128 v4, v[140:143] offset:128
  ds_write_b128 v4, v[144:147] offset:256
  ds_write_b128 v4, v[148:151] offset:384
  s_mov_b64 exec, -1
  s_waitcnt lgkmcnt(0)
L_sequential_preLN__mha_block__mixer_gmlp__prompt_kernel_p4l_skippre:
  s_barrier
  s_lshl_b32 s32, s35, 2
  s_and_b32 s33, s36, 3
  s_add_u32 s46, s32, s33
  s_lshr_b32 s47, s36, 2
  s_lshl_b32 s55, s33, 1
  s_add_u32 s55, s55, s47
  s_and_b32 s55, s55, 0
  s_mul_i32 s55, s55, 7
  s_lshr_b32 s55, s55, 2
  v_lshrrev_b32 v4, 2, v1
  v_lshlrev_b32 v4, 10, v4
  v_and_b32 v5, 3, v1
  v_lshl_add_u32 v153, v5, 4, v4
  v_add_u32 v154, 64, v153
  v_add_u32 v153, 1024, v153
  s_lshr_b32 s32, s40, 1
  s_lshl_b32 s33, s46, 1
  s_add_u32 s32, s32, s33
  s_mul_i32 s52, s32, 57344
  s_and_b32 s32, s40, 1
  s_lshl_b32 s32, s32, 11
  s_add_u32 s52, s52, s32
  s_add_u32 s52, s52, 0x1200000
  s_lshl_b32 s54, s40, 11
  s_lshl_b32 s53, s40, 14
  s_lshl_b32 s32, s47, 7
  s_add_u32 s53, s53, s32
  s_sub_u32 s48, s18, 1024
  s_subb_u32 s49, s19, 0
  s_and_b32 s49, s49, 0xffff
  s_mov_b32 s50, 0xe0400
  s_mov_b32 s51, 0x20000
  s_and_b32 s32, s35, 3
  s_lshl_b32 s32, s32, 3
  s_and_b32 s33, s36, 7
  s_add_u32 s56, s32, s33
  s_lshr_b32 s32, s35, 2
  s_lshl_b32 s32, s32, 2
  s_lshr_b32 s57, s36, 3
  s_add_u32 s57, s57, s32
  v_lshrrev_b32 v4, 4, v1
  v_and_b32 v5, 7, v1
  v_xor_b32 v5, v5, v4
  v_lshrrev_b32 v4, 3, v1
  v_lshlrev_b32 v4, 12, v4
  v_lshl_add_u32 v155, v5, 4, v4
  v_xor_b32 v156, 64, v155
  v_add_u32 v156, 31744, v156
  s_lshl_b32 s64, s56, 18
  s_lshl_b32 s32, s40, 16
  s_add_u32 s64, s64, s32
  s_lshl_b32 s65, s40, 11
  s_add_u32 s66, s65, 163840
  s_lshl_b32 s67, s35, 1
  s_and_b32 s68, s36, 0
  s_mov_b32 s60, s14
  s_and_b32 s61, s15, 0xffff
  s_mov_b32 s62, 0x800000
  s_mov_b32 s63, 0x20000
  s_cmp_ge_u32 s36, 28
  s_cbranch_scc1 L_sequential_preLN__mha_block__mixer_gmlp__prompt_kernel_p4l_idle
  s_lshl_b32 s32, s40, 7
  s_add_u32 s32, s32, 157696
  v_and_b32 v4, 31, v1
  v_lshl_add_u32 v4, v4, 2, s32
  ds_read_b32 v8, v4 offset:0
  ds_read_b32 v9, v4 offset:512
  ds_read_b32 v10, v4 offset:1024
  ds_read_b32 v11, v4 offset:1536
  v_subrev_u32 v5, 2048, v4
  s_waitcnt lgkmcnt(0)
  v_add_f32 v8, v8, v9
  v_add_f32 v10, v10, v11
  v_add_f32 v8, v8, v10
  ds_write_b32 v5, v8
  s_waitcnt lgkmcnt(0)
  s_barrier
  s_add_u32 s32, s45, 0
  s_and_b32 s32, s32, 7
  s_add_u32 m0, s44, 0
  s_lshl_b32 s32, s32, 12
  s_add_u32 s32, s32, s43
  buffer_load_dwordx4 v2, s[28:31], s32 offen offset:0 sc1 lds
  buffer_load_dwordx4 v2, s[28:31], s32 offen offset:1024 sc1 lds
  buffer_load_dwordx4 v2, s[28:31], s32 offen offset:2048 sc1 lds
  buffer_load_dwordx4 v2, s[28:31], s32 offen offset:3072 sc1 lds
  s_add_u32 s32, s45, 1
  s_and_b32 s32, s32, 7
  s_add_u32 m0, s44, 16384
  s_lshl_b32 s32, s32, 12
  s_add_u32 s32, s32, s43
  buffer_load_dwordx4 v2, s[28:31], s32 offen offset:0 sc1 lds
  buffer_load_dwordx4 v2, s[28:31], s32 offen offset:1024 sc1 lds
  buffer_load_dwordx4 v2, s[28:31], s32 offen offset:2048 sc1 lds
  buffer_load_dwordx4 v2, s[28:31], s32 offen offset:3072 sc1 lds
  s_add_u32 s32, s45, 2
  s_and_b32 s32, s32, 7
  s_add_u32 m0, s44, 32768
  s_lshl_b32 s32, s32, 12
  s_add_u32 s32, s32, s43
  buffer_load_dwordx4 v2, s[28:31], s32 offen offset:0 sc1 lds
  buffer_load_dwordx4 v2, s[28:31], s32 offen offset:1024 sc1 lds
  buffer_load_dwordx4 v2, s[28:31], s32 offen offset:2048 sc1 lds
  buffer_load_dwordx4 v2, s[28:31], s32 offen offset:3072 sc1 lds
  s_waitcnt vmcnt(8) lgkmcnt(0)
  s_barrier
  s_add_u32 s32, s45, 3
  s_and_b32 s32, s32, 7
  s_add_u32 m0, s44, 49152
  s_lshl_b32 s32, s32, 12
  s_add_u32 s32, s32, s43
  buffer_load_dwordx4 v2, s[28:31], s32 offen offset:0 sc1 lds
  buffer_load_dwordx4 v2, s[28:31], s32 offen offset:1024 sc1 lds
  buffer_load_dwordx4 v2, s[28:31], s32 offen offset:2048 sc1 lds
  buffer_load_dwordx4 v2, s[28:31], s32 offen offset:3072 sc1 lds
  s_waitcnt vmcnt(8) lgkmcnt(0)
  s_barrier
  s_add_u32 s32, s45, 4
  s_and_b32 s32, s32, 7
  s_add_u32 m0, s44, 65536
  s_lshl_b32 s32, s32, 12
  s_add_u32 s32, s32, s43
  buffer_load_dwordx4 v2, s[28:31], s32 offen offset:0 sc1 lds
  buffer_load_dwordx4 v2, s[28:31], s32 offen offset:1024 sc1 lds
  buffer_load_dwordx4 v2, s[28:31], s32 offen offset:2048 sc1 lds
  buffer_load_dwordx4 v2, s[28:31], s32 offen offset:3072 sc1 lds
  s_sub_u32 s32, s43, 0x800000
  s_lshr_b32 s32, s32, 3
  s_add_u32 s32, s32, 0x1680000
  buffer_load_dwordx4 v[8:11], v2, s[28:31], s32 offen offset:0 sc1
  buffer_load_dwordx4 v[12:15], v2, s[28:31], s32 offen offset:1024 sc1
  buffer_load_dwordx4 v[16:19], v2, s[28:31], s32 offen offset:2048 sc1
  buffer_load_dwordx4 v[20:23], v2, s[28:31], s32 offen offset:3072 sc1
  s_waitcnt vmcnt(12) lgkmcnt(0)
  s_barrier
  ds_write_b128 v152, v[32:35] offset:0
  ds_write_b128 v152, v[36:39] offset:1024
  s_add_u32 s32, s45, 5
  s_and_b32 s32, s32, 7
  s_add_u32 m0, s44, 81920
  s_lshl_b32 s32, s32, 12
  s_add_u32 s32, s32, s43
  buffer_load_dwordx4 v2, s[28:31], s32 offen offset:0 sc1 lds
  buffer_load_dwordx4 v2, s[28:31], s32 offen offset:1024 sc1 lds
  buffer_load_dwordx4 v2, s[28:31], s32 offen offset:2048 sc1 lds
  buffer_load_dwordx4 v2, s[28:31], s32 offen offset:3072 sc1 lds
  s_waitcnt vmcnt(12) lgkmcnt(0)
  s_barrier
  ds_write_b128 v152, v[40:43] offset:8192
  ds_write_b128 v152, v[44:47] offset:9216
  s_add_u32 s32, s45, 6
  s_and_b32 s32, s32, 7
  s_add_u32 m0, s44, 98304
  s_lshl_b32 s32, s32, 12
  s_add_u32 s32, s32, s43
  buffer_load_dwordx4 v2, s[28:31], s32 offen offset:0 sc1 lds
  buffer_load_dwordx4 v2, s[28:31], s32 offen offset:1024 sc1 lds
  buffer_load_dwordx4 v2, s[28:31], s32 offen offset:2048 sc1 lds
  buffer_load_dwordx4 v2, s[28:31], s32 offen offset:3072 sc1 lds
  s_waitcnt vmcnt(12) lgkmcnt(0)
  s_barrier
  ds_write_b128 v152, v[48:51] offset:16384
  ds_write_b128 v152, v[52:55] offset:17408
  s_add_u32 s32, s45, 7
  s_and_b32 s32, s32, 7
  s_add_u32 m0, s44, 114688
  s_lshl_b32 s32, s32, 12
  s_add_u32 s32, s32, s43
  buffer_load_dwordx4 v2, s[28:31], s32 offen offset:0 sc1 lds
  buffer_load_dwordx4 v2, s[28:31], s32 offen offset:1024 sc1 lds
  buffer_load_dwordx4 v2, s[28:31], s32 offen offset:2048 sc1 lds
  buffer_load_dwordx4 v2, s[28:31], s32 offen offset:3072 sc1 lds
  s_add_u32 s32, s55, 0
  s_sub_u32 s33, s32, 14
  s_cselect_b32 s32, s32, s33
  s_lshl_b32 s32, s32, 16
  s_add_u32 s32, s32, s53
  buffer_load_dwordx4 v[24:27], v153, s[48:51], s32 offen
  buffer_load_dwordx4 v[28:31], v154, s[48:51], s32 offen offset:1024
  s_add_u32 s32, s55, 1
  s_sub_u32 s33, s32, 14
  s_cselect_b32 s32, s32, s33
  s_lshl_b32 s32, s32, 16
  s_add_u32 s32, s32, s53
  buffer_load_dwordx4 v[32:35], v153, s[48:51], s32 offen
  buffer_load_dwordx4 v[36:39], v154, s[48:51], s32 offen offset:1024
  s_waitcnt vmcnt(12) lgkmcnt(0)
  s_barrier
  ds_write_b128 v152, v[56:59] offset:0
  ds_write_b128 v152, v[60:63] offset:1024
  v_add_f32 v8, v8, v12
  v_add_f32 v16, v16, v20
  v_add_f32 v8, v8, v16
  v_add_f32 v9, v9, v13
  v_add_f32 v17, v17, v21
  v_add_f32 v9, v9, v17
  v_add_f32 v10, v10, v14
  v_add_f32 v18, v18, v22
  v_add_f32 v10, v10, v18
  v_add_f32 v11, v11, v15
  v_add_f32 v19, v19, v23
  v_add_f32 v11, v11, v19
  v_mov_b32 v12, v8
  v_mov_b32 v13, v9
  v_mov_b32 v14, v10
  v_mov_b32 v15, v11
  s_nop 1
  v_permlane32_swap_b32 v12, v8
  v_permlane32_swap_b32 v13, v9
  v_permlane32_swap_b32 v14, v10
  v_permlane32_swap_b32 v15, v11
  s_nop 1
  v_add_f32 v8, v8, v12
  v_add_f32 v9, v9, v13
  v_add_f32 v10, v10, v14
  v_add_f32 v11, v11, v15
  v_mov_b32 v12, v8
  v_mov_b32 v13, v9
  v_mov_b32 v14, v10
  v_mov_b32 v15, v11
  s_add_u32 s32, s55, 2
  s_sub_u32 s33, s32, 14
  s_cselect_b32 s32, s32, s33
  s_lshl_b32 s32, s32, 16
  s_add_u32 s32, s32, s53
  buffer_load_dwordx4 v[40:43], v153, s[48:51], s32 offen
  buffer_load_dwordx4 v[44:47], v154, s[48:51], s32 offen offset:1024
  s_add_u32 s32, s55, 3
  s_sub_u32 s33, s32, 14
  s_cselect_b32 s32, s32, s33
  s_lshl_b32 s32, s32, 16
  s_add_u32 s32, s32, s53
  buffer_load_dwordx4 v[48:51], v153, s[48:51], s32 offen
  buffer_load_dwordx4 v[52:55], v154, s[48:51], s32 offen offset:1024
  s_waitcnt vmcnt(12) lgkmcnt(0)
  s_barrier
  ds_write_b128 v152, v[64:67] offset:8192
  ds_write_b128 v152, v[68:71] offset:9216
  s_nop 1
  v_permlane16_swap_b32 v12, v8
  v_permlane16_swap_b32 v13, v9
  v_permlane16_swap_b32 v14, v10
  v_permlane16_swap_b32 v15, v11
  s_nop 1
  v_add_f32 v8, v8, v12
  v_add_f32 v9, v9, v13
  v_add_f32 v10, v10, v14
  v_add_f32 v11, v11, v15
  v_mul_f32 v8, 0x3b000000, v8
  v_mul_f32 v9, 0x3b000000, v9
  v_fma_f32 v9, -v8, v8, v9
  v_max_f32 v9, 0, v9
  v_add_f32 v9, 0x3727c5ac, v9
  v_rsq_f32 v12, v9
  s_nop 0
  v_mul_f32 v13, v8, v12
  v_sub_f32 v13, 0, v13
  v_mul_f32 v10, 0x3b000000, v10
  v_mul_f32 v11, 0x3b000000, v11
  v_fma_f32 v11, -v10, v10, v11
  s_add_u32 s32, s55, 4
  s_sub_u32 s33, s32, 14
  s_cselect_b32 s32, s32, s33
  s_lshl_b32 s32, s32, 16
  s_add_u32 s32, s32, s53
  buffer_load_dwordx4 v[56:59], v153, s[48:51], s32 offen
  buffer_load_dwordx4 v[60:63], v154, s[48:51], s32 offen offset:1024
  s_waitcnt vmcnt(10) lgkmcnt(0)
  s_barrier
  ds_write_b128 v152, v[72:75] offset:16384
  ds_write_b128 v152, v[76:79] offset:17408
  v_max_f32 v11, 0, v11
  v_add_f32 v11, 0x3727c5ac, v11
  v_rsq_f32 v14, v11
  s_nop 0
  v_mul_f32 v15, v10, v14
  v_sub_f32 v15, 0, v15
  s_lshl_b32 s32, s40, 8
  s_add_u32 s32, s32, 156160
  v_and_b32 v8, 15, v1
  v_lshl_add_u32 v8, v8, 4, s32
  ds_write_b128 v8, v[12:15]
  s_add_u32 s32, s55, 5
  s_sub_u32 s33, s32, 14
  s_cselect_b32 s32, s32, s33
  s_lshl_b32 s32, s32, 16
  s_add_u32 s32, s32, s53
  buffer_load_dwordx4 v[64:67], v153, s[48:51], s32 offen
  buffer_load_dwordx4 v[68:71], v154, s[48:51], s32 offen offset:1024
  s_waitcnt lgkmcnt(0)
  s_barrier
  ds_write_b128 v152, v[80:83] offset:0
  ds_write_b128 v152, v[84:87] offset:1024
  s_add_u32 s32, s55, 6
  s_sub_u32 s33, s32, 14
  s_cselect_b32 s32, s32, s33
  s_lshl_b32 s32, s32, 16
  s_add_u32 s32, s32, s53
  buffer_load_dwordx4 v[72:75], v153, s[48:51], s32 offen
  buffer_load_dwordx4 v[76:79], v154, s[48:51], s32 offen offset:1024
  s_add_u32 s67, s67, 8
  s_add_u32 s33, s67, s68
  s_and_b32 s33, s33, 3
  s_and_b32 s32, s67, 12
  s_or_b32 s32, s32, s33
  s_mul_i32 s32, s32, 256
  s_add_u32 s32, s32, s64
  s_add_u32 s67, s67, 1
  s_sub_u32 s67, s67, 9
  buffer_load_dwordx4 v[8:11], v155, s[60:63], s32 offen offset:0
  buffer_load_dwordx4 v[12:15], v156, s[60:63], s32 offen offset:1024
  buffer_load_dwordx4 v[16:19], v155, s[60:63], s32 offen offset:128
  buffer_load_dwordx4 v[20:23], v156, s[60:63], s32 offen offset:1152
  s_waitcnt lgkmcnt(0)
  s_barrier
  ds_write_b128 v152, v[88:91] offset:8192
  ds_write_b128 v152, v[92:95] offset:9216
  s_add_u32 s32, s55, 7
  s_sub_u32 s33, s32, 14
  s_cselect_b32 s32, s32, s33
  s_lshl_b32 s32, s32, 16
  s_add_u32 s32, s32, s53
  buffer_load_dwordx4 v[80:83], v153, s[48:51], s32 offen
  buffer_load_dwordx4 v[84:87], v154, s[48:51], s32 offen offset:1024
  s_add_u32 s67, s67, 9
  s_add_u32 s33, s67, s68
  s_and_b32 s33, s33, 3
  s_and_b32 s32, s67, 12
  s_or_b32 s32, s32, s33
  s_mul_i32 s32, s32, 256
  s_add_u32 s32, s32, s64
  s_add_u32 s67, s67, 1
  s_sub_u32 s67, s67, 10
  buffer_load_dwordx4 v[136:139], v155, s[60:63], s32 offen offset:0
  buffer_load_dwordx4 v[140:143], v156, s[60:63], s32 offen offset:1024
  buffer_load_dwordx4 v[144:147], v155, s[60:63], s32 offen offset:128
  buffer_load_dwordx4 v[148:151], v156, s[60:63], s32 offen offset:1152
  s_waitcnt lgkmcnt(0)
  s_barrier
  ds_write_b128 v152, v[96:99] offset:16384
  ds_write_b128 v152, v[100:103] offset:17408
  s_add_u32 s32, s55, 8
  s_sub_u32 s33, s32, 14
  s_cselect_b32 s32, s32, s33
  s_lshl_b32 s32, s32, 16
  s_add_u32 s32, s32, s53
  buffer_load_dwordx4 v[88:91], v153, s[48:51], s32 offen
  buffer_load_dwordx4 v[92:95], v154, s[48:51], s32 offen offset:1024
  s_mov_b32 m0, s65
  s_add_u32 s33, s67, s68
  s_and_b32 s33, s33, 3
  s_and_b32 s32, s67, 12
  s_or_b32 s32, s32, s33
  s_mul_i32 s32, s32, 256
  s_add_u32 s32, s32, s64
  s_add_u32 s67, s67, 1
  buffer_load_dwordx4 v155, s[60:63], s32 offen lds
  buffer_load_dwordx4 v156, s[60:63], s32 offen offset:1024 lds
  s_add_u32 m0, m0, 8192
  s_add_u32 s32, s32, 128
  buffer_load_dwordx4 v155, s[60:63], s32 offen lds
  buffer_load_dwordx4 v156, s[60:63], s32 offen offset:1024 lds
  s_add_u32 s65, s65, 16384
  s_sub_u32 s32, s65, 163840
  s_cmp_eq_u32 s65, s66
  s_cselect_b32 s65, s32, s65
  s_waitcnt lgkmcnt(0)
  s_barrier
  ds_write_b128 v152, v[104:107] offset:0
  ds_write_b128 v152, v[108:111] offset:1024
  s_add_u32 s32, s55, 9
  s_sub_u32 s33, s32, 14
  s_cselect_b32 s32, s32, s33
  s_lshl_b32 s32, s32, 16
  s_add_u32 s32, s32, s53
  buffer_load_dwordx4 v[96:99], v153, s[48:51], s32 offen
  buffer_load_dwordx4 v[100:103], v154, s[48:51], s32 offen offset:1024
  s_mov_b32 m0, s65
  s_add_u32 s33, s67, s68
  s_and_b32 s33, s33, 3
  s_and_b32 s32, s67, 12
  s_or_b32 s32, s32, s33
  s_mul_i32 s32, s32, 256
  s_add_u32 s32, s32, s64
  s_add_u32 s67, s67, 1
  buffer_load_dwordx4 v155, s[60:63], s32 offen lds
  buffer_load_dwordx4 v156, s[60:63], s32 offen offset:1024 lds
  s_add_u32 m0, m0, 8192
  s_add_u32 s32, s32, 128
  buffer_load_dwordx4 v155, s[60:63], s32 offen lds
  buffer_load_dwordx4 v156, s[60:63], s32 offen offset:1024 lds
  s_add_u32 s65, s65, 16384
  s_sub_u32 s32, s65, 163840
  s_cmp_eq_u32 s65, s66
  s_cselect_b32 s65, s32, s65
  s_waitcnt lgkmcnt(0)
  s_barrier
  ds_write_b128 v152, v[112:115] offset:8192
  ds_write_b128 v152, v[116:119] offset:9216
  s_add_u32 s32, s55, 10
  s_sub_u32 s33, s32, 14
  s_cselect_b32 s32, s32, s33
  s_lshl_b32 s32, s32, 16
  s_add_u32 s32, s32, s53
  buffer_load_dwordx4 v[104:107], v153, s[48:51], s32 offen
  buffer_load_dwordx4 v[108:111], v154, s[48:51], s32 offen offset:1024
  s_mov_b32 m0, s65
  s_add_u32 s33, s67, s68
  s_and_b32 s33, s33, 3
  s_and_b32 s32, s67, 12
  s_or_b32 s32, s32, s33
  s_mul_i32 s32, s32, 256
  s_add_u32 s32, s32, s64
  s_add_u32 s67, s67, 1
  buffer_load_dwordx4 v155, s[60:63], s32 offen lds
  buffer_load_dwordx4 v156, s[60:63], s32 offen offset:1024 lds
  s_add_u32 m0, m0, 8192
  s_add_u32 s32, s32, 128
  buffer_load_dwordx4 v155, s[60:63], s32 offen lds
  buffer_load_dwordx4 v156, s[60:63], s32 offen offset:1024 lds
  s_add_u32 s65, s65, 16384
  s_sub_u32 s32, s65, 163840
  s_cmp_eq_u32 s65, s66
  s_cselect_b32 s65, s32, s65
  s_waitcnt lgkmcnt(0)
  s_barrier
  ds_write_b128 v152, v[120:123] offset:16384
  ds_write_b128 v152, v[124:127] offset:17408
  s_add_u32 s32, s55, 11
  s_sub_u32 s33, s32, 14
  s_cselect_b32 s32, s32, s33
  s_lshl_b32 s32, s32, 16
  s_add_u32 s32, s32, s53
  buffer_load_dwordx4 v[112:115], v153, s[48:51], s32 offen
  buffer_load_dwordx4 v[116:119], v154, s[48:51], s32 offen offset:1024
  s_mov_b32 m0, s65
  s_add_u32 s33, s67, s68
  s_and_b32 s33, s33, 3
  s_and_b32 s32, s67, 12
  s_or_b32 s32, s32, s33
  s_mul_i32 s32, s32, 256
  s_add_u32 s32, s32, s64
  s_add_u32 s67, s67, 1
  buffer_load_dwordx4 v155, s[60:63], s32 offen lds
  buffer_load_dwordx4 v156, s[60:63], s32 offen offset:1024 lds
  s_add_u32 m0, m0, 8192
  s_add_u32 s32, s32, 128
  buffer_load_dwordx4 v155, s[60:63], s32 offen lds
  buffer_load_dwordx4 v156, s[60:63], s32 offen offset:1024 lds
  s_add_u32 s65, s65, 16384
  s_sub_u32 s32, s65, 163840
  s_cmp_eq_u32 s65, s66
  s_cselect_b32 s65, s32, s65
  s_waitcnt lgkmcnt(0)
  s_barrier
  ds_write_b128 v152, v[128:131] offset:0
  ds_write_b128 v152, v[132:135] offset:1024
  s_add_u32 s32, s55, 12
  s_sub_u32 s33, s32, 14
  s_cselect_b32 s32, s32, s33
  s_lshl_b32 s32, s32, 16
  s_add_u32 s32, s32, s53
  buffer_load_dwordx4 v[120:123], v153, s[48:51], s32 offen
  buffer_load_dwordx4 v[124:127], v154, s[48:51], s32 offen offset:1024
  s_mov_b32 m0, s65
  s_add_u32 s33, s67, s68
  s_and_b32 s33, s33, 3
  s_and_b32 s32, s67, 12
  s_or_b32 s32, s32, s33
  s_mul_i32 s32, s32, 256
  s_add_u32 s32, s32, s64
  s_add_u32 s67, s67, 1
  buffer_load_dwordx4 v155, s[60:63], s32 offen lds
  buffer_load_dwordx4 v156, s[60:63], s32 offen offset:1024 lds
  s_add_u32 m0, m0, 8192
  s_add_u32 s32, s32, 128
  buffer_load_dwordx4 v155, s[60:63], s32 offen lds
  buffer_load_dwordx4 v156, s[60:63], s32 offen offset:1024 lds
  s_add_u32 s65, s65, 16384
  s_sub_u32 s32, s65, 163840
  s_cmp_eq_u32 s65, s66
  s_cselect_b32 s65, s32, s65
  s_waitcnt lgkmcnt(0)
  s_barrier
  s_add_u32 s32, s55, 13
  s_sub_u32 s33, s32, 14
  s_cselect_b32 s32, s32, s33
  s_lshl_b32 s32, s32, 16
  s_add_u32 s32, s32, s53
  buffer_load_dwordx4 v[128:131], v153, s[48:51], s32 offen
  buffer_load_dwordx4 v[132:135], v154, s[48:51], s32 offen offset:1024
  s_mov_b32 m0, s65
  s_add_u32 s33, s67, s68
  s_and_b32 s33, s33, 3
  s_and_b32 s32, s67, 12
  s_or_b32 s32, s32, s33
  s_mul_i32 s32, s32, 256
  s_add_u32 s32, s32, s64
  s_add_u32 s67, s67, 1
  buffer_load_dwordx4 v155, s[60:63], s32 offen lds
  buffer_load_dwordx4 v156, s[60:63], s32 offen offset:1024 lds
  s_add_u32 m0, m0, 8192
  s_add_u32 s32, s32, 128
  buffer_load_dwordx4 v155, s[60:63], s32 offen lds
  buffer_load_dwordx4 v156, s[60:63], s32 offen offset:1024 lds
  s_add_u32 s65, s65, 16384
  s_sub_u32 s32, s65, 163840
  s_cmp_eq_u32 s65, s66
  s_cselect_b32 s65, s32, s65
  s_waitcnt lgkmcnt(0)
  s_barrier
  s_mov_b32 m0, s65
  s_add_u32 s33, s67, s68
  s_and_b32 s33, s33, 3
  s_and_b32 s32, s67, 12
  s_or_b32 s32, s32, s33
  s_mul_i32 s32, s32, 256
  s_add_u32 s32, s32, s64
  s_add_u32 s67, s67, 1
  buffer_load_dwordx4 v155, s[60:63], s32 offen lds
  buffer_load_dwordx4 v156, s[60:63], s32 offen offset:1024 lds
  s_add_u32 m0, m0, 8192
  s_add_u32 s32, s32, 128
  buffer_load_dwordx4 v155, s[60:63], s32 offen lds
  buffer_load_dwordx4 v156, s[60:63], s32 offen offset:1024 lds
  s_add_u32 s65, s65, 16384
  s_sub_u32 s32, s65, 163840
  s_cmp_eq_u32 s65, s66
  s_cselect_b32 s65, s32, s65
  s_mov_b32 m0, s65
  s_add_u32 s33, s67, s68
  s_and_b32 s33, s33, 3
  s_and_b32 s32, s67, 12
  s_or_b32 s32, s32, s33
  s_mul_i32 s32, s32, 256
  s_add_u32 s32, s32, s64
  s_add_u32 s67, s67, 1
  buffer_load_dwordx4 v155, s[60:63], s32 offen lds
  buffer_load_dwordx4 v156, s[60:63], s32 offen offset:1024 lds
  s_add_u32 m0, m0, 8192
  s_add_u32 s32, s32, 128
  buffer_load_dwordx4 v155, s[60:63], s32 offen lds
  buffer_load_dwordx4 v156, s[60:63], s32 offen offset:1024 lds
  s_add_u32 s65, s65, 16384
  s_sub_u32 s32, s65, 163840
  s_cmp_eq_u32 s65, s66
  s_cselect_b32 s65, s32, s65
  s_branch L_sequential_preLN__mha_block__mixer_gmlp__prompt_kernel_p4l_end
L_sequential_preLN__mha_block__mixer_gmlp__prompt_kernel_p4l_idle:
  s_add_u32 s67, s67, 8
  s_add_u32 s33, s67, s68
  s_and_b32 s33, s33, 3
  s_and_b32 s32, s67, 12
  s_or_b32 s32, s32, s33
  s_mul_i32 s32, s32, 256
  s_add_u32 s32, s32, s64
  s_add_u32 s67, s67, 1
  s_sub_u32 s67, s67, 9
  buffer_load_dwordx4 v[8:11], v155, s[60:63], s32 offen offset:0
  buffer_load_dwordx4 v[12:15], v156, s[60:63], s32 offen offset:1024
  buffer_load_dwordx4 v[16:19], v155, s[60:63], s32 offen offset:128
  buffer_load_dwordx4 v[20:23], v156, s[60:63], s32 offen offset:1152
  s_add_u32 s67, s67, 9
  s_add_u32 s33, s67, s68
  s_and_b32 s33, s33, 3
  s_and_b32 s32, s67, 12
  s_or_b32 s32, s32, s33
  s_mul_i32 s32, s32, 256
  s_add_u32 s32, s32, s64
  s_add_u32 s67, s67, 1
  s_sub_u32 s67, s67, 10
  buffer_load_dwordx4 v[136:139], v155, s[60:63], s32 offen offset:0
  buffer_load_dwordx4 v[140:143], v156, s[60:63], s32 offen offset:1024
  buffer_load_dwordx4 v[144:147], v155, s[60:63], s32 offen offset:128
  buffer_load_dwordx4 v[148:151], v156, s[60:63], s32 offen offset:1152
  s_mov_b32 m0, s65
  s_add_u32 s33, s67, s68
  s_and_b32 s33, s33, 3
  s_and_b32 s32, s67, 12
  s_or_b32 s32, s32, s33
  s_mul_i32 s32, s32, 256
  s_add_u32 s32, s32, s64
  s_add_u32 s67, s67, 1
  buffer_load_dwordx4 v155, s[60:63], s32 offen lds
  buffer_load_dwordx4 v156, s[60:63], s32 offen offset:1024 lds
  s_add_u32 m0, m0, 8192
  s_add_u32 s32, s32, 128
  buffer_load_dwordx4 v155, s[60:63], s32 offen lds
  buffer_load_dwordx4 v156, s[60:63], s32 offen offset:1024 lds
  s_add_u32 s65, s65, 16384
  s_sub_u32 s32, s65, 163840
  s_cmp_eq_u32 s65, s66
  s_cselect_b32 s65, s32, s65
  s_mov_b32 m0, s65
  s_add_u32 s33, s67, s68
  s_and_b32 s33, s33, 3
  s_and_b32 s32, s67, 12
  s_or_b32 s32, s32, s33
  s_mul_i32 s32, s32, 256
  s_add_u32 s32, s32, s64
  s_add_u32 s67, s67, 1
  buffer_load_dwordx4 v155, s[60:63], s32 offen lds
  buffer_load_dwordx4 v156, s[60:63], s32 offen offset:1024 lds
  s_add_u32 m0, m0, 8192
  s_add_u32 s32, s32, 128
  buffer_load_dwordx4 v155, s[60:63], s32 offen lds
  buffer_load_dwordx4 v156, s[60:63], s32 offen offset:1024 lds
  s_add_u32 s65, s65, 16384
  s_sub_u32 s32, s65, 163840
  s_cmp_eq_u32 s65, s66
  s_cselect_b32 s65, s32, s65
  s_mov_b32 m0, s65
  s_add_u32 s33, s67, s68
  s_and_b32 s33, s33, 3
  s_and_b32 s32, s67, 12
  s_or_b32 s32, s32, s33
  s_mul_i32 s32, s32, 256
  s_add_u32 s32, s32, s64
  s_add_u32 s67, s67, 1
  buffer_load_dwordx4 v155, s[60:63], s32 offen lds
  buffer_load_dwordx4 v156, s[60:63], s32 offen offset:1024 lds
  s_add_u32 m0, m0, 8192
  s_add_u32 s32, s32, 128
  buffer_load_dwordx4 v155, s[60:63], s32 offen lds
  buffer_load_dwordx4 v156, s[60:63], s32 offen offset:1024 lds
  s_add_u32 s65, s65, 16384
  s_sub_u32 s32, s65, 163840
  s_cmp_eq_u32 s65, s66
  s_cselect_b32 s65, s32, s65
  s_mov_b32 m0, s65
  s_add_u32 s33, s67, s68
  s_and_b32 s33, s33, 3
  s_and_b32 s32, s67, 12
  s_or_b32 s32, s32, s33
  s_mul_i32 s32, s32, 256
  s_add_u32 s32, s32, s64
  s_add_u32 s67, s67, 1
  buffer_load_dwordx4 v155, s[60:63], s32 offen lds
  buffer_load_dwordx4 v156, s[60:63], s32 offen offset:1024 lds
  s_add_u32 m0, m0, 8192
  s_add_u32 s32, s32, 128
  buffer_load_dwordx4 v155, s[60:63], s32 offen lds
  buffer_load_dwordx4 v156, s[60:63], s32 offen offset:1024 lds
  s_add_u32 s65, s65, 16384
  s_sub_u32 s32, s65, 163840
  s_cmp_eq_u32 s65, s66
  s_cselect_b32 s65, s32, s65
  s_mov_b32 m0, s65
  s_add_u32 s33, s67, s68
  s_and_b32 s33, s33, 3
  s_and_b32 s32, s67, 12
  s_or_b32 s32, s32, s33
  s_mul_i32 s32, s32, 256
  s_add_u32 s32, s32, s64
  s_add_u32 s67, s67, 1
  buffer_load_dwordx4 v155, s[60:63], s32 offen lds
  buffer_load_dwordx4 v156, s[60:63], s32 offen offset:1024 lds
  s_add_u32 m0, m0, 8192
  s_add_u32 s32, s32, 128
  buffer_load_dwordx4 v155, s[60:63], s32 offen lds
  buffer_load_dwordx4 v156, s[60:63], s32 offen offset:1024 lds
  s_add_u32 s65, s65, 16384
  s_sub_u32 s32, s65, 163840
  s_cmp_eq_u32 s65, s66
  s_cselect_b32 s65, s32, s65
  s_mov_b32 m0, s65
  s_add_u32 s33, s67, s68
  s_and_b32 s33, s33, 3
  s_and_b32 s32, s67, 12
  s_or_b32 s32, s32, s33
  s_mul_i32 s32, s32, 256
  s_add_u32 s32, s32, s64
  s_add_u32 s67, s67, 1
  buffer_load_dwordx4 v155, s[60:63], s32 offen lds
  buffer_load_dwordx4 v156, s[60:63], s32 offen offset:1024 lds
  s_add_u32 m0, m0, 8192
  s_add_u32 s32, s32, 128
  buffer_load_dwordx4 v155, s[60:63], s32 offen lds
  buffer_load_dwordx4 v156, s[60:63], s32 offen offset:1024 lds
  s_add_u32 s65, s65, 16384
  s_sub_u32 s32, s65, 163840
  s_cmp_eq_u32 s65, s66
  s_cselect_b32 s65, s32, s65
  s_mov_b32 m0, s65
  s_add_u32 s33, s67, s68
  s_and_b32 s33, s33, 3
  s_and_b32 s32, s67, 12
  s_or_b32 s32, s32, s33
  s_mul_i32 s32, s32, 256
  s_add_u32 s32, s32, s64
  s_add_u32 s67, s67, 1
  buffer_load_dwordx4 v155, s[60:63], s32 offen lds
  buffer_load_dwordx4 v156, s[60:63], s32 offen offset:1024 lds
  s_add_u32 m0, m0, 8192
  s_add_u32 s32, s32, 128
  buffer_load_dwordx4 v155, s[60:63], s32 offen lds
  buffer_load_dwordx4 v156, s[60:63], s32 offen offset:1024 lds
  s_add_u32 s65, s65, 16384
  s_sub_u32 s32, s65, 163840
  s_cmp_eq_u32 s65, s66
  s_cselect_b32 s65, s32, s65
  s_mov_b32 m0, s65
  s_add_u32 s33, s67, s68
  s_and_b32 s33, s33, 3
  s_and_b32 s32, s67, 12
  s_or_b32 s32, s32, s33
  s_mul_i32 s32, s32, 256
  s_add_u32 s32, s32, s64
  s_add_u32 s67, s67, 1
  buffer_load_dwordx4 v155, s[60:63], s32 offen lds
  buffer_load_dwordx4 v156, s[60:63], s32 offen offset:1024 lds
  s_add_u32 m0, m0, 8192
  s_add_u32 s32, s32, 128
  buffer_load_dwordx4 v155, s[60:63], s32 offen lds
  buffer_load_dwordx4 v156, s[60:63], s32 offen offset:1024 lds
  s_add_u32 s65, s65, 16384
  s_sub_u32 s32, s65, 163840
  s_cmp_eq_u32 s65, s66
  s_cselect_b32 s65, s32, s65
L_sequential_preLN__mha_block__mixer_gmlp__prompt_kernel_p4l_end:
  s_cmp_ge_u32 s36, 28
  s_cbranch_scc1 L_sequential_preLN__mha_block__mixer_gmlp__prompt_kernel_p5l_nost
  s_barrier
L_sequential_preLN__mha_block__mixer_gmlp__prompt_kernel_p5l_nost:
  v_add_u32 v4, s65, v2
  s_waitcnt vmcnt(0)
  ds_write_b128 v4, v[8:11] offset:0
  ds_write_b128 v4, v[12:15] offset:1024
  ds_write_b128 v4, v[16:19] offset:8192
  ds_write_b128 v4, v[20:23] offset:9216
  ds_write_b128 v4, v[136:139] offset:16384
  ds_write_b128 v4, v[140:143] offset:17408
  ds_write_b128 v4, v[144:147] offset:24576
  ds_write_b128 v4, v[148:151] offset:25600
  s_sub_u32 s65, s65, 131072
  s_add_u32 s67, s67, 2
  s_waitcnt lgkmcnt(0)
  s_cmp_lg_u32 s40, 0
  s_cbranch_scc1 L_sequential_preLN__mha_block__mixer_gmlp__prompt_kernel_p5l_nopoll
  s_mul_i32 s69, s57, 7
  s_lshr_b32 s69, s69, 2
  s_min_u32 s69, s69, 11
  s_lshl_b32 s69, s69, 4
  s_add_u32 s69, s69, 6144
  s_and_b32 s33, s36, 7
  s_lshl_b32 s33, s33, 8
  s_add_u32 s69, s69, s33
  s_cmp_lt_u32 s36, 28
  s_cbranch_scc1 L_sequential_preLN__mha_block__mixer_gmlp__prompt_kernel_p5l_nolong
  s_mov_b32 s70, s69
  s_lshl_b32 s70, s70, 7
  s_add_u32 s70, s70, 0x1700000
  v_min_u32 v4, 0, v1
  v_lshlrev_b32 v4, 7, v4
  s_mov_b32 s37, 100000
  s_mov_b64 exec, 0x1
  s_branch L_sequential_preLN__mha_block__mixer_gmlp__prompt_kernel_p5l_poll0g
L_sequential_preLN__mha_block__mixer_gmlp__prompt_kernel_p5l_poll0:
  s_sleep 8
L_sequential_preLN__mha_block__mixer_gmlp__prompt_kernel_p5l_poll0g:
  buffer_load_dwordx2 v[158:159], v4, s[28:31], s70 offen sc1
  s_sub_u32 s37, s37, 1
  s_cbranch_scc1 L_sequential_preLN__mha_block__mixer_gmlp__prompt_kernel_p5l_poll0x
  s_waitcnt vmcnt(0)
  v_cmp_ne_u64 vcc, s[38:39], v[158:159]
  s_and_b64 exec, exec, vcc
  s_cbranch_scc1 L_sequential_preLN__mha_block__mixer_gmlp__prompt_kernel_p5l_poll0
L_sequential_preLN__mha_block__mixer_gmlp__prompt_kernel_p5l_poll0x:
  s_mov_b64 exec, -1
L_sequential_preLN__mha_block__mixer_gmlp__prompt_kernel_p5l_nolong:
  s_lshl_b32 s69, s69, 7
  s_add_u32 s69, s69, 0x1700000
  v_min_u32 v4, 47, v1
  v_lshlrev_b32 v4, 7, v4
  s_mov_b32 s37, 100000
  s_mov_b32 exec_hi, 0xffff
  s_branch L_sequential_preLN__mha_block__mixer_gmlp__prompt_kernel_p5l_pollg
L_sequential_preLN__mha_block__mixer_gmlp__prompt_kernel_p5l_poll:
  s_sleep 2
L_sequential_preLN__mha_block__mixer_gmlp__prompt_kernel_p5l_pollg:
  buffer_load_dwordx2 v[158:159], v4, s[28:31], s69 offen sc1
  s_sub_u32 s37, s37, 1
  s_cbranch_scc1 L_sequential_preLN__mha_block__mixer_gmlp__prompt_kernel_p5l_pollx
  s_waitcnt vmcnt(0)
  v_cmp_ne_u64 vcc, s[38:39], v[158:159]
  s_and_b64 exec, exec, vcc
  s_cbranch_scc1 L_sequential_preLN__mha_block__mixer_gmlp__prompt_kernel_p5l_poll
L_sequential_preLN__mha_block__mixer_gmlp__prompt_kernel_p5l_pollx:
  s_mov_b64 exec, -1
L_sequential_preLN__mha_block__mixer_gmlp__prompt_kernel_p5l_nopoll:
  s_waitcnt vmcnt(12)
  s_barrier
  s_waitcnt vmcnt(0)
  s_barrier
  s_cmp_lg_u32 s40, 0
  s_cbranch_scc1 L_sequential_preLN__mha_block__mixer_gmlp__prompt_kernel_p5l_noz1f
  s_lshr_b32 s69, s36, 1
  s_lshl_b32 s69, s69, 4
  s_lshl_b32 s32, s35, 1
  s_add_u32 s69, s69, s32
  s_and_b32 s32, s36, 1
  s_add_u32 s69, s69, s32
  s_add_u32 s69, s69, 9216
  s_lshl_b32 s69, s69, 7
  s_add_u32 s69, s69, 0x1700000
  v_lshlrev_b32 v4, 15, v1
  v_mov_b32 v158, s38
  v_mov_b32 v159, s39
  s_mov_b64 exec, 1
  buffer_store_dwordx2 v[158:159], v4, s[28:31], s69 offen sc1
  s_mov_b64 exec, -1
L_sequential_preLN__mha_block__mixer_gmlp__prompt_kernel_p5l_noz1f:
  s_mov_b32 m0, s65
  s_add_u32 s33, s67, s68
  s_and_b32 s33, s33, 3
  s_and_b32 s32, s67, 12
  s_or_b32 s32, s32, s33
  s_mul_i32 s32, s32, 256
  s_add_u32 s32, s32, s64
  s_add_u32 s67, s67, 1
  buffer_load_dwordx4 v155, s[60:63], s32 offen lds
  buffer_load_dwordx4 v156, s[60:63], s32 offen offset:1024 lds
  s_add_u32 m0, m0, 8192
  s_add_u32 s32, s32, 128
  buffer_load_dwordx4 v155, s[60:63], s32 offen lds
  buffer_load_dwordx4 v156, s[60:63], s32 offen offset:1024 lds
  s_add_u32 s65, s65, 16384
  s_sub_u32 s32, s65, 163840
  s_cmp_eq_u32 s65, s66
  s_cselect_b32 s65, s32, s65
  s_mov_b32 m0, s65
  s_add_u32 s33, s67, s68
  s_and_b32 s33, s33, 3
  s_and_b32 s32, s67, 12
  s_or_b32 s32, s32, s33
  s_mul_i32 s32, s32, 256
  s_add_u32 s32, s32, s64
  s_add_u32 s67, s67, 1
  buffer_load_dwordx4 v155, s[60:63], s32 offen lds
  buffer_load_dwordx4 v156, s[60:63], s32 offen offset:1024 lds
  s_add_u32 m0, m0, 8192
  s_add_u32 s32, s32, 128
  buffer_load_dwordx4 v155, s[60:63], s32 offen lds
  buffer_load_dwordx4 v156, s[60:63], s32 offen offset:1024 lds
  s_add_u32 s65, s65, 16384
  s_sub_u32 s32, s65, 163840
  s_cmp_eq_u32 s65, s66
  s_cselect_b32 s65, s32, s65
  s_mov_b32 m0, s65
  s_add_u32 s33, s67, s68
  s_and_b32 s33, s33, 3
  s_and_b32 s32, s67, 12
  s_or_b32 s32, s32, s33
  s_mul_i32 s32, s32, 256
  s_add_u32 s32, s32, s64
  s_add_u32 s67, s67, 1
  buffer_load_dwordx4 v155, s[60:63], s32 offen lds
  buffer_load_dwordx4 v156, s[60:63], s32 offen offset:1024 lds
  s_add_u32 m0, m0, 8192
  s_add_u32 s32, s32, 128
  buffer_load_dwordx4 v155, s[60:63], s32 offen lds
  buffer_load_dwordx4 v156, s[60:63], s32 offen offset:1024 lds
  s_add_u32 s65, s65, 16384
  s_sub_u32 s32, s65, 163840
  s_cmp_eq_u32 s65, s66
  s_cselect_b32 s65, s32, s65
  s_mov_b32 m0, s65
  s_add_u32 s33, s67, s68
  s_and_b32 s33, s33, 3
  s_and_b32 s32, s67, 12
  s_or_b32 s32, s32, s33
  s_mul_i32 s32, s32, 256
  s_add_u32 s32, s32, s64
  s_add_u32 s67, s67, 1
  buffer_load_dwordx4 v155, s[60:63], s32 offen lds
  buffer_load_dwordx4 v156, s[60:63], s32 offen offset:1024 lds
  s_add_u32 m0, m0, 8192
  s_add_u32 s32, s32, 128
  buffer_load_dwordx4 v155, s[60:63], s32 offen lds
  buffer_load_dwordx4 v156, s[60:63], s32 offen offset:1024 lds
  s_add_u32 s65, s65, 16384
  s_sub_u32 s32, s65, 163840
  s_cmp_eq_u32 s65, s66
  s_cselect_b32 s65, s32, s65
  s_waitcnt vmcnt(4)
  s_barrier
  s_mov_b32 m0, s65
  s_add_u32 s33, s67, s68
  s_and_b32 s33, s33, 3
  s_and_b32 s32, s67, 12
  s_or_b32 s32, s32, s33
  s_mul_i32 s32, s32, 256
  s_add_u32 s32, s32, s64
  s_add_u32 s67, s67, 1
  buffer_load_dwordx4 v155, s[60:63], s32 offen lds
  buffer_load_dwordx4 v156, s[60:63], s32 offen offset:1024 lds
  s_add_u32 m0, m0, 8192
  s_add_u32 s32, s32, 128
  buffer_load_dwordx4 v155, s[60:63], s32 offen lds
  buffer_load_dwordx4 v156, s[60:63], s32 offen offset:1024 lds
  s_add_u32 s65, s65, 16384
  s_sub_u32 s32, s65, 163840
  s_cmp_eq_u32 s65, s66
  s_cselect_b32 s65, s32, s65
  s_mov_b32 m0, s65
  s_add_u32 s33, s67, s68
  s_and_b32 s33, s33, 3
  s_and_b32 s32, s67, 12
  s_or_b32 s32, s32, s33
  s_mul_i32 s32, s32, 256
  s_add_u32 s32, s32, s64
  s_add_u32 s67, s67, 1
  buffer_load_dwordx4 v155, s[60:63], s32 offen lds
  buffer_load_dwordx4 v156, s[60:63], s32 offen offset:1024 lds
  s_add_u32 m0, m0, 8192
  s_add_u32 s32, s32, 128
  buffer_load_dwordx4 v155, s[60:63], s32 offen lds
  buffer_load_dwordx4 v156, s[60:63], s32 offen offset:1024 lds
  s_add_u32 s65, s65, 16384
  s_sub_u32 s32, s65, 163840
  s_cmp_eq_u32 s65, s66
  s_cselect_b32 s65, s32, s65
  s_waitcnt vmcnt(0)
  s_cmp_lg_u32 s40, 0
  s_cbranch_scc1 L_sequential_preLN__mha_block__mixer_gmlp__prompt_kernel_p5l_noz1
  s_mul_i32 s69, s57, 7
  s_lshr_b32 s69, s69, 2
  s_min_u32 s69, s69, 11
  s_lshl_b32 s69, s69, 4
  s_lshr_b32 s32, s56, 1
  s_add_u32 s69, s69, s32
  s_add_u32 s69, s69, 9216
  s_lshl_b32 s69, s69, 7
  s_add_u32 s69, s69, 0x1700000
  v_min_u32 v4, 2, v1
  v_lshlrev_b32 v4, 11, v4
  s_mov_b32 s37, 100000
  s_mov_b64 exec, 0x7
  s_branch L_sequential_preLN__mha_block__mixer_gmlp__prompt_kernel_p5l_pz1g
L_sequential_preLN__mha_block__mixer_gmlp__prompt_kernel_p5l_pz1:
  s_sleep 2
L_sequential_preLN__mha_block__mixer_gmlp__prompt_kernel_p5l_pz1g:
  buffer_load_dwordx2 v[158:159], v4, s[28:31], s69 offen sc1
  s_sub_u32 s37, s37, 1
  s_cbranch_scc1 L_sequential_preLN__mha_block__mixer_gmlp__prompt_kernel_p5l_pz1x
  s_waitcnt vmcnt(0)
  v_cmp_ne_u64 vcc, s[38:39], v[158:159]
  s_and_b64 exec, exec, vcc
  s_cbranch_scc1 L_sequential_preLN__mha_block__mixer_gmlp__prompt_kernel_p5l_pz1
L_sequential_preLN__mha_block__mixer_gmlp__prompt_kernel_p5l_pz1x:
  s_mov_b64 exec, -1
L_sequential_preLN__mha_block__mixer_gmlp__prompt_kernel_p5l_noz1:
  s_barrier
  s_barrier
  s_lshl_b32 s32, s35, 2
  s_and_b32 s33, s36, 3
  s_add_u32 s41, s32, s33
  s_lshr_b32 s42, s36, 2
  s_lshl_b32 s51, s33, 1
  s_add_u32 s51, s51, s42
  s_and_b32 s51, s51, 0
  s_mul_i32 s51, s51, 7
  s_lshr_b32 s51, s51, 2
  v_lshrrev_b32 v4, 2, v1
  v_lshlrev_b32 v4, 10, v4
  v_and_b32 v5, 3, v1
  v_lshl_add_u32 v152, v5, 4, v4
  v_add_u32 v153, 64, v152
  v_add_u32 v152, 1024, v152
  s_lshr_b32 s32, s40, 1
  s_lshl_b32 s33, s41, 1
  s_add_u32 s32, s32, s33
  s_mul_i32 s48, s32, 57344
  s_and_b32 s32, s40, 1
  s_lshl_b32 s32, s32, 11
  s_add_u32 s48, s48, s32
  s_add_u32 s48, s48, 0x1200000
  s_lshl_b32 s50, s40, 11
  s_lshl_b32 s49, s40, 14
  s_lshl_b32 s32, s42, 7
  s_add_u32 s49, s49, s32
  s_sub_u32 s44, s18, 1024
  s_subb_u32 s45, s19, 0
  s_and_b32 s45, s45, 0xffff
  s_mov_b32 s46, 0xe0400
  s_mov_b32 s47, 0x20000
  v_add_u32 v154, s50, v2
  v_add_u32 v155, 65536, v154
  v_add_u32 v156, 131072, v154
  s_waitcnt vmcnt(0)
  ds_write_b128 v154, v[24:27] offset:0
  ds_write_b128 v154, v[28:31] offset:1024
  ds_write_b128 v154, v[32:35] offset:8192
  ds_write_b128 v154, v[36:39] offset:9216
  ds_write_b128 v154, v[40:43] offset:16384
  ds_write_b128 v154, v[44:47] offset:17408
  ds_write_b128 v154, v[48:51] offset:24576
  ds_write_b128 v154, v[52:55] offset:25600
  s_barrier
L_sequential_preLN__mha_block__mixer_gmlp__prompt_kernel_p6l_nomid:
  ds_write_b128 v154, v[56:59] offset:32768
  ds_write_b128 v154, v[60:63] offset:33792
  ds_write_b128 v154, v[64:67] offset:40960
  ds_write_b128 v154, v[68:71] offset:41984
  ds_write_b128 v154, v[72:75] offset:49152
  ds_write_b128 v154, v[76:79] offset:50176
  ds_write_b128 v154, v[80:83] offset:57344
  ds_write_b128 v154, v[84:87] offset:58368
  ds_write_b128 v155, v[88:91] offset:0
  ds_write_b128 v155, v[92:95] offset:1024
  ds_write_b128 v155, v[96:99] offset:8192
  ds_write_b128 v155, v[100:103] offset:9216
  ds_write_b128 v155, v[104:107] offset:16384
  ds_write_b128 v155, v[108:111] offset:17408
  ds_write_b128 v155, v[112:115] offset:24576
  ds_write_b128 v155, v[116:119] offset:25600
  ds_write_b128 v155, v[120:123] offset:32768
  ds_write_b128 v155, v[124:127] offset:33792
  ds_write_b128 v155, v[128:131] offset:40960
  ds_write_b128 v155, v[132:135] offset:41984
  s_waitcnt lgkmcnt(0)
  s_waitcnt vmcnt(0)
  s_barrier
  s_add_u32 s32, s51, 0
  s_sub_u32 s33, s32, 14
  s_cselect_b32 s32, s32, s33
  s_add_u32 m0, s50, 114688
  s_lshl_b32 s32, s32, 12
  s_add_u32 s32, s32, s48
  buffer_load_dwordx4 v2, s[28:31], s32 offen sc1 lds
  buffer_load_dwordx4 v2, s[28:31], s32 offen offset:1024 sc1 lds
  s_add_u32 s32, s51, 1
  s_sub_u32 s33, s32, 14
  s_cselect_b32 s32, s32, s33
  s_add_u32 m0, s50, 122880
  s_lshl_b32 s32, s32, 12
  s_add_u32 s32, s32, s48
  buffer_load_dwordx4 v2, s[28:31], s32 offen sc1 lds
  buffer_load_dwordx4 v2, s[28:31], s32 offen offset:1024 sc1 lds
  s_add_u32 s32, s51, 2
  s_sub_u32 s33, s32, 14
  s_cselect_b32 s32, s32, s33
  s_add_u32 m0, s50, 131072
  s_lshl_b32 s32, s32, 12
  s_add_u32 s32, s32, s48
  buffer_load_dwordx4 v2, s[28:31], s32 offen sc1 lds
  buffer_load_dwordx4 v2, s[28:31], s32 offen offset:1024 sc1 lds
  s_add_u32 s32, s51, 3
  s_sub_u32 s33, s32, 14
  s_cselect_b32 s32, s32, s33
  s_add_u32 m0, s50, 139264
  s_lshl_b32 s32, s32, 12
  s_add_u32 s32, s32, s48
  buffer_load_dwordx4 v2, s[28:31], s32 offen sc1 lds
  buffer_load_dwordx4 v2, s[28:31], s32 offen offset:1024 sc1 lds
  s_add_u32 s32, s51, 4
  s_sub_u32 s33, s32, 14
  s_cselect_b32 s32, s32, s33
  s_add_u32 m0, s50, 147456
  s_lshl_b32 s32, s32, 12
  s_add_u32 s32, s32, s48
  buffer_load_dwordx4 v2, s[28:31], s32 offen sc1 lds
  buffer_load_dwordx4 v2, s[28:31], s32 offen offset:1024 sc1 lds
  s_waitcnt vmcnt(8)
  s_barrier
  s_add_u32 s32, s51, 5
  s_sub_u32 s33, s32, 14
  s_cselect_b32 s32, s32, s33
  s_add_u32 m0, s50, 155648
  s_lshl_b32 s32, s32, 12
  s_add_u32 s32, s32, s48
  buffer_load_dwordx4 v2, s[28:31], s32 offen sc1 lds
  buffer_load_dwordx4 v2, s[28:31], s32 offen offset:1024 sc1 lds
  s_waitcnt vmcnt(8)
  s_barrier
  s_add_u32 s32, s51, 6
  s_sub_u32 s33, s32, 14
  s_cselect_b32 s32, s32, s33
  s_add_u32 m0, s50, 0
  s_lshl_b32 s32, s32, 12
  s_add_u32 s32, s32, s48
  buffer_load_dwordx4 v2, s[28:31], s32 offen sc1 lds
  buffer_load_dwordx4 v2, s[28:31], s32 offen offset:1024 sc1 lds
  s_waitcnt vmcnt(8)
  s_barrier
  s_add_u32 s32, s51, 7
  s_sub_u32 s33, s32, 14
  s_cselect_b32 s32, s32, s33
  s_add_u32 m0, s50, 114688
  s_lshl_b32 s32, s32, 12
  s_add_u32 s32, s32, s48
  buffer_load_dwordx4 v2, s[28:31], s32 offen sc1 lds
  buffer_load_dwordx4 v2, s[28:31], s32 offen offset:1024 sc1 lds
  s_waitcnt vmcnt(8)
  s_barrier
  s_add_u32 s32, s51, 8
  s_sub_u32 s33, s32, 14
  s_cselect_b32 s32, s32, s33
  s_add_u32 m0, s50, 8192
  s_lshl_b32 s32, s32, 12
  s_add_u32 s32, s32, s48
  buffer_load_dwordx4 v2, s[28:31], s32 offen sc1 lds
  buffer_load_dwordx4 v2, s[28:31], s32 offen offset:1024 sc1 lds
  s_waitcnt vmcnt(8)
  s_barrier
  s_add_u32 s32, s51, 9
  s_sub_u32 s33, s32, 14
  s_cselect_b32 s32, s32, s33
  s_add_u32 m0, s50, 122880
  s_lshl_b32 s32, s32, 12
  s_add_u32 s32, s32, s48
  buffer_load_dwordx4 v2, s[28:31], s32 offen sc1 lds
  buffer_load_dwordx4 v2, s[28:31], s32 offen offset:1024 sc1 lds
  s_waitcnt vmcnt(8)
  s_barrier
  s_add_u32 s32, s51, 10
  s_sub_u32 s33, s32, 14
  s_cselect_b32 s32, s32, s33
  s_add_u32 m0, s50, 16384
  s_lshl_b32 s32, s32, 12
  s_add_u32 s32, s32, s48
  buffer_load_dwordx4 v2, s[28:31], s32 offen sc1 lds
  buffer_load_dwordx4 v2, s[28:31], s32 offen offset:1024 sc1 lds
  s_waitcnt vmcnt(8)
  s_barrier
  s_add_u32 s32, s51, 11
  s_sub_u32 s33, s32, 14
  s_cselect_b32 s32, s32, s33
  s_add_u32 m0, s50, 131072
  s_lshl_b32 s32, s32, 12
  s_add_u32 s32, s32, s48
  buffer_load_dwordx4 v2, s[28:31], s32 offen sc1 lds
  buffer_load_dwordx4 v2, s[28:31], s32 offen offset:1024 sc1 lds
  s_waitcnt vmcnt(8)
  s_barrier
  s_add_u32 s32, s51, 12
  s_sub_u32 s33, s32, 14
  s_cselect_b32 s32, s32, s33
  s_add_u32 m0, s50, 24576
  s_lshl_b32 s32, s32, 12
  s_add_u32 s32, s32, s48
  buffer_load_dwordx4 v2, s[28:31], s32 offen sc1 lds
  buffer_load_dwordx4 v2, s[28:31], s32 offen offset:1024 sc1 lds
  s_waitcnt vmcnt(8)
  s_barrier
  s_add_u32 s32, s51, 13
  s_sub_u32 s33, s32, 14
  s_cselect_b32 s32, s32, s33
  s_add_u32 m0, s50, 139264
  s_lshl_b32 s32, s32, 12
  s_add_u32 s32, s32, s48
  buffer_load_dwordx4 v2, s[28:31], s32 offen sc1 lds
  buffer_load_dwordx4 v2, s[28:31], s32 offen offset:1024 sc1 lds
  s_waitcnt vmcnt(8)
  s_barrier
  s_waitcnt vmcnt(6)
  s_barrier
  s_waitcnt vmcnt(4)
  s_barrier
  s_waitcnt vmcnt(2)
  s_barrier
  s_waitcnt vmcnt(0)
  s_barrier
  s_endpgm
L_sequential_preLN__mha_block__mixer_gmlp__prompt_kernel_codeend:
.section .rodata,"a"
.p2align 6
.amdhsa_kernel sequential_preLN__mha_block__mixer_gmlp__prompt_kernel
  .amdhsa_next_free_vgpr 164
  .amdhsa_next_free_sgpr 76
  .amdhsa_accum_offset 164
  .amdhsa_group_segment_fixed_size 0
  .amdhsa_kernarg_size 88
  .amdhsa_user_sgpr_count 2
  .amdhsa_user_sgpr_kernarg_segment_ptr 1
  .amdhsa_system_sgpr_workgroup_id_x 1
.end_amdhsa_kernel
```
